```python
import torch

def _softmax(x, axis=-1):
    return torch.softmax(x, dim=axis)
def _gelu(x):
    return torch.nn.functional.gelu(x, approximate="tanh")
def _silu(x):
    return torch.nn.functional.silu(x)
def _sigmoid(x):
    return torch.sigmoid(x)
def _layernorm(x, axis=-1, eps=1e-5):
    m = x.mean(dim=axis, keepdim=True)
    v = x.var(dim=axis, keepdim=True, unbiased=False)
    return (x - m) / torch.sqrt(v + eps)
def _scatter_add(tgt, idx, src, axis=0):
    return tgt.clone().index_add_(axis, idx, src)
def _segment_sum(src, seg, n):
    out = torch.zeros((n,) + src.shape[1:], dtype=src.dtype)
    return out.index_add_(0, seg, src)
def _pad(x, pw):
    flat = tuple(v for pair in reversed(pw) for v in pair)
    return torch.nn.functional.pad(x, flat)

kernel_name = 'sequential_preLN__ssm_conv_h3__geglu_ffn__prompt'

def setup_inputs():

    _w = (lambda a: (lambda t: t.to(torch.bfloat16) if t.is_floating_point() else t)(torch.as_tensor(a)))
    def _A_setup():
        B, S, D = 1, 2048, 640
        ks = 4
        return {
            "q": _w((lambda *s: torch.randn(*s, dtype=torch.bfloat16) * 0.05)(B, S, D)),
            "k": _w((lambda *s: torch.randn(*s, dtype=torch.bfloat16) * 0.4)(B, S, D)),
            "v": _w((lambda *s: torch.randn(*s, dtype=torch.bfloat16) * 0.4)(B, S, D)),
            "shift_k": _w((lambda *s: torch.randn(*s, dtype=torch.bfloat16) * 0.4)(D, ks) * 0.5),
            "ssm_k": _w((lambda *s: torch.randn(*s, dtype=torch.bfloat16) * 0.4)(D, S) * (1.0 / S ** 0.5)),
            "ssm_D": _w((lambda *s: torch.randn(*s, dtype=torch.bfloat16) * 0.4)(D)),
        }
    _A_in = _A_setup()

    def _B_setup():
        B, S, D, F = 1, 2048, 640, 1536
        return {
            "x": _w((lambda *s: torch.randn(*s, dtype=torch.bfloat16) * 0.05)(B, S, D)),
            "w_gate": _w((lambda *s: torch.randn(*s, dtype=torch.bfloat16) * 0.05)(D, F)),
            "w_up": _w((lambda *s: torch.randn(*s, dtype=torch.bfloat16) * 0.05)(D, F)),
            "w_down": _w((lambda *s: torch.randn(*s, dtype=torch.bfloat16) * 0.05)(F, D)),
        }
    _B_in = _B_setup()

    return {
        "A_q": _A_in["q"],
        "A_k": _A_in["k"],
        "A_v": _A_in["v"],
        "A_shift_k": _A_in["shift_k"],
        "A_ssm_k": _A_in["ssm_k"],
        "A_ssm_D": _A_in["ssm_D"],
        "B_x": _B_in["x"],
        "B_w_gate": _B_in["w_gate"],
        "B_w_up": _B_in["w_up"],
        "B_w_down": _B_in["w_down"],
    }

def reference(A_q, A_k, A_v, A_shift_k, A_ssm_k, A_ssm_D, B_x, B_w_gate, B_w_up, B_w_down):
    def _A_ref(q, k, v, shift_k, ssm_k, ssm_D):
        B, S, D = q.shape
        ks = shift_k.shape[-1]
        k_pad = _pad(k, ((0, 0), (ks - 1, 0), (0, 0)))
        k_shift = torch.zeros_like(k)
        for t in range(ks):
            k_shift = k_shift + k_pad[:, t:t + S, :] * shift_k[:, ks - 1 - t][None, None, :]
        kv = k_shift * v
        L = 2 * S
        kv_pad = _pad(kv, ((0, 0), (0, S), (0, 0)))
        kf_pad = _pad(ssm_k, ((0, 0), (0, S)))
        kv_f = (lambda x, axes=(-2,-1): torch.fft.rfft2(x.float(), dim=axes))(kv_pad[:, None, :, :], axes=(1, 2))
        kf_f = (lambda x, axes=(-2,-1): torch.fft.rfft2(x.float(), dim=axes))(kf_pad[:, None, :], axes=(1, 2))
        kf_f = (lambda x, *d: x.permute(*d))(kf_f, 1, 2, 0)
        y_f = kv_f * kf_f[None, :, :, :]
        y = (lambda x, s, axes=(-2,-1): torch.fft.irfft2(x, s=s, dim=axes).to(torch.bfloat16))(y_f, (1, L), axes=(1, 2))[:, 0, :S, :]
        y = y + kv * ssm_D[None, None, :]
        return q * y

    def _B_ref(x, w_gate, w_up, w_down):
        return (_gelu(x @ w_gate) * (x @ w_up)) @ w_down

    x = A_q
    h = x + _A_ref(_layernorm(x, axis=-1), A_k, A_v, A_shift_k, A_ssm_k, A_ssm_D)
    h2 = h + _B_ref(_layernorm(h, axis=-1), B_w_gate, B_w_up, B_w_down)
    return h2
```

```asm
; @launch grid=(256,1,1) block=(256,1,1) lds=163840
.amdgcn_target "amdgcn-amd-amdhsa--gfx950"
.text
.globl sequential_preLN__ssm_conv_h3__geglu_ffn__prompt_kernel
.p2align 8
.type sequential_preLN__ssm_conv_h3__geglu_ffn__prompt_kernel,@function
sequential_preLN__ssm_conv_h3__geglu_ffn__prompt_kernel:
    s_load_dwordx2 s[4:5], s[0:1], 8
    s_load_dwordx2 s[40:41], s[0:1], 96
    s_getpc_b64 s[46:47]
    s_lshr_b32 s58, s2, 3
    s_min_u32 s71, s58, 31
    s_mul_i32 s71, s71, 1536
    v_min_u32 v14, 23, v0
    v_lshl_add_u32 v14, v14, 6, s71
    global_load_dword v15, v14, s[46:47]
    s_load_dwordx2 s[8:9], s[0:1], 16
    s_load_dwordx2 s[12:13], s[0:1], 24
    s_load_dwordx2 s[20:21], s[0:1], 0
    s_load_dwordx2 s[24:25], s[0:1], 56
    s_load_dwordx2 s[32:33], s[0:1], 64
    s_load_dwordx2 s[16:17], s[0:1], 32
    s_load_dwordx2 s[28:29], s[0:1], 72
    s_load_dwordx2 s[36:37], s[0:1], 80
    s_load_dwordx2 s[34:35], s[0:1], 40
    s_cmp_ge_u32 s2, 256
    s_cbranch_scc1 L_end
    v_lshrrev_b32 v12, 6, v0
    v_and_b32 v1, 63, v0
    v_readfirstlane_b32 s56, v12
    s_and_b32 s57, s2, 7
    v_bfrev_b32 v5, 1
    v_lshlrev_b32 v2, 4, v1
    v_and_b32 v7, 15, v1
    v_lshrrev_b32 v8, 4, v1
    s_cmp_ge_u32 s58, 20
    s_cbranch_scc1 L_prep
    s_cmp_ge_u32 s58, 10
    s_cselect_b32 s72, 10, 0
    s_addc_u32 s78, s57, s57
    s_sub_u32 s72, s58, s72
    s_lshl2_add_u32 s71, s78, s56
    s_mul_i32 s73, s71, 40960
    s_lshl_b32 s74, s72, 7
    s_add_u32 s73, s73, s74
    v_lshrrev_b32_e64 v58, 3, v1
    v_mul_u32_u24 v56, 1280, v58
    v_and_b32_e64 v58, 7, v1
    v_lshl_add_u32 v56, v58, 4, v56
    s_cmp_eq_u32 s71, 0
    s_cselect_b32 s75, 64, 40
    s_cselect_b32 s76, 0, 10240
    v_cmp_gt_u32 vcc, s75, v1
    s_sub_u32 s76, s73, s76
    s_mov_b32 s6, 2621440
    s_mov_b32 s7, 0x00020000
    s_mov_b32 s10, 2621440
    s_mov_b32 s11, 0x00020000
    s_mov_b32 s14, 5120
    s_mov_b32 s15, 0x00020000
    s_mov_b32 s18, 2621440
    s_mov_b32 s19, 0x00020000
    v_cndmask_b32_e64 v57, v56, v5, vcc
    s_mul_i32 s66, s56, 16640
    s_add_u32 s66, s66, 18304
    s_lshl_b32 s74, s72, 9
    v_lshrrev_b32 v59, 2, v1
    v_lshlrev_b32_e64 v58, 5, v59
    s_add_u32 m0, s66, 1088
    s_mov_b32 s42, 21364736
    s_mov_b32 s43, 0x00020000
    v_cmp_ne_u32 vcc, 0, v0
    s_mov_b32 s59, 0xffff0000
    s_nop 0
    v_cndmask_b32_e64 v4, 0, v5, vcc
    s_mul_i32 s65, s57, 20
    s_add_u32 s65, s65, s58
    s_lshl2_add_u32 s77, s65, s56
    s_lshr_b32 s77, s77, 1
    s_lshl_b32 s77, s77, 2
    s_waitcnt lgkmcnt(0)
    buffer_load_dwordx4 v56, s[4:7], s73 offen lds
    s_load_dwordx2 s[44:45], s[40:41], 524032
    s_load_dword s20, s[34:35], s77
    s_add_u32 m0, s66, 2176
    s_add_u32 s75, s73, 10240
    buffer_load_dwordx4 v56, s[4:7], s75 offen lds
    s_add_u32 m0, s66, 3264
    s_add_u32 s75, s73, 20480
    buffer_load_dwordx4 v56, s[4:7], s75 offen lds
    s_add_u32 m0, s66, 4352
    s_add_u32 s75, s73, 30720
    buffer_load_dwordx4 v56, s[4:7], s75 offen lds
    s_mov_b32 m0, s66
    buffer_load_dwordx4 v[100:103], v58, s[12:15], s74 offen
    buffer_load_dwordx4 v57, s[4:7], s76 offen lds
    s_add_u32 m0, s66, 5440
    s_nop 0
    buffer_load_dwordx4 v[104:107], v58, s[12:15], s74 offen offset:16
    buffer_load_dwordx4 v56, s[8:11], s73 offen lds
    s_add_u32 m0, s66, 6528
    s_add_u32 s75, s73, 10240
    buffer_load_dwordx4 v56, s[8:11], s75 offen lds
    s_add_u32 m0, s66, 7616
    s_add_u32 s75, s73, 20480
    buffer_load_dwordx4 v56, s[8:11], s75 offen lds
    s_add_u32 m0, s66, 8704
    s_add_u32 s75, s73, 30720
    buffer_load_dwordx4 v56, s[8:11], s75 offen lds
    s_mov_b32 s22, s65
    s_lshl2_add_u32 s29, s22, s56
    s_lshl_b32 s54, s29, 12
    v_cmp_eq_u32 vcc, 0, v1
    v_add_u32 v149, 1016, v2
    v_subrev_u32 v148, 8, v2
    v_cndmask_b32 v148, v148, v5, vcc
    s_and_b32 s61, s57, 1
    s_lshl_b32 s61, s61, 3
    s_lshr_b32 s73, s58, 2
    s_add_u32 s61, s61, s73
    s_lshr_b32 s62, s57, 1
    s_lshl_b32 s62, s62, 2
    s_and_b32 s73, s58, 3
    s_add_u32 s62, s62, s73
    s_lshr_b32 s63, s62, 2
    s_mul_i32 s74, s62, 192
    s_add_u32 s73, s63, 0
    s_and_b32 s73, s73, 3
    s_mul_i32 s73, s73, 491520
    s_add_u32 s67, s74, s73
    s_add_u32 s73, s63, 1
    s_and_b32 s73, s73, 3
    s_mul_i32 s73, s73, 491520
    s_add_u32 s68, s74, s73
    s_add_u32 s73, s63, 2
    s_and_b32 s73, s73, 3
    s_mul_i32 s73, s73, 491520
    s_add_u32 s69, s74, s73
    s_add_u32 s73, s63, 3
    s_and_b32 s73, s73, 3
    s_mul_i32 s73, s73, 491520
    s_add_u32 s70, s74, s73
    s_lshr_b32 s73, s56, 1
    s_lshl_b32 s73, s73, 3
    s_movk_i32 s74, 3072
    s_mul_i32 s95, s56, 3088
    v_add_u32 v58, 0, v1
    v_mul_u32_u24 v59, 5462, v58
    v_lshrrev_b32 v59, 16, v59
    v_mul_u32_u24 v60, 12, v59
    v_sub_u32 v58, v58, v60
    v_lshlrev_b32 v58, 4, v58
    v_and_b32 v60, 8, v59
    v_add3_u32 v59, v59, v60, s73
    v_mad_u32_u24 v51, v59, s74, v58
    v_add_u32_e64 v58, 64, v1
    v_mul_u32_u24 v59, 5462, v58
    v_lshrrev_b32 v59, 16, v59
    v_mul_u32_u24 v60, 12, v59
    v_sub_u32 v58, v58, v60
    v_lshlrev_b32 v58, 4, v58
    v_and_b32_e64 v60, 8, v59
    v_add3_u32 v59, v59, v60, s73
    v_mad_u32_u24 v52, v59, s74, v58
    v_add_u32 v58, 128, v1
    v_mul_u32_u24 v59, 5462, v58
    v_lshrrev_b32 v59, 16, v59
    v_mul_u32_u24 v60, 12, v59
    v_sub_u32 v58, v58, v60
    v_lshlrev_b32 v58, 4, v58
    v_and_b32_e64 v60, 8, v59
    v_add3_u32 v59, v59, v60, s73
    v_mad_u32_u24 v53, v59, s74, v58
    s_mov_b32 s26, 1966080
    s_mov_b32 s27, 0x00020000
    s_bitcmp1_b32 s56, 0
    s_cselect_b32 s24, s32, s24
    s_cselect_b32 s25, s33, s25
    v_bfe_u32 v60, v1, 2, 2
    v_and_b32 v58, 1, v8
    v_mul_u32_u24 v54, 6176, v58
    v_lshrrev_b32_e64 v58, 1, v8
    v_lshl_add_u32 v58, v58, 3, v60
    v_mul_u32_u24 v58, 192, v58
    s_mul_i32 s73, s56, 48
    s_add_u32 s73, s73, 84864
    v_add3_u32 v54, v54, v58, s73
    v_and_b32 v60, 3, v1
    v_lshrrev_b32 v58, 1, v60
    v_mul_u32_u24 v58, 3088, v58
    v_and_b32 v59, 1, v60
    v_lshl_add_u32 v58, v59, 3, v58
    v_add3_u32 v55, v54, v58, 32
    v_lshl_add_u32 v54, v60, 3, v54
    v_min_u32 v58, 23, v1
    v_mul_u32_u24 v59, 10923, v58
    v_lshrrev_b32 v59, 16, v59
    v_mul_u32_u24 v59, 2304, v59
    v_lshl_add_u32 v150, v58, 7, v59
    s_lshr_b32 s73, s56, 1
    s_lshl1_add_u32 s73, s58, s73
    s_mul_i32 s73, s73, 12288
    s_and_b32 s74, s62, 3
    s_mul_i32 s74, s74, 192
    s_sub_u32 s65, s73, s74
    s_lshl4_add_u32 s23, s72, s78
    s_lshl_b32 s23, s23, 7
    v_lshrrev_b32 v59, 2, v1
    v_and_b32 v58, 3, v1
    v_mul_u32_u24 v151, 1088, v58
    v_lshl_add_u32 v151, v59, 3, v151
    v_add_u32_e64 v151, s66, v151
    v_mul_u32_u24 v152, 16896, v59
    v_lshl_add_u32 v152, v58, 4, v152
    s_mul_i32 s30, s72, 270336
    s_lshl_b32 s74, s71, 6
    s_add_u32 s30, s30, s74
    v_bfe_u32 v58, v7, 1, 2
    v_xor_b32 v58, s56, v58
    v_lshlrev_b32 v58, 4, v58
    v_lshl_add_u32 v47, v7, 7, v58
    v_lshrrev_b32 v58, 1, v8
    v_lshl_add_u32 v47, v58, 6, v47
    v_and_b32 v58, 1, v8
    v_lshl_add_u32 v47, v58, 3, v47
    v_add_u32 v47, 147456, v47
    v_add_u32 v48, 155648, v2
    s_mul_i32 s73, s56, 16640
    s_add_u32 s73, s73, 18360
    v_and_b32 v58, 3, v7
    v_sub_u32 v58, 3, v58
    v_mul_u32_u24 v44, 4160, v58
    v_lshrrev_b32_e64 v58, 2, v7
    v_lshl_add_u32 v44, v58, 3, v44
    v_lshlrev_b32 v58, 4, v8
    v_sub_u32 v44, v44, v58
    v_add_u32_e64 v44, s73, v44
    s_mul_i32 s74, s56, 4576
    v_lshl_add_u32 v45, v7, 1, v8
    v_lshl_add_u32 v45, v45, 4, s74
    v_lshrrev_b32 v58, 1, v8
    v_lshl_add_u32 v46, v7, 1, v58
    v_lshlrev_b32 v46, 4, v46
    v_and_b32 v59, 1, v8
    v_lshlrev_b32 v59, 3, v59
    v_sub_u32 v46, v46, v59
    s_add_u32 s77, s74, 488
    v_add_u32 v46, s77, v46
    s_bfe_u32 s77, s29, 0x10001
    s_bfe_u32 s78, s29, 0x10003
    s_lshl1_add_u32 s77, s78, s77
    v_and_b32 v58, 2, v8
    v_bfe_u32 v59, v7, 1, 1
    v_or_b32 v58, v58, v59
    v_xor_b32 v58, s77, v58
    v_lshlrev_b32 v58, 5, v58
    v_and_b32 v59, 1, v7
    v_lshl_add_u32 v58, v59, 4, v58
    v_and_b32 v59, 1, v8
    v_lshlrev_b32 v59, 2, v59
    v_lshrrev_b32 v49, 2, v7
    v_add_u32 v49, v49, v59
    s_mov_b32 s78, 81920
    v_mad_u32_u24 v49, v49, s78, v58
    s_lshl_b32 s31, s29, 7
    s_add_u32 s31, s31, 6553600
    v_mov_b32 v154, 0
    v_mov_b32 v155, 0
    v_mov_b32 v156, 0
    v_mov_b32 v157, 0
    v_add_u32 v58, s74, v2
    v_subrev_u32 v59, 30, v1
    v_lshrrev_b32 v158, 1, v59
    v_mul_u32_u24 v158, 4160, v158
    v_and_b32 v59, 1, v59
    v_lshl_add_u32 v158, v59, 4, v158
    v_cmp_gt_u32 vcc, 30, v1
    s_sub_u32 s73, s73, 56
    v_add_u32 v158, s73, v158
    v_cndmask_b32 v159, v158, v58, vcc
    v_add_u32 v158, s73, v2
    s_lshl_b32 s28, s22, 6
    s_add_u32 s77, s28, 40960
    s_add_u32 s28, s28, 20480
    v_add_u32 v6, s77, v4
    s_add_u32 s77, s57, 1312
    s_lshl_b32 s77, s77, 7
    s_cmp_eq_u32 s58, 0
    s_cselect_b32 s77, s77, 0x80000000
    v_or_b32_e64 v50, s77, v4
    s_and_b32 s77, s22, 0xf0
    v_add_lshl_u32 v9, v7, s77, 7
    s_mov_b32 s38, 2621440
    s_mov_b32 s39, 0x00020000
    s_lshl2_add_u32 s72, s62, s56
    v_min_u32 v36, 29, v1
    v_lshlrev_b32 v36, 7, v36
    s_lshl_b32 s88, s72, 8
    s_add_u32 s88, s88, 188416
    v_min_u32 v30, 2, v7
    v_lshl_add_u32 v30, v30, 2, v8
    v_lshlrev_b32 v30, 4, v30
    s_mul_i32 s86, s61, 196608
    s_mul_i32 s72, s72, 768
    s_add_u32 s86, s86, s72
    s_add_u32 s86, s86, 15073280
    s_lshl4_add_u32 s87, s61, s62
    s_add_u32 s87, s87, 480
    s_lshl_b32 s87, s87, 7
    s_add_u32 s71, s56, 1
    s_and_b32 s71, s71, 3
    s_lshl_b32 s84, s71, 12
    s_lshl2_add_u32 s72, s63, s63
    s_add_u32 s71, s71, s72
    s_mul_i32 s72, s61, 81920
    s_add_u32 s72, s72, 6553600
    s_add_u32 s73, s71, 0
    s_sub_u32 s74, s73, 20
    s_min_u32 s73, s73, s74
    s_lshl_b32 s73, s73, 12
    s_add_u32 s79, s72, s73
    s_add_u32 s73, s71, 4
    s_sub_u32 s74, s73, 20
    s_min_u32 s73, s73, s74
    s_lshl_b32 s73, s73, 12
    s_add_u32 s80, s72, s73
    s_add_u32 s73, s71, 8
    s_sub_u32 s74, s73, 20
    s_min_u32 s73, s73, s74
    s_lshl_b32 s73, s73, 12
    s_add_u32 s81, s72, s73
    s_add_u32 s73, s71, 12
    s_sub_u32 s74, s73, 20
    s_min_u32 s73, s73, s74
    s_lshl_b32 s73, s73, 12
    s_add_u32 s82, s72, s73
    s_add_u32 s73, s71, 16
    s_sub_u32 s74, s73, 20
    s_min_u32 s73, s73, s74
    s_lshl_b32 s73, s73, 12
    s_add_u32 s83, s72, s73
    v_add_u32 v3, 1310720, v2
    v_lshrrev_b32 v27, 3, v1
    v_min_u32 v27, 4, v27
    v_lshl_add_u32 v27, v27, 2, s71
    v_subrev_u32 v58, 20, v27
    v_min_u32 v27, v27, v58
    s_and_b32 s73, s62, 3
    s_lshl_b32 s73, s73, 10
    s_add_u32 s73, s73, s72
    v_and_b32 v58, 7, v1
    v_lshl_add_u32 v37, v27, 5, v58
    v_lshl_add_u32 v37, v37, 7, s73
    v_lshl_add_u32 v27, v27, 3, v58
    v_lshlrev_b32 v27, 6, v27
    v_add_u32 v27, 20480, v27
    v_bfe_u32 v58, v1, 2, 2
    v_lshl_add_u32 v59, v8, 3, v58
    v_lshlrev_b32 v59, 7, v59
    s_mov_b32 s3, 0
    s_mov_b64 exec, 0
    s_cmp_eq_u32 s56, 0
    s_cbranch_scc1 L_pg1
    s_cmp_eq_u32 s56, 1
    s_cbranch_scc1 L_pg2
    s_cmp_eq_u32 s56, 2
    s_cbranch_scc1 L_pg3
    s_branch L_pg4
L_pgret:
    s_mov_b64 exec, -1
    s_cmp_eq_u32 s3, 1
    s_cbranch_scc1 L_pgret2
    s_branch L_main
L_spin3:
    s_mov_b32 s60, 200000
L_lp4:
    s_mov_b64 exec, vcc
    buffer_load_dwordx2 v[12:13], v9, s[40:43], 0 offen sc1
    s_waitcnt vmcnt(0)
    v_cmp_ne_u64 vcc, v[10:11], v[12:13]
    s_cbranch_vccz L_out5
    s_sleep 1
    s_sub_u32 s60, s60, 1
    s_cmp_lg_u32 s60, 0
    s_cbranch_scc1 L_lp4
L_out5:
    s_mov_b64 exec, -1
    s_branch L_ok2
L_spin10:
    s_mov_b32 s60, 200000
L_lp11:
    s_mov_b64 exec, vcc
    buffer_load_dwordx2 v[12:13], v9, s[40:43], s76 offen sc1
    s_waitcnt vmcnt(0)
    v_cmp_ne_u64 vcc, v[10:11], v[12:13]
    s_cbranch_vccz L_out12
    s_sleep 6
    s_sub_u32 s60, s60, 1
    s_cmp_lg_u32 s60, 0
    s_cbranch_scc1 L_lp11
L_out12:
    s_mov_b64 exec, -1
    s_branch L_ok9
L_spin14:
    s_mov_b32 s60, 200000
L_lp15:
    s_mov_b64 exec, vcc
    buffer_load_dwordx2 v[12:13], v9, s[40:43], s78 offen sc1
    s_waitcnt vmcnt(0)
    v_cmp_ne_u64 vcc, v[10:11], v[12:13]
    s_cbranch_vccz L_out16
    s_sleep 6
    s_sub_u32 s60, s60, 1
    s_cmp_lg_u32 s60, 0
    s_cbranch_scc1 L_lp15
L_out16:
    s_mov_b64 exec, -1
    s_branch L_ok13
L_spin18:
    s_mov_b32 s60, 200000
L_lp19:
    s_mov_b64 exec, vcc
    buffer_load_dwordx2 v[12:13], v27, s[40:43], 0 offen sc1
    s_waitcnt vmcnt(0)
    v_cmp_ne_u64 vcc, v[10:11], v[12:13]
    s_cbranch_vccz L_out20
    s_sleep 4
    s_sub_u32 s60, s60, 1
    s_cmp_lg_u32 s60, 0
    s_cbranch_scc1 L_lp19
L_out20:
    s_mov_b64 exec, -1
    s_branch L_ok17
L_spin24:
    s_mov_b32 s60, 200000
L_lp25:
    s_mov_b64 exec, vcc
    buffer_load_dwordx2 v[12:13], v9, s[40:43], s76 offen sc1
    s_waitcnt vmcnt(0)
    v_cmp_ne_u64 vcc, v[10:11], v[12:13]
    s_cbranch_vccz L_out26
    s_sleep 4
    s_sub_u32 s60, s60, 1
    s_cmp_lg_u32 s60, 0
    s_cbranch_scc1 L_lp25
L_out26:
    s_mov_b64 exec, -1
    s_branch L_ok23
L_spin28:
    s_mov_b32 s60, 200000
L_lp29:
    s_mov_b64 exec, vcc
    buffer_load_dwordx2 v[12:13], v27, s[40:43], 0 offen sc1
    s_waitcnt vmcnt(0)
    v_cmp_ne_u64 vcc, v[10:11], v[12:13]
    s_cbranch_vccz L_out30
    s_sleep 4
    s_sub_u32 s60, s60, 1
    s_cmp_lg_u32 s60, 0
    s_cbranch_scc1 L_lp29
L_out30:
    s_mov_b64 exec, -1
    s_branch L_ok27
L_spin34:
    s_mov_b32 s60, 200000
L_lp35:
    s_mov_b64 exec, vcc
    buffer_load_dwordx2 v[14:15], v29, s[40:43], 0 offen sc1
    s_waitcnt vmcnt(0)
    v_cmp_ne_u64 vcc, v[10:11], v[14:15]
    s_cbranch_vccz L_out36
    s_sleep 1
    s_sub_u32 s60, s60, 1
    s_cmp_lg_u32 s60, 0
    s_cbranch_scc1 L_lp35
L_out36:
    s_mov_b64 exec, -1
    s_branch L_ok33
L_spin38:
    s_mov_b32 s60, 200000
L_lp39:
    s_mov_b64 exec, vcc
    buffer_load_dwordx2 v[12:13], v27, s[40:43], s76 offen sc1
    s_waitcnt vmcnt(0)
    v_cmp_ne_u64 vcc, v[10:11], v[12:13]
    s_cbranch_vccz L_out40
    s_sleep 4
    s_sub_u32 s60, s60, 1
    s_cmp_lg_u32 s60, 0
    s_cbranch_scc1 L_lp39
L_out40:
    s_mov_b64 exec, -1
    s_branch L_ok37
L_spin42:
    s_mov_b32 s60, 200000
L_lp43:
    s_mov_b64 exec, vcc
    buffer_load_dwordx4 v[156:159], v2, s[40:43], s85 offen offset:0 sc1
    s_waitcnt vmcnt(0)
    v_xor_b32 v157, v10, v157
    v_bitop3_b32 v157, v159, v11, v157 bitop3:0xbe
    v_cmp_ne_u32 vcc, 0, v157
    s_cbranch_vccz L_out44
    s_sleep 1
    s_sub_u32 s60, s60, 1
    s_cmp_lg_u32 s60, 0
    s_cbranch_scc1 L_lp43
L_out44:
    s_mov_b64 exec, -1
    s_branch L_ok41
L_spin48:
    s_mov_b32 s60, 200000
L_lp49:
    s_mov_b64 exec, vcc
    buffer_load_dwordx4 v[156:159], v2, s[40:43], s85 offen offset:0 sc1
    s_waitcnt vmcnt(0)
    v_xor_b32 v157, v10, v157
    v_bitop3_b32 v157, v159, v11, v157 bitop3:0xbe
    v_cmp_ne_u32 vcc, 0, v157
    s_cbranch_vccz L_out50
    s_sleep 1
    s_sub_u32 s60, s60, 1
    s_cmp_lg_u32 s60, 0
    s_cbranch_scc1 L_lp49
L_out50:
    s_mov_b64 exec, -1
    s_branch L_ok47
L_spin52:
    s_mov_b32 s60, 200000
L_lp53:
    s_mov_b64 exec, vcc
    buffer_load_dwordx2 v[12:13], v28, s[40:43], s94 offen sc1
    s_waitcnt vmcnt(0)
    v_cmp_ne_u64 vcc, v[10:11], v[12:13]
    s_cbranch_vccz L_out54
    s_sleep 1
    s_sub_u32 s60, s60, 1
    s_cmp_lg_u32 s60, 0
    s_cbranch_scc1 L_lp53
L_out54:
    s_mov_b64 exec, -1
    s_branch L_ok51
L_spin56:
    s_mov_b32 s60, 200000
L_lp57:
    s_mov_b64 exec, vcc
    buffer_load_dwordx2 v[12:13], v28, s[40:43], s77 offen sc1
    s_waitcnt vmcnt(0)
    v_cmp_ne_u64 vcc, v[10:11], v[12:13]
    s_cbranch_vccz L_out58
    s_sub_u32 s60, s60, 1
    s_cmp_lg_u32 s60, 0
    s_cbranch_scc1 L_lp57
L_out58:
    s_mov_b64 exec, -1
    s_branch L_ok55
.p2align 12
L_main:
    s_waitcnt vmcnt(4)
    ds_read_b64 v[62:63], v151 offset:640
    ds_read_b64 v[64:65], v151 offset:768
    ds_read_b64 v[66:67], v151 offset:896
    s_nop 0
    ds_read_b64 v[68:69], v151 offset:1088
    ds_read_b64 v[70:71], v151 offset:1216
    ds_read_b64 v[72:73], v151 offset:1344
    ds_read_b64 v[74:75], v151 offset:1472
    ds_read_b64 v[76:77], v151 offset:1600
    ds_read_b64 v[78:79], v151 offset:1728
    ds_read_b64 v[80:81], v151 offset:1856
    ds_read_b64 v[82:83], v151 offset:1984
    buffer_load_dwordx4 v[124:127], v2, s[16:19], s54 offen offset:0
    buffer_load_dwordx2 v[140:141], v148, s[16:19], s54 offen offset:0
    buffer_load_dwordx4 v[128:131], v2, s[16:19], s54 offen offset:1024
    buffer_load_dwordx2 v[142:143], v149, s[16:19], s54 offen offset:0
    buffer_load_dwordx4 v[132:135], v2, s[16:19], s54 offen offset:2048
    buffer_load_dwordx2 v[144:145], v149, s[16:19], s54 offen offset:1024
    buffer_load_dwordx4 v[136:139], v2, s[16:19], s54 offen offset:3072
    buffer_load_dwordx2 v[146:147], v149, s[16:19], s54 offen offset:2048
    v_lshlrev_b32 v108, 16, v100
    v_lshlrev_b32 v109, 16, v102
    v_and_b32 v110, s59, v100
    v_and_b32 v111, s59, v102
    v_lshlrev_b32 v112, 16, v101
    v_lshlrev_b32 v113, 16, v103
    v_and_b32 v114, s59, v101
    v_and_b32 v115, s59, v103
    v_lshlrev_b32 v116, 16, v104
    v_lshlrev_b32 v117, 16, v106
    v_and_b32 v118, s59, v104
    v_and_b32 v119, s59, v106
    v_lshlrev_b32 v120, 16, v105
    v_lshlrev_b32 v121, 16, v107
    v_and_b32 v122, s59, v105
    v_and_b32 v123, s59, v107
    s_waitcnt lgkmcnt(0)
    v_lshlrev_b32 v160, 16, v62
    v_and_b32 v161, s59, v62
    v_lshlrev_b32 v162, 16, v63
    v_and_b32 v163, s59, v63
    v_lshlrev_b32 v164, 16, v64
    v_and_b32 v165, s59, v64
    v_lshlrev_b32 v166, 16, v65
    v_and_b32 v167, s59, v65
    v_lshlrev_b32 v168, 16, v66
    v_and_b32 v169, s59, v66
    v_lshlrev_b32 v170, 16, v67
    v_and_b32 v171, s59, v67
    v_lshlrev_b32 v172, 16, v68
    v_and_b32 v173, s59, v68
    v_lshlrev_b32 v174, 16, v69
    v_and_b32 v175, s59, v69
    v_lshlrev_b32 v176, 16, v70
    v_and_b32 v177, s59, v70
    v_lshlrev_b32 v178, 16, v71
    v_and_b32 v179, s59, v71
    v_lshlrev_b32 v180, 16, v72
    v_and_b32 v181, s59, v72
    v_lshlrev_b32 v182, 16, v73
    v_and_b32 v183, s59, v73
    v_lshlrev_b32 v184, 16, v74
    v_and_b32 v185, s59, v74
    v_lshlrev_b32 v186, 16, v75
    v_and_b32 v187, s59, v75
    v_lshlrev_b32 v188, 16, v76
    v_and_b32 v189, s59, v76
    v_lshlrev_b32 v190, 16, v77
    v_and_b32 v191, s59, v77
    v_lshlrev_b32 v192, 16, v78
    v_and_b32 v193, s59, v78
    v_lshlrev_b32 v194, 16, v79
    v_and_b32 v195, s59, v79
    v_lshlrev_b32 v196, 16, v80
    v_and_b32 v197, s59, v80
    v_lshlrev_b32 v198, 16, v81
    v_and_b32 v199, s59, v81
    v_lshlrev_b32 v200, 16, v82
    v_and_b32 v201, s59, v82
    v_lshlrev_b32 v202, 16, v83
    v_and_b32_e64 v203, s59, v83
    v_pk_mul_f32 v[208:209], v[172:173], v[108:109]
    v_pk_mul_f32 v[210:211], v[174:175], v[116:117]
    v_pk_mul_f32 v[212:213], v[176:177], v[108:109]
    v_pk_mul_f32 v[214:215], v[178:179], v[116:117]
    v_pk_mul_f32 v[216:217], v[180:181], v[108:109]
    v_pk_mul_f32 v[218:219], v[182:183], v[116:117]
    v_pk_mul_f32 v[220:221], v[184:185], v[108:109]
    v_pk_mul_f32 v[222:223], v[186:187], v[116:117]
    v_pk_mul_f32 v[224:225], v[188:189], v[108:109]
    v_pk_mul_f32 v[226:227], v[190:191], v[116:117]
    v_pk_mul_f32 v[228:229], v[192:193], v[108:109]
    v_pk_mul_f32 v[230:231], v[194:195], v[116:117]
    v_pk_mul_f32 v[232:233], v[196:197], v[108:109]
    v_pk_mul_f32 v[234:235], v[198:199], v[116:117]
    v_pk_mul_f32 v[236:237], v[200:201], v[108:109]
    v_pk_mul_f32 v[238:239], v[202:203], v[116:117]
    v_pk_fma_f32 v[208:209], v[168:169], v[110:111], v[208:209]
    v_pk_fma_f32 v[210:211], v[170:171], v[118:119], v[210:211]
    v_pk_fma_f32 v[212:213], v[172:173], v[110:111], v[212:213]
    v_pk_fma_f32 v[214:215], v[174:175], v[118:119], v[214:215]
    v_pk_fma_f32 v[216:217], v[176:177], v[110:111], v[216:217]
    v_pk_fma_f32 v[218:219], v[178:179], v[118:119], v[218:219]
    v_pk_fma_f32 v[220:221], v[180:181], v[110:111], v[220:221]
    v_pk_fma_f32 v[222:223], v[182:183], v[118:119], v[222:223]
    v_pk_fma_f32 v[224:225], v[184:185], v[110:111], v[224:225]
    v_pk_fma_f32 v[226:227], v[186:187], v[118:119], v[226:227]
    v_pk_fma_f32 v[228:229], v[188:189], v[110:111], v[228:229]
    v_pk_fma_f32 v[230:231], v[190:191], v[118:119], v[230:231]
    v_pk_fma_f32 v[232:233], v[192:193], v[110:111], v[232:233]
    v_pk_fma_f32 v[234:235], v[194:195], v[118:119], v[234:235]
    v_pk_fma_f32 v[236:237], v[196:197], v[110:111], v[236:237]
    v_pk_fma_f32 v[238:239], v[198:199], v[118:119], v[238:239]
    v_pk_fma_f32 v[208:209], v[164:165], v[112:113], v[208:209]
    v_pk_fma_f32 v[210:211], v[166:167], v[120:121], v[210:211]
    v_pk_fma_f32 v[212:213], v[168:169], v[112:113], v[212:213]
    v_pk_fma_f32 v[214:215], v[170:171], v[120:121], v[214:215]
    v_pk_fma_f32 v[216:217], v[172:173], v[112:113], v[216:217]
    v_pk_fma_f32 v[218:219], v[174:175], v[120:121], v[218:219]
    v_pk_fma_f32 v[220:221], v[176:177], v[112:113], v[220:221]
    v_pk_fma_f32 v[222:223], v[178:179], v[120:121], v[222:223]
    v_pk_fma_f32 v[224:225], v[180:181], v[112:113], v[224:225]
    v_pk_fma_f32 v[226:227], v[182:183], v[120:121], v[226:227]
    v_pk_fma_f32 v[228:229], v[184:185], v[112:113], v[228:229]
    v_pk_fma_f32 v[230:231], v[186:187], v[120:121], v[230:231]
    v_pk_fma_f32 v[232:233], v[188:189], v[112:113], v[232:233]
    v_pk_fma_f32 v[234:235], v[190:191], v[120:121], v[234:235]
    v_pk_fma_f32 v[236:237], v[192:193], v[112:113], v[236:237]
    v_pk_fma_f32 v[238:239], v[194:195], v[120:121], v[238:239]
    v_pk_fma_f32 v[208:209], v[160:161], v[114:115], v[208:209]
    v_pk_fma_f32 v[210:211], v[162:163], v[122:123], v[210:211]
    v_pk_fma_f32 v[212:213], v[164:165], v[114:115], v[212:213]
    v_pk_fma_f32 v[214:215], v[166:167], v[122:123], v[214:215]
    s_waitcnt vmcnt(8)
    s_nop 0
    ds_read_b64 v[84:85], v151 offset:5440
    ds_read_b64 v[86:87], v151 offset:5568
    ds_read_b64 v[88:89], v151 offset:5696
    ds_read_b64 v[90:91], v151 offset:5824
    ds_read_b64 v[92:93], v151 offset:5952
    ds_read_b64 v[94:95], v151 offset:6080
    ds_read_b64 v[96:97], v151 offset:6208
    ds_read_b64 v[98:99], v151 offset:6336
    v_pk_fma_f32 v[216:217], v[168:169], v[114:115], v[216:217]
    v_pk_fma_f32 v[218:219], v[170:171], v[122:123], v[218:219]
    v_pk_fma_f32 v[220:221], v[172:173], v[114:115], v[220:221]
    v_pk_fma_f32 v[222:223], v[174:175], v[122:123], v[222:223]
    v_pk_fma_f32 v[224:225], v[176:177], v[114:115], v[224:225]
    v_pk_fma_f32 v[226:227], v[178:179], v[122:123], v[226:227]
    v_pk_fma_f32 v[228:229], v[180:181], v[114:115], v[228:229]
    v_pk_fma_f32 v[230:231], v[182:183], v[122:123], v[230:231]
    v_pk_fma_f32 v[232:233], v[184:185], v[114:115], v[232:233]
    v_pk_fma_f32 v[234:235], v[186:187], v[122:123], v[234:235]
    v_pk_fma_f32 v[236:237], v[188:189], v[114:115], v[236:237]
    v_pk_fma_f32 v[238:239], v[190:191], v[122:123], v[238:239]
    s_waitcnt lgkmcnt(4)
    v_lshlrev_b32 v160, 16, v84
    v_and_b32 v161, s59, v84
    v_lshlrev_b32 v164, 16, v86
    v_and_b32 v165, s59, v86
    v_lshlrev_b32 v168, 16, v88
    v_and_b32 v169, s59, v88
    v_lshlrev_b32 v172, 16, v90
    v_and_b32 v173, s59, v90
    s_waitcnt lgkmcnt(0)
    v_lshlrev_b32 v176, 16, v92
    v_and_b32 v177, s59, v92
    v_lshlrev_b32 v180, 16, v94
    v_and_b32 v181, s59, v94
    v_lshlrev_b32 v184, 16, v96
    v_and_b32 v185, s59, v96
    v_lshlrev_b32 v188, 16, v98
    v_and_b32 v189, s59, v98
    v_pk_mul_f32 v[208:209], v[208:209], v[160:161]
    v_pk_mul_f32 v[212:213], v[212:213], v[164:165]
    v_pk_mul_f32 v[216:217], v[216:217], v[168:169]
    v_pk_mul_f32 v[220:221], v[220:221], v[172:173]
    v_pk_mul_f32 v[224:225], v[224:225], v[176:177]
    v_pk_mul_f32 v[228:229], v[228:229], v[180:181]
    v_pk_mul_f32 v[232:233], v[232:233], v[184:185]
    v_pk_mul_f32 v[236:237], v[236:237], v[188:189]
    v_cvt_pk_bf16_f32 v62, v236, v232
    v_cvt_pk_bf16_f32 v63, v228, v224
    v_cvt_pk_bf16_f32 v64, v220, v216
    v_cvt_pk_bf16_f32 v65, v212, v208
    s_add_u32 s55, s30, 1048576
    buffer_store_dwordx4 v[62:65], v152, s[40:43], s55 offen sc1
    v_cvt_pk_bf16_f32 v66, v237, v233
    v_cvt_pk_bf16_f32 v67, v229, v225
    v_cvt_pk_bf16_f32 v68, v221, v217
    v_cvt_pk_bf16_f32 v69, v213, v209
    s_add_u32 s55, s30, 1052800
    buffer_store_dwordx4 v[66:69], v152, s[40:43], s55 offen sc1
    v_lshlrev_b32 v162, 16, v85
    v_and_b32 v163, s59, v85
    v_lshlrev_b32 v166, 16, v87
    v_and_b32 v167, s59, v87
    v_lshlrev_b32 v170, 16, v89
    v_and_b32 v171, s59, v89
    v_lshlrev_b32 v174, 16, v91
    v_and_b32 v175, s59, v91
    v_lshlrev_b32 v178, 16, v93
    v_and_b32 v179, s59, v93
    v_lshlrev_b32 v182, 16, v95
    v_and_b32 v183, s59, v95
    v_lshlrev_b32 v186, 16, v97
    v_and_b32 v187, s59, v97
    v_lshlrev_b32 v190, 16, v99
    v_and_b32 v191, s59, v99
    v_pk_mul_f32 v[210:211], v[210:211], v[162:163]
    v_pk_mul_f32 v[214:215], v[214:215], v[166:167]
    v_pk_mul_f32 v[218:219], v[218:219], v[170:171]
    v_pk_mul_f32 v[222:223], v[222:223], v[174:175]
    v_pk_mul_f32 v[226:227], v[226:227], v[178:179]
    v_pk_mul_f32 v[230:231], v[230:231], v[182:183]
    v_pk_mul_f32 v[234:235], v[234:235], v[186:187]
    v_pk_mul_f32 v[238:239], v[238:239], v[190:191]
    v_cvt_pk_bf16_f32 v70, v238, v234
    v_cvt_pk_bf16_f32 v71, v230, v226
    v_cvt_pk_bf16_f32 v72, v222, v218
    v_cvt_pk_bf16_f32 v73, v214, v210
    s_add_u32 s55, s30, 1057024
    buffer_store_dwordx4 v[70:73], v152, s[40:43], s55 offen sc1
    v_cvt_pk_bf16_f32 v74, v239, v235
    v_cvt_pk_bf16_f32 v75, v231, v227
    v_cvt_pk_bf16_f32 v76, v223, v219
    v_cvt_pk_bf16_f32 v77, v215, v211
    s_add_u32 s55, s30, 1061248
    buffer_store_dwordx4 v[74:77], v152, s[40:43], s55 offen sc1
    s_add_u32 s64, s68, s65
    buffer_load_dword v14, v150, s[24:27], s64 offen
    s_bfm_b64 exec, 38, 0
    ds_write_b128 v159, v[154:157]
    s_mov_b64 exec, -1
    s_add_u32 s44, s44, 0x7f4a7c15
    s_addc_u32 s45, s45, 0x9e3779b9
    v_mov_b32 v10, s44
    v_mov_b32 v11, s45
    v_and_b32 v60, 3, v1
    v_lshlrev_b32_e64 v28, 7, v60
    v_lshl_add_u32 v59, v60, 3, v59
    v_add_u32 v59, 81920, v59
    v_cmp_eq_u32 s[48:49], 1, v60
    v_cmp_eq_u32 s[50:51], 2, v60
    v_cmp_eq_u32 s[52:53], 3, v60
    v_lshrrev_b32 v58, 1, v58
    v_and_b32 v60, 1, v8
    v_lshl_or_b32 v58, v60, 1, v58
    s_add_u32 s71, s56, 0
    s_and_b32 s71, s71, 3
    v_xor_b32 v60, s71, v58
    v_lshl_add_u32 v16, v60, 5, v59
    s_add_u32 s71, s56, 1
    s_and_b32 s71, s71, 3
    v_xor_b32 v60, s71, v58
    v_lshl_add_u32 v17, v60, 5, v59
    s_add_u32 s71, s56, 2
    s_and_b32 s71, s71, 3
    v_xor_b32 v60, s71, v58
    v_lshl_add_u32 v18, v60, 5, v59
    s_add_u32 s71, s56, 3
    s_and_b32 s71, s71, 3
    v_xor_b32 v60, s71, v58
    v_lshl_add_u32 v19, v60, 5, v59
    v_mov_b32 v40, 0x3f803f80
    v_mov_b32 v41, 0x3f803f80
    v_mov_b32 v42, 0x3f803f80
    v_mov_b32 v43, 0x3f803f80
    s_lshl2_add_u32 s85, s61, s56
    s_lshl_b32 s85, s85, 10
    s_add_u32 s85, s85, 204800
    s_lshl_b32 s71, s63, 8
    s_and_b32 s72, s62, 3
    s_cselect_b32 s71, 0x80000000, s71
    v_lshrrev_b32 v58, 2, v7
    v_cmp_eq_u32 vcc, v58, v8
    v_lshl_add_u32 v26, v7, 4, s71
    s_lshl_b32 s72, s56, 10
    s_add_u32 s72, s72, 81920
    v_cndmask_b32 v26, v5, v26, vcc
    v_lshl_add_u32 v24, v7, 4, s72
    v_sub_u32 v58, s56, v8
    v_and_b32 v58, 3, v58
    v_lshl_add_u32 v58, v8, 2, v58
    v_lshl_add_u32 v58, v58, 4, v7
    v_lshlrev_b32 v58, 4, v58
    v_add_u32 v23, 81920, v58
    v_lshrrev_b32 v60, 1, v8
    v_lshl_add_u32 v25, v60, 8, v24
    s_mov_b32 s72, 49152
    v_lshlrev_b32 v59, 4, v7
    v_and_b32 v58, 1, v8
    v_add3_u32 v20, v58, s56, 0
    v_and_b32 v20, 3, v20
    v_mad_u32_u24 v20, v20, s72, v59
    v_lshl_add_u32 v20, v60, 8, v20
    v_add3_u32 v21, v58, s56, 2
    v_and_b32 v21, 3, v21
    v_mad_u32_u24 v21, v21, s72, v59
    v_lshl_add_u32 v21, v60, 8, v21
    v_lshl_or_b32 v22, v58, 1, v60
    v_add_u32 v22, s56, v22
    v_and_b32 v22, 3, v22
    v_mad_u32_u24 v22, v22, s72, v59
    s_mul_i32 s71, s56, 5600
    v_mul_u32_u24 v33, 560, v60
    v_lshl_add_u32 v33, v58, 8, v33
    v_add3_u32 v33, v33, v59, s71
    s_and_b32 s75, s57, 1
    s_lshl_b32 s75, s75, 2
    s_bfe_u32 s71, s57, 0x20001
    s_add_u32 s75, s75, s71
    s_lshl_b32 s75, s75, 1
    s_and_b32 s71, s58, 1
    s_add_u32 s75, s75, s71
    s_bfe_u32 s76, s58, 0x10001
    s_lshr_b32 s77, s57, 3
    s_mul_i32 s77, s77, 8
    s_lshr_b32 s71, s58, 2
    s_add_u32 s77, s77, s71
    s_lshl2_add_u32 s71, s77, s56
    s_mul_i32 s89, s71, 61440
    s_add_u32 s89, s89, 13107200
    s_and_b32 s71, s58, 3
    s_mul_i32 s71, s71, 3840
    s_add_u32 s96, s89, s71
    s_lshr_b32 s71, s58, 2
    s_mul_i32 s71, s71, 1536
    v_and_b32 v58, 31, v1
    v_min_u32 v58, 11, v58
    v_lshl_add_u32 v58, v58, 7, s71
    v_lshrrev_b32 v59, 5, v1
    v_mul_u32_u24 v59, 49152, v59
    v_add_u32_e64 v38, v58, v59
    s_lshl_b32 s71, s56, 3
    s_lshr_b32 s72, s77, 2
    s_add_u32 s71, s71, s72
    s_add_u32 s71, s71, 1200
    s_add_u32 s72, s62, 1296
    v_cmp_gt_u32 vcc, 4, v1
    v_lshl_add_u32 v29, v1, 1, s71
    v_mov_b32 v58, s72
    v_cndmask_b32 v29, v58, v29, vcc
    v_lshlrev_b32_e64 v29, 7, v29
    s_lshl2_add_u32 s94, s75, s56
    s_lshl_b32 s94, s94, 9
    s_add_u32 s94, s94, 61440
    s_lshl1_add_u32 s90, s75, s76
    s_mul_i32 s90, s90, 98304
    s_mul_i32 s71, s56, 12288
    s_add_u32 s90, s90, s71
    s_add_u32 s90, s90, 15073280
    s_lshr_b32 s71, s56, 1
    s_and_b32 s72, s56, 1
    v_lshrrev_b32 v58, 5, v1
    v_xor_b32 v58, s76, v58
    v_lshrrev_b32 v59, 2, v1
    v_lshl_add_u32 v58, v59, 1, v58
    v_and_b32_e64 v60, 3, v1
    v_lshl_add_u32 v58, v58, 2, v60
    v_lshlrev_b32 v31, 4, v58
    s_lshl4_add_u32 s92, s71, s75
    s_mul_i32 s92, s92, 81920
    s_mul_i32 s73, s77, 10240
    s_add_u32 s92, s92, s73
    s_mul_i32 s73, s72, 6144
    s_add_u32 s92, s92, s73
    s_add_u32 s92, s92, 6553600
    s_mul_i32 s93, s56, 3072
    s_add_u32 s93, s93, 98304
    s_mul_i32 s73, s71, 6144
    s_add_u32 s73, s73, 98304
    v_bfe_u32 v58, v1, 3, 1
    v_xor_b32 v58, s72, v58
    v_lshl_add_u32 v58, v59, 1, v58
    v_lshl_add_u32 v58, v58, 2, v60
    v_lshl_add_u32 v32, v58, 3, s73
    s_lshl2_add_u32 s91, s75, s71
    s_lshl1_add_u32 s91, s91, s76
    s_lshl1_add_u32 s91, s91, s72
    s_mul_i32 s91, s91, 5120
    s_mul_i32 s71, s77, 160
    s_add_u32 s91, s91, s71
    s_lshl_b32 s71, s56, 6
    s_movk_i32 s72, 1280
    v_min_u32 v58, 39, v1
    v_mul_u32_u24 v59, 6554, v58
    v_lshrrev_b32 v59, 16, v59
    v_mul_u32_u24 v60, 10, v59
    v_sub_u32_e64 v58, v58, v60
    v_mul_u32_u24 v34, 560, v58
    v_lshl_add_u32 v34, v59, 4, v34
    v_add_u32 v34, s71, v34
    v_cmp_gt_u32 vcc, 40, v1
    v_lshlrev_b32_e64 v58, 4, v58
    v_mad_u32_u24 v35, v59, s72, v58
    v_cndmask_b32 v35, v5, v35, vcc
    s_waitcnt vmcnt(11)
    v_alignbit_b32 v160, v124, v141, 16
    v_alignbit_b32 v161, v125, v124, 16
    v_alignbit_b32 v162, v126, v125, 16
    v_alignbit_b32 v163, v127, v126, 16
    v_mov_b32 v164, v141
    v_mov_b32 v165, v124
    v_mov_b32 v166, v125
    v_mov_b32 v167, v126
    v_alignbit_b32 v168, v141, v140, 16
    v_alignbit_b32 v169, v124, v141, 16
    v_alignbit_b32 v170, v125, v124, 16
    v_alignbit_b32 v171, v126, v125, 16
    ds_write_b128 v158, v[124:127] offset:32
    ds_write_b128 v158, v[160:163] offset:4192
    ds_write_b128 v158, v[164:167] offset:8352
    ds_write_b128 v158, v[168:171] offset:12512
    s_waitcnt vmcnt(9)
    v_alignbit_b32 v172, v128, v143, 16
    v_alignbit_b32 v173, v129, v128, 16
    v_alignbit_b32 v174, v130, v129, 16
    v_alignbit_b32 v175, v131, v130, 16
    v_mov_b32 v176, v143
    v_mov_b32 v177, v128
    v_mov_b32 v178, v129
    v_mov_b32_e64 v179, v130
    v_alignbit_b32 v180, v143, v142, 16
    v_alignbit_b32 v181, v128, v143, 16
    v_alignbit_b32 v182, v129, v128, 16
    v_alignbit_b32 v183, v130, v129, 16
    ds_write_b128 v158, v[128:131] offset:1056
    ds_write_b128 v158, v[172:175] offset:5216
    ds_write_b128 v158, v[176:179] offset:9376
    ds_write_b128 v158, v[180:183] offset:13536
    s_waitcnt vmcnt(1)
    s_barrier
    buffer_store_dwordx2 v[10:11], v4, s[40:43], s23 offen sc1
    s_bitcmp1_b32 s29, 0
    s_cselect_b32 s77, 0, 16
    s_lshl_b32 s20, s20, s77
    s_and_b32 s20, s20, s59
    s_mov_b32 s21, s20
    s_mul_i32 s77, s29, 4224
    s_add_u32 s77, s77, 1048576
    s_lshl_b32 s55, s56, 11
    s_mul_i32 s30, s22, 16512
    s_add_u32 s30, s30, s55
    v_alignbit_b32 v184, v132, v145, 16
    s_add_u32 m0, s95, 84864
    s_nop 0
    buffer_load_dwordx4 v51, s[24:27], s67 offen lds
    v_alignbit_b32 v185, v133, v132, 16
    s_add_u32 m0, s95, 85888
    v_alignbit_b32 v186, v134, v133, 16
    buffer_load_dwordx4 v52, s[24:27], s67 offen lds
    v_alignbit_b32 v187, v135, v134, 16
    s_add_u32 m0, s95, 86912
    s_nop 0
    buffer_load_dwordx4 v53, s[24:27], s67 offen lds
    v_mov_b32 v188, v145
    s_add_u32 m0, s95, 97216
    v_mov_b32 v189, v132
    s_add_u32 s64, s67, 98304
    v_mov_b32 v190, v133
    buffer_load_dwordx4 v51, s[24:27], s64 offen lds
    s_add_u32 m0, s95, 98240
    v_mov_b32_e64 v191, v134
    buffer_load_dwordx4 v52, s[24:27], s64 offen lds
    v_alignbit_b32 v192, v145, v144, 16
    s_add_u32 m0, s95, 99264
    v_alignbit_b32 v193, v132, v145, 16
    buffer_load_dwordx4 v53, s[24:27], s64 offen lds
    s_add_u32 m0, s95, 109568
    v_alignbit_b32 v194, v133, v132, 16
    s_add_u32 s64, s67, 196608
    v_alignbit_b32 v195, v134, v133, 16
    buffer_load_dwordx4 v51, s[24:27], s64 offen lds
    ds_write_b128 v158, v[132:135] offset:2080
    s_add_u32 m0, s95, 110592
    ds_write_b128 v158, v[184:187] offset:6240
    ds_write_b128 v158, v[188:191] offset:10400
    ds_write_b128 v158, v[192:195] offset:14560
    buffer_load_dwordx4 v52, s[24:27], s64 offen lds
    v_alignbit_b32 v196, v136, v147, 16
    s_add_u32 m0, s95, 111616
    v_alignbit_b32 v197, v137, v136, 16
    buffer_load_dwordx4 v53, s[24:27], s64 offen lds
    v_alignbit_b32 v198, v138, v137, 16
    s_add_u32 m0, s95, 121920
    v_alignbit_b32 v199, v139, v138, 16
    s_add_u32 s64, s67, 294912
    buffer_load_dwordx4 v51, s[24:27], s64 offen lds
    v_mov_b32 v200, v147
    s_add_u32 m0, s95, 122944
    v_mov_b32 v201, v136
    buffer_load_dwordx4 v52, s[24:27], s64 offen lds
    v_mov_b32 v202, v137
    s_add_u32 m0, s95, 123968
    s_nop 0
    buffer_load_dwordx4 v53, s[24:27], s64 offen lds
    v_mov_b32_e64 v203, v138
    s_add_u32 m0, s95, 134272
    v_alignbit_b32 v204, v147, v146, 16
    s_add_u32 s64, s67, 393216
    v_alignbit_b32 v205, v136, v147, 16
    buffer_load_dwordx4 v51, s[24:27], s64 offen lds
    s_add_u32 m0, s95, 135296
    v_alignbit_b32 v206, v137, v136, 16
    buffer_load_dwordx4 v52, s[24:27], s64 offen lds
    v_alignbit_b32 v207, v138, v137, 16
    s_add_u32 m0, s95, 136320
    ds_write_b128 v158, v[136:139] offset:3104
    buffer_load_dwordx4 v53, s[24:27], s64 offen lds
    ds_write_b128 v158, v[196:199] offset:7264
    ds_write_b128 v158, v[200:203] offset:11424
    ds_write_b128 v158, v[204:207] offset:15584
    buffer_load_dwordx2 v[12:13], v9, s[40:43], 0 offen sc1
    s_mul_i32 s74, s56, 4576
    s_add_u32 m0, s74, 480
    s_mov_b32 s76, 137216
    s_mov_b32 s78, 145408
    s_lshl_b32 s75, s56, 4
    s_waitcnt vmcnt(0)
    v_cmp_ne_u64 vcc, v[10:11], v[12:13]
    s_cbranch_vccnz L_spin3
L_ok2:
    buffer_load_dwordx4 v2, s[40:43], s77 offen offset:0 sc1 lds
    buffer_load_dwordx4 v2, s[40:43], s77 offen offset:1024 sc1 lds
    buffer_load_dwordx4 v2, s[40:43], s77 offen offset:2048 sc1 lds
    buffer_load_dwordx4 v2, s[40:43], s77 offen offset:3072 sc1 lds
    v_add_lshl_u32 v9, v7, s75, 7
    buffer_load_dwordx2 v[12:13], v9, s[40:43], s76 offen sc1
    s_barrier
    ds_read_b64_tr_b16 a[0:1], v54 offset:0
    ds_read_b64_tr_b16 a[2:3], v54 offset:768
    s_nop 0
    ds_read_b64_tr_b16 a[4:5], v54 offset:3088
    ds_read_b64_tr_b16 a[6:7], v54 offset:3856
    ds_read_b64_tr_b16 a[8:9], v55 offset:0
    ds_read_b64_tr_b16 a[10:11], v55 offset:768
    ds_read_b64_tr_b16 a[12:13], v54 offset:12352
    ds_read_b64_tr_b16 a[14:15], v54 offset:13120
    ds_read_b64_tr_b16 a[16:17], v54 offset:15440
    ds_read_b64_tr_b16 a[18:19], v54 offset:16208
    ds_read_b64_tr_b16 a[20:21], v55 offset:12352
    ds_read_b64_tr_b16 a[22:23], v55 offset:13120
    ds_read_b64_tr_b16 a[24:25], v54 offset:24704
    ds_read_b64_tr_b16 a[26:27], v54 offset:25472
    ds_read_b64_tr_b16 a[28:29], v54 offset:27792
    ds_read_b64_tr_b16 a[30:31], v54 offset:28560
    ds_read_b64_tr_b16 a[32:33], v55 offset:24704
    ds_read_b64_tr_b16 a[34:35], v55 offset:25472
    ds_read_b64_tr_b16 a[36:37], v54 offset:37056
    ds_read_b64_tr_b16 a[38:39], v54 offset:37824
    ds_read_b64_tr_b16 a[40:41], v54 offset:40144
    ds_read_b64_tr_b16 a[42:43], v54 offset:40912
    ds_read_b64_tr_b16 a[44:45], v55 offset:37056
    ds_read_b64_tr_b16 a[46:47], v55 offset:37824
    ds_read_b64_tr_b16 a[48:49], v54 offset:49408
    ds_read_b64_tr_b16 a[50:51], v54 offset:50176
    ds_read_b64_tr_b16 a[52:53], v54 offset:52496
    ds_read_b64_tr_b16 a[54:55], v54 offset:53264
    ds_read_b64_tr_b16 a[56:57], v55 offset:49408
    ds_read_b64_tr_b16 a[58:59], v55 offset:50176
    s_waitcnt lgkmcnt(0)
    s_barrier
    s_add_u32 m0, s95, 84864
    s_nop 0
    buffer_load_dwordx4 v51, s[24:27], s68 offen lds
    s_add_u32 m0, s95, 85888
    s_nop 0
    buffer_load_dwordx4 v52, s[24:27], s68 offen lds
    s_add_u32 m0, s95, 86912
    s_nop 0
    s_nop 0
    buffer_load_dwordx4 v53, s[24:27], s68 offen lds
    s_add_u32 m0, s95, 97216
    s_add_u32 s64, s68, 98304
    buffer_load_dwordx4 v51, s[24:27], s64 offen lds
    s_add_u32 m0, s95, 98240
    s_nop 0
    buffer_load_dwordx4 v52, s[24:27], s64 offen lds
    s_add_u32 m0, s95, 99264
    s_nop 0
    buffer_load_dwordx4 v53, s[24:27], s64 offen lds
    s_waitcnt vmcnt(9)
    ds_read_b64 v[88:89], v44 offset:0
    ds_read_b64 v[90:91], v44 offset:8
    s_nop 0
    ds_read_b128 v[92:95], v45 offset:448
    ds_read_b128 v[100:103], v45 offset:960
    ds_read_b64 v[96:97], v44 offset:512
    ds_read_b64 v[98:99], v44 offset:520
    ds_read_b128 v[108:111], v45 offset:1472
    ds_read_b64 v[104:105], v44 offset:1024
    ds_read_b64 v[106:107], v44 offset:1032
    ds_read_b128 v[116:119], v45 offset:1984
    ds_read_b64 v[112:113], v44 offset:1536
    ds_read_b64 v[114:115], v44 offset:1544
    s_waitcnt lgkmcnt(6)
    v_mfma_f32_16x16x32_bf16 v[56:59], v[88:91], v[92:95], 0
    s_waitcnt vmcnt(6)
    ds_read_b64 v[152:153], v44 offset:64
    ds_read_b64 v[154:155], v44 offset:72
    v_mfma_f32_16x16x32_bf16 v[60:63], v[88:91], v[100:103], 0
    ds_read_b128 v[156:159], v45 offset:384
    v_cmp_ne_u64 vcc, v[10:11], v[12:13]
    v_mfma_f32_16x16x32_bf16 v[60:63], v[96:99], v[92:95], v[60:63]
    s_waitcnt lgkmcnt(6)
    ds_read_b128 v[164:167], v45 offset:896
    v_mfma_f32_16x16x32_bf16 v[64:67], v[88:91], v[108:111], 0
    ds_read_b64 v[160:161], v44 offset:576
    v_mfma_f32_16x16x32_bf16 v[64:67], v[96:99], v[100:103], v[64:67]
    ds_read_b64 v[162:163], v44 offset:584
    v_mfma_f32_16x16x32_bf16 v[64:67], v[104:107], v[92:95], v[64:67]
    s_waitcnt lgkmcnt(6)
    ds_read_b128 v[172:175], v45 offset:1408
    v_mfma_f32_16x16x32_bf16 v[68:71], v[88:91], v[116:119], 0
    ds_read_b64 v[168:169], v44 offset:1088
    v_mfma_f32_16x16x32_bf16 v[68:71], v[96:99], v[108:111], v[68:71]
    ds_read_b64 v[170:171], v44 offset:1096
    ds_read_b128 v[180:183], v45 offset:1920
    v_mfma_f32_16x16x32_bf16 v[68:71], v[104:107], v[100:103], v[68:71]
    s_cbranch_vccnz L_spin10
L_ok9:
    v_mfma_f32_16x16x32_bf16 v[68:71], v[112:115], v[92:95], v[68:71]
    s_waitcnt lgkmcnt(4)
    ds_read_b64 v[176:177], v44 offset:1600
    s_add_u32 m0, s55, 147456
    v_mfma_f32_16x16x32_bf16 v[56:59], v[152:155], v[156:159], v[56:59]
    s_add_u32 s75, s30, 3801088
    ds_read_b64 v[88:89], v44 offset:128
    ds_read_b64 v[178:179], v44 offset:1608
    v_mfma_f32_16x16x32_bf16 v[60:63], v[152:155], v[164:167], v[60:63]
L_pg1:
    s_cbranch_execz L_pg5
    buffer_load_dwordx4 v2, s[40:43], s75 offen offset:0 sc1 lds
    v_mfma_f32_16x16x32_bf16 v[60:63], v[160:163], v[156:159], v[60:63]
    s_waitcnt lgkmcnt(4)
    ds_read_b64 v[90:91], v44 offset:136
    ds_read_b128 v[92:95], v45 offset:320
    v_mfma_f32_16x16x32_bf16 v[64:67], v[152:155], v[172:175], v[64:67]
    ds_read_b128 v[100:103], v45 offset:832
    ds_read_b64 v[96:97], v44 offset:640
    v_mfma_f32_16x16x32_bf16 v[64:67], v[160:163], v[164:167], v[64:67]
    ds_read_b64 v[98:99], v44 offset:648
    v_mfma_f32_16x16x32_bf16 v[64:67], v[168:171], v[156:159], v[64:67]
    s_waitcnt lgkmcnt(5)
    buffer_load_dwordx4 v2, s[40:43], s75 offen offset:1024 sc1 lds
    v_mfma_f32_16x16x32_bf16 v[68:71], v[152:155], v[180:183], v[68:71]
    s_add_u32 m0, s55, 155648
    ds_read_b128 v[108:111], v45 offset:1344
    ds_read_b64 v[104:105], v44 offset:1152
    v_mfma_f32_16x16x32_bf16 v[68:71], v[160:163], v[172:175], v[68:71]
    s_add_u32 s75, s55, 172032
    ds_read_b64 v[106:107], v44 offset:1160
    ds_read_b128 v[116:119], v45 offset:1856
    v_mfma_f32_16x16x32_bf16 v[68:71], v[168:171], v[164:167], v[68:71]
    ds_read_b64 v[112:113], v44 offset:1664
    v_mfma_f32_16x16x32_bf16 v[68:71], v[176:179], v[156:159], v[68:71]
    s_waitcnt lgkmcnt(5)
    buffer_load_dwordx4 v2, s[40:43], s75 offen offset:0 sc1 lds
    v_mfma_f32_16x16x32_bf16 v[56:59], v[88:91], v[92:95], v[56:59]
    ds_read_b64 v[152:153], v44 offset:192
    ds_read_b64 v[114:115], v44 offset:1672
    v_mfma_f32_16x16x32_bf16 v[60:63], v[88:91], v[100:103], v[60:63]
    ds_read_b64 v[154:155], v44 offset:200
    ds_read_b128 v[156:159], v45 offset:256
    v_mfma_f32_16x16x32_bf16 v[60:63], v[96:99], v[92:95], v[60:63]
    s_waitcnt lgkmcnt(6)
    ds_read_b128 v[164:167], v45 offset:768
    v_mfma_f32_16x16x32_bf16 v[64:67], v[88:91], v[108:111], v[64:67]
    ds_read_b64 v[160:161], v44 offset:704
    v_mfma_f32_16x16x32_bf16 v[64:67], v[96:99], v[100:103], v[64:67]
    ds_read_b64 v[162:163], v44 offset:712
    v_mfma_f32_16x16x32_bf16 v[64:67], v[104:107], v[92:95], v[64:67]
    s_waitcnt lgkmcnt(5)
    buffer_load_dwordx4 v2, s[40:43], s75 offen offset:1024 sc1 lds
    v_mfma_f32_16x16x32_bf16 v[68:71], v[88:91], v[116:119], v[68:71]
    s_add_u32 m0, s95, 109568
    ds_read_b128 v[172:175], v45 offset:1280
    ds_read_b64 v[168:169], v44 offset:1216
    v_mfma_f32_16x16x32_bf16 v[68:71], v[96:99], v[108:111], v[68:71]
    s_add_u32 s64, s68, 196608
    ds_read_b64 v[170:171], v44 offset:1224
    ds_read_b128 v[180:183], v45 offset:1792
    v_mfma_f32_16x16x32_bf16 v[68:71], v[104:107], v[100:103], v[68:71]
    ds_read_b64 v[176:177], v44 offset:1728
    v_mfma_f32_16x16x32_bf16 v[68:71], v[112:115], v[92:95], v[68:71]
    s_waitcnt lgkmcnt(5)
    buffer_load_dwordx4 v51, s[24:27], s64 offen lds
    v_mfma_f32_16x16x32_bf16 v[56:59], v[152:155], v[156:159], v[56:59]
    s_add_u32 m0, s95, 110592
    ds_read_b64 v[88:89], v44 offset:256
    ds_read_b64 v[178:179], v44 offset:1736
    v_mfma_f32_16x16x32_bf16 v[60:63], v[152:155], v[164:167], v[60:63]
    ds_read_b64 v[90:91], v44 offset:264
    ds_read_b128 v[92:95], v45 offset:192
    v_mfma_f32_16x16x32_bf16 v[60:63], v[160:163], v[156:159], v[60:63]
    s_waitcnt lgkmcnt(6)
    ds_read_b128 v[100:103], v45 offset:704
    v_mfma_f32_16x16x32_bf16 v[64:67], v[152:155], v[172:175], v[64:67]
    ds_read_b64 v[96:97], v44 offset:768
    v_mfma_f32_16x16x32_bf16 v[64:67], v[160:163], v[164:167], v[64:67]
    ds_read_b64 v[98:99], v44 offset:776
    v_mfma_f32_16x16x32_bf16 v[64:67], v[168:171], v[156:159], v[64:67]
    s_waitcnt lgkmcnt(5)
    buffer_load_dwordx4 v52, s[24:27], s64 offen lds
    v_mfma_f32_16x16x32_bf16 v[68:71], v[152:155], v[180:183], v[68:71]
    s_waitcnt vmcnt(9)
    ds_read_b128 v[108:111], v45 offset:1216
    s_barrier
    ds_read_b64 v[104:105], v44 offset:1280
    v_mfma_f32_16x16x32_bf16 v[68:71], v[160:163], v[172:175], v[68:71]
    s_add_u32 m0, s95, 111616
    ds_read_b64 v[106:107], v44 offset:1288
    ds_read_b128 v[116:119], v45 offset:1728
    v_mfma_f32_16x16x32_bf16 v[68:71], v[168:171], v[164:167], v[68:71]
    ds_read_b64_tr_b16 a[60:61], v54 offset:0
    v_mfma_f32_16x16x32_bf16 v[68:71], v[176:179], v[156:159], v[68:71]
    s_waitcnt lgkmcnt(5)
    ds_read_b64 v[112:113], v44 offset:1792
    v_mfma_f32_16x16x32_bf16 v[56:59], v[88:91], v[92:95], v[56:59]
    ds_read_b64 v[114:115], v44 offset:1800
    buffer_load_dwordx4 v53, s[24:27], s64 offen lds
    v_mfma_f32_16x16x32_bf16 v[60:63], v[88:91], v[100:103], v[60:63]
    s_add_u32 m0, s95, 121920
    ds_read_b64 v[152:153], v44 offset:320
    ds_read_b64_tr_b16 a[62:63], v54 offset:768
    v_mfma_f32_16x16x32_bf16 v[60:63], v[96:99], v[92:95], v[60:63]
    s_waitcnt lgkmcnt(6)
    ds_read_b64 v[154:155], v44 offset:328
    ds_read_b128 v[156:159], v45 offset:128
    s_add_u32 s64, s68, 294912
    buffer_load_dwordx4 v51, s[24:27], s64 offen lds
    v_mfma_f32_16x16x32_bf16 v[64:67], v[88:91], v[108:111], v[64:67]
    s_add_u32 m0, s95, 122944
    ds_read_b128 v[164:167], v45 offset:640
    ds_read_b64_tr_b16 a[64:65], v54 offset:3088
    ds_read_b64 v[160:161], v44 offset:832
    v_mfma_f32_16x16x32_bf16 v[64:67], v[96:99], v[100:103], v[64:67]
    ds_read_b64 v[162:163], v44 offset:840
    v_mfma_f32_16x16x32_bf16 v[64:67], v[104:107], v[92:95], v[64:67]
    s_waitcnt lgkmcnt(8)
    buffer_load_dwordx4 v52, s[24:27], s64 offen lds
    v_mfma_f32_16x16x32_bf16 v[68:71], v[88:91], v[116:119], v[68:71]
    s_add_u32 m0, s95, 123968
    ds_read_b128 v[172:175], v45 offset:1152
    ds_read_b64_tr_b16 a[66:67], v54 offset:3856
    ds_read_b64 v[168:169], v44 offset:1344
    v_mfma_f32_16x16x32_bf16 v[68:71], v[96:99], v[108:111], v[68:71]
    ds_read_b64 v[170:171], v44 offset:1352
    ds_read_b128 v[180:183], v45 offset:1664
    v_mfma_f32_16x16x32_bf16 v[68:71], v[104:107], v[100:103], v[68:71]
    buffer_load_dwordx4 v53, s[24:27], s64 offen lds
    v_mfma_f32_16x16x32_bf16 v[68:71], v[112:115], v[92:95], v[68:71]
    s_waitcnt lgkmcnt(5)
    ds_read_b64 v[176:177], v44 offset:1856
    ds_read_b64_tr_b16 a[68:69], v55 offset:0
    v_mfma_f32_16x16x32_bf16 v[56:59], v[152:155], v[156:159], v[56:59]
    s_add_u32 m0, s95, 134272
    ds_read_b64 v[88:89], v44 offset:384
    ds_read_b64 v[178:179], v44 offset:1864
    s_add_u32 s64, s68, 393216
    buffer_load_dwordx4 v51, s[24:27], s64 offen lds
    v_mfma_f32_16x16x32_bf16 v[60:63], v[152:155], v[164:167], v[60:63]
    s_add_u32 m0, s95, 135296
    ds_read_b64 v[90:91], v44 offset:392
    ds_read_b128 v[92:95], v45 offset:64
    v_mfma_f32_16x16x32_bf16 v[60:63], v[160:163], v[156:159], v[60:63]
    s_waitcnt lgkmcnt(7)
    ds_read_b64_tr_b16 a[70:71], v55 offset:768
    ds_read_b128 v[100:103], v45 offset:576
    v_mfma_f32_16x16x32_bf16 v[64:67], v[152:155], v[172:175], v[64:67]
    ds_read_b64 v[96:97], v44 offset:896
    buffer_load_dwordx4 v52, s[24:27], s64 offen lds
    v_mfma_f32_16x16x32_bf16 v[64:67], v[160:163], v[164:167], v[64:67]
    s_add_u32 m0, s95, 136320
    ds_read_b64 v[98:99], v44 offset:904
    v_mfma_f32_16x16x32_bf16 v[64:67], v[168:171], v[156:159], v[64:67]
    s_waitcnt lgkmcnt(6)
    ds_read_b128 v[108:111], v45 offset:1088
    v_mfma_f32_16x16x32_bf16 v[68:71], v[152:155], v[180:183], v[68:71]
    ds_read_b64 v[104:105], v44 offset:1408
    buffer_load_dwordx4 v53, s[24:27], s64 offen lds
    v_mfma_f32_16x16x32_bf16 v[68:71], v[160:163], v[172:175], v[68:71]
    ds_read_b64 v[106:107], v44 offset:1416
    ds_read_b128 v[116:119], v45 offset:1600
    v_mfma_f32_16x16x32_bf16 v[68:71], v[168:171], v[164:167], v[68:71]
    s_waitcnt vmcnt(13) lgkmcnt(7)
    s_barrier
    v_mfma_f32_16x16x32_bf16 v[68:71], v[176:179], v[156:159], v[68:71]
    s_waitcnt lgkmcnt(4)
    ds_read_b64 v[112:113], v44 offset:1920
    ds_read_b64_tr_b16 a[72:73], v54 offset:12352
    v_mfma_f32_16x16x32_bf16 v[56:59], v[88:91], v[92:95], v[56:59]
    s_add_u32 m0, s95, 84864
    ds_read_b64 v[152:153], v44 offset:448
    ds_read_b64 v[114:115], v44 offset:1928
    v_mfma_f32_16x16x32_bf16 v[60:63], v[88:91], v[100:103], v[60:63]
    buffer_load_dwordx4 v51, s[24:27], s69 offen lds
    v_mfma_f32_16x16x32_bf16 v[60:63], v[96:99], v[92:95], v[60:63]
    s_waitcnt lgkmcnt(5)
    ds_read_b64 v[154:155], v44 offset:456
    ds_read_b64_tr_b16 a[74:75], v54 offset:13120
    ds_read_b128 v[156:159], v45 offset:0
    v_mfma_f32_16x16x32_bf16 v[64:67], v[88:91], v[108:111], v[64:67]
    s_add_u32 m0, s95, 85888
    ds_read_b64_tr_b16 a[76:77], v54 offset:15440
    ds_read_b128 v[164:167], v45 offset:512
    ds_read_b64 v[160:161], v44 offset:960
    v_mfma_f32_16x16x32_bf16 v[64:67], v[96:99], v[100:103], v[64:67]
    ds_read_b64_tr_b16 a[78:79], v54 offset:16208
    ds_read_b64_tr_b16 a[80:81], v55 offset:12352
    ds_read_b64 v[162:163], v44 offset:968
    v_mfma_f32_16x16x32_bf16 v[64:67], v[104:107], v[92:95], v[64:67]
    s_waitcnt lgkmcnt(9)
    ds_read_b64_tr_b16 a[82:83], v55 offset:13120
    ds_read_b128 v[172:175], v45 offset:1024
    v_mfma_f32_16x16x32_bf16 v[68:71], v[88:91], v[116:119], v[68:71]
    ds_read_b64 v[168:169], v44 offset:1472
    buffer_load_dwordx4 v52, s[24:27], s69 offen lds
    v_mfma_f32_16x16x32_bf16 v[68:71], v[96:99], v[108:111], v[68:71]
    s_add_u32 m0, s95, 86912
    ds_read_b64 v[170:171], v44 offset:1480
    ds_read_b128 v[180:183], v45 offset:1536
    v_mfma_f32_16x16x32_bf16 v[68:71], v[104:107], v[100:103], v[68:71]
    ds_read_b64 v[176:177], v44 offset:1984
    v_mfma_f32_16x16x32_bf16 v[68:71], v[112:115], v[92:95], v[68:71]
    s_waitcnt lgkmcnt(6)
    buffer_load_dwordx4 v53, s[24:27], s69 offen lds
    v_mfma_f32_16x16x32_bf16 v[56:59], v[152:155], v[156:159], v[56:59]
    s_waitcnt vmcnt(9) lgkmcnt(5)
    ds_read_b64 v[178:179], v44 offset:1992
    s_barrier
    v_mfma_f32_16x16x32_bf16 v[60:63], v[152:155], v[164:167], v[60:63]
    s_add_u32 m0, s95, 97216
    ds_read_b64 v[184:185], v47 offset:0
    ds_read_b64 v[186:187], v47 offset:2048
    v_mfma_f32_16x16x32_bf16 v[60:63], v[160:163], v[156:159], v[60:63]
    s_waitcnt lgkmcnt(5)
    ds_read_b64 v[188:189], v47 offset:4096
    ds_read_b64 v[190:191], v47 offset:6144
    ds_read_b64_tr_b16 a[84:85], v54 offset:24704
    v_mfma_f32_16x16x32_bf16 v[64:67], v[152:155], v[172:175], v[64:67]
    s_add_u32 s64, s69, 98304
    ds_read_b128 v[216:219], v48 offset:0
    ds_read_b64_tr_b16 a[86:87], v54 offset:25472
    buffer_load_dwordx4 v51, s[24:27], s64 offen lds
    ds_read_b64_tr_b16 a[88:89], v54 offset:27792
    v_mfma_f32_16x16x32_bf16 v[64:67], v[160:163], v[164:167], v[64:67]
    s_nop 0
    s_add_u32 m0, s95, 98240
    ds_read_b128 v[220:223], v48 offset:1024
    ds_read_b128 v[224:227], v48 offset:2048
    ds_read_b64_tr_b16 a[90:91], v54 offset:28560
    ds_read_b64_tr_b16 a[92:93], v55 offset:24704
    v_mfma_f32_16x16x32_bf16 v[64:67], v[168:171], v[156:159], v[64:67]
    s_waitcnt lgkmcnt(12)
    ds_read_b128 v[228:231], v48 offset:3072
    ds_read_b128 v[232:235], v48 offset:4096
    ds_read_b64_tr_b16 a[94:95], v55 offset:25472
    v_mfma_f32_16x16x32_bf16 v[68:71], v[152:155], v[180:183], v[68:71]
    ds_read_b128 v[236:239], v48 offset:5120
    buffer_load_dwordx4 v52, s[24:27], s64 offen lds
    ds_read_b128 v[240:243], v48 offset:6144
    v_mfma_f32_16x16x32_bf16 v[68:71], v[160:163], v[172:175], v[68:71]
    s_add_u32 m0, s95, 99264
    ds_read_b128 v[244:247], v48 offset:7168
    ds_read_b64 v[192:193], v46 offset:0
    v_mfma_f32_16x16x32_bf16 v[68:71], v[168:171], v[164:167], v[68:71]
    ds_read_b64 v[194:195], v46 offset:512
    ds_read_b64 v[196:197], v46 offset:1024
    v_mfma_f32_16x16x32_bf16 v[68:71], v[176:179], v[156:159], v[68:71]
    ds_read_b64 v[198:199], v46 offset:1536
    buffer_load_dwordx4 v53, s[24:27], s64 offen lds
    s_waitcnt lgkmcnt(15)
    v_lshlrev_b32 v200, 16, v184
    ds_read_b64 v[88:89], v44 offset:0
    v_and_b32 v201, s59, v184
    v_lshlrev_b32 v202, 16, v185
    ds_read_b64 v[90:91], v44 offset:8
    v_and_b32 v203, s59, v185
    v_lshlrev_b32 v204, 16, v186
    ds_read_b128 v[124:127], v45 offset:2496
    v_and_b32 v205, s59, v186
    v_lshlrev_b32 v206, 16, v187
    ds_read_b64 v[96:97], v44 offset:512
    v_and_b32 v207, s59, v187
    v_lshlrev_b32 v208, 16, v188
    ds_read_b64 v[98:99], v44 offset:520
    v_and_b32 v209, s59, v188
    v_lshlrev_b32 v210, 16, v189
    ds_read_b128 v[116:119], v45 offset:1984
    v_and_b32 v211, s59, v189
    v_lshlrev_b32 v212, 16, v190
    ds_read_b64 v[104:105], v44 offset:1024
    v_and_b32 v213, s59, v190
    v_lshlrev_b32 v214, 16, v191
    ds_read_b64 v[106:107], v44 offset:1032
    v_and_b32 v215, s59, v191
    s_waitcnt lgkmcnt(12)
    v_pk_fma_f32 v[216:217], v[200:201], v[216:217], v[220:221]
    ds_read_b128 v[108:111], v45 offset:1472
    v_pk_fma_f32 v[218:219], v[202:203], v[218:219], v[222:223]
    s_nop 0
    v_pk_fma_f32 v[224:225], v[204:205], v[224:225], v[228:229]
    ds_read_b64 v[112:113], v44 offset:1536
    v_pk_fma_f32 v[226:227], v[206:207], v[226:227], v[230:231]
    v_pk_fma_f32 v[232:233], v[208:209], v[232:233], v[236:237]
    ds_read_b64 v[114:115], v44 offset:1544
    v_pk_fma_f32 v[234:235], v[210:211], v[234:235], v[238:239]
    v_pk_fma_f32 v[240:241], v[212:213], v[240:241], v[244:245]
    v_pk_fma_f32 v[242:243], v[214:215], v[242:243], v[246:247]
    ds_read_b128 v[100:103], v45 offset:960
    s_waitcnt lgkmcnt(12)
    v_and_b32 v220, s59, v193
    v_lshlrev_b32 v221, 16, v193
    ds_read_b64 v[120:121], v44 offset:2048
    v_and_b32 v222, s59, v192
    v_lshlrev_b32 v223, 16, v192
    ds_read_b64 v[122:123], v44 offset:2056
    v_and_b32 v228, s59, v195
    v_lshlrev_b32 v229, 16, v195
    ds_read_b128 v[92:95], v45 offset:448
    v_and_b32 v230, s59, v194
    v_lshlrev_b32 v231, 16, v194
    ds_read_b128 v[132:135], v45 offset:3008
    v_and_b32 v236, s59, v197
    v_lshlrev_b32 v237, 16, v197
    ds_read_b64 v[128:129], v44 offset:2560
    v_and_b32 v238, s59, v196
    v_lshlrev_b32 v239, 16, v196
    ds_read_b64 v[130:131], v44 offset:2568
    v_and_b32 v244, s59, v199
    v_lshlrev_b32 v245, 16, v199
    ds_read_b128 v[140:143], v45 offset:3520
    v_and_b32 v246, s59, v198
    v_lshlrev_b32_e64 v247, 16, v198
    ds_read_b64 v[136:137], v44 offset:3072
    v_pk_fma_f32 v[56:57], v[220:221], s[20:21], v[56:57]
    v_pk_fma_f32 v[58:59], v[222:223], s[20:21], v[58:59]
    ds_read_b64 v[138:139], v44 offset:3080
    v_pk_fma_f32 v[60:61], v[228:229], s[20:21], v[60:61]
    v_pk_fma_f32 v[62:63], v[230:231], s[20:21], v[62:63]
    v_pk_fma_f32 v[64:65], v[236:237], s[20:21], v[64:65]
    ds_read_b128 v[148:151], v45 offset:4032
    v_pk_fma_f32 v[66:67], v[238:239], s[20:21], v[66:67]
    v_pk_fma_f32 v[68:69], v[244:245], s[20:21], v[68:69]
    ds_read_b64 v[144:145], v44 offset:3584
    v_pk_fma_f32 v[70:71], v[246:247], s[20:21], v[70:71]
    v_pk_fma_f32 v[200:201], v[216:217], v[56:57], v[200:201]
    ds_read_b64 v[146:147], v44 offset:3592
    v_pk_fma_f32 v[202:203], v[218:219], v[58:59], v[202:203]
    v_pk_fma_f32 v[204:205], v[224:225], v[60:61], v[204:205]
    v_pk_fma_f32 v[206:207], v[226:227], v[62:63], v[206:207]
    v_pk_fma_f32 v[208:209], v[232:233], v[64:65], v[208:209]
    v_pk_fma_f32 v[210:211], v[234:235], v[66:67], v[210:211]
    v_pk_fma_f32 v[212:213], v[240:241], v[68:69], v[212:213]
    v_pk_fma_f32 v[214:215], v[242:243], v[70:71], v[214:215]
    v_cvt_pk_bf16_f32 v192, v200, v201
    v_cvt_pk_bf16_f32 v193, v202, v203
    v_cvt_pk_bf16_f32 v194, v204, v205
    v_cvt_pk_bf16_f32 v195, v206, v207
    v_cvt_pk_bf16_f32 v196, v208, v209
    v_cvt_pk_bf16_f32 v197, v210, v211
    v_cvt_pk_bf16_f32 v198, v212, v213
    v_cvt_pk_bf16_f32 v199, v214, v215
    s_add_u32 s74, s31, 0
    v_permlane16_swap_b32 v192, v194
    v_permlane16_swap_b32 v193, v195
    buffer_store_dwordx4 v[192:195], v49, s[40:43], s74 offen sc1
    s_add_u32 s74, s31, 655360
    v_permlane16_swap_b32 v196, v198
    v_permlane16_swap_b32 v197, v199
    buffer_store_dwordx4 v[196:199], v49, s[40:43], s74 offen sc1
    s_waitcnt lgkmcnt(9)
    v_mfma_f32_16x16x32_bf16 v[72:75], v[88:91], v[124:127], 0
    ds_read_b64 v[152:153], v44 offset:64
    v_mfma_f32_16x16x32_bf16 v[72:75], v[96:99], v[116:119], v[72:75]
    ds_read_b64 v[154:155], v44 offset:72
    v_mfma_f32_16x16x32_bf16 v[72:75], v[104:107], v[108:111], v[72:75]
    ds_read_b128 v[188:191], v45 offset:2432
    v_mfma_f32_16x16x32_bf16 v[72:75], v[112:115], v[100:103], v[72:75]
    ds_read_b64 v[160:161], v44 offset:576
    v_mfma_f32_16x16x32_bf16 v[72:75], v[120:123], v[92:95], v[72:75]
    s_waitcnt lgkmcnt(10)
    ds_read_b64 v[162:163], v44 offset:584
    v_mfma_f32_16x16x32_bf16 v[76:79], v[88:91], v[132:135], 0
    s_waitcnt vmcnt(11)
    s_barrier
    v_mfma_f32_16x16x32_bf16 v[76:79], v[96:99], v[124:127], v[76:79]
    s_add_u32 m0, s95, 109568
    ds_read_b64_tr_b16 a[96:97], v54 offset:37056
    v_mfma_f32_16x16x32_bf16 v[76:79], v[104:107], v[116:119], v[76:79]
    s_add_u32 s64, s69, 196608
    buffer_load_dwordx4 v51, s[24:27], s64 offen lds
    v_mfma_f32_16x16x32_bf16 v[76:79], v[112:115], v[108:111], v[76:79]
    ds_read_b128 v[180:183], v45 offset:1920
    ds_read_b64_tr_b16 a[98:99], v54 offset:37824
    v_mfma_f32_16x16x32_bf16 v[76:79], v[120:123], v[100:103], v[76:79]
    ds_read_b64 v[168:169], v44 offset:1088
    v_mfma_f32_16x16x32_bf16 v[76:79], v[128:131], v[92:95], v[76:79]
    s_waitcnt lgkmcnt(12)
    ds_read_b64 v[170:171], v44 offset:1096
    ds_read_b64_tr_b16 a[100:101], v54 offset:40144
    v_mfma_f32_16x16x32_bf16 v[80:83], v[88:91], v[140:143], 0
    s_add_u32 m0, s95, 110592
    ds_read_b128 v[172:175], v45 offset:1408
    v_mfma_f32_16x16x32_bf16 v[80:83], v[96:99], v[132:135], v[80:83]
    buffer_load_dwordx4 v52, s[24:27], s64 offen lds
    v_mfma_f32_16x16x32_bf16 v[80:83], v[104:107], v[124:127], v[80:83]
    ds_read_b64_tr_b16 a[102:103], v54 offset:40912
    ds_read_b64 v[176:177], v44 offset:1600
    v_mfma_f32_16x16x32_bf16 v[80:83], v[112:115], v[116:119], v[80:83]
    ds_read_b64_tr_b16 a[104:105], v55 offset:37056
    ds_read_b64 v[178:179], v44 offset:1608
    v_mfma_f32_16x16x32_bf16 v[80:83], v[120:123], v[108:111], v[80:83]
    s_add_u32 m0, s95, 111616
    ds_read_b128 v[164:167], v45 offset:896
    v_mfma_f32_16x16x32_bf16 v[80:83], v[128:131], v[100:103], v[80:83]
    ds_read_b64_tr_b16 a[106:107], v55 offset:37824
    ds_read_b64 v[184:185], v44 offset:2112
    v_mfma_f32_16x16x32_bf16 v[80:83], v[136:139], v[92:95], v[80:83]
    s_waitcnt lgkmcnt(15)
    buffer_load_dwordx4 v53, s[24:27], s64 offen lds
    v_mfma_f32_16x16x32_bf16 v[84:87], v[88:91], v[148:151], 0
    ds_read_b128 v[196:199], v45 offset:2944
    ds_read_b64 v[186:187], v44 offset:2120
    v_mfma_f32_16x16x32_bf16 v[84:87], v[96:99], v[140:143], v[84:87]
    ds_read_b64 v[192:193], v44 offset:2624
    ds_read_b128 v[156:159], v45 offset:384
    v_mfma_f32_16x16x32_bf16 v[84:87], v[104:107], v[132:135], v[84:87]
    ds_read_b128 v[204:207], v45 offset:3456
    v_mfma_f32_16x16x32_bf16 v[84:87], v[112:115], v[124:127], v[84:87]
    s_waitcnt vmcnt(11) lgkmcnt(6)
    s_barrier
    v_mfma_f32_16x16x32_bf16 v[84:87], v[120:123], v[116:119], v[84:87]
    s_add_u32 m0, s95, 121920
    ds_read_b64 v[194:195], v44 offset:2632
    ds_read_b64 v[200:201], v44 offset:3136
    v_mfma_f32_16x16x32_bf16 v[84:87], v[128:131], v[108:111], v[84:87]
    s_add_u32 s64, s69, 294912
    buffer_load_dwordx4 v51, s[24:27], s64 offen lds
    v_mfma_f32_16x16x32_bf16 v[84:87], v[136:139], v[100:103], v[84:87]
    ds_read_b128 v[212:215], v45 offset:3968
    ds_read_b64_tr_b16 a[108:109], v54 offset:49408
    v_mfma_f32_16x16x32_bf16 v[84:87], v[144:147], v[92:95], v[84:87]
    s_waitcnt lgkmcnt(5)
    ds_read_b64 v[202:203], v44 offset:3144
    ds_read_b64_tr_b16 a[110:111], v54 offset:50176
    v_mfma_f32_16x16x32_bf16 v[72:75], v[152:155], v[188:191], v[72:75]
    s_add_u32 m0, s95, 122944
    ds_read_b64 v[208:209], v44 offset:3648
    ds_read_b64 v[88:89], v44 offset:128
    v_mfma_f32_16x16x32_bf16 v[72:75], v[160:163], v[180:183], v[72:75]
    ds_read_b64_tr_b16 a[112:113], v54 offset:52496
    v_mfma_f32_16x16x32_bf16 v[72:75], v[168:171], v[172:175], v[72:75]
    buffer_load_dwordx4 v52, s[24:27], s64 offen lds
    v_mfma_f32_16x16x32_bf16 v[72:75], v[176:179], v[164:167], v[72:75]
    ds_read_b64 v[210:211], v44 offset:3656
    ds_read_b64 v[90:91], v44 offset:136
    v_mfma_f32_16x16x32_bf16 v[72:75], v[184:187], v[156:159], v[72:75]
    s_waitcnt lgkmcnt(10)
    ds_read_b64_tr_b16 a[114:115], v54 offset:53264
    ds_read_b128 v[124:127], v45 offset:2368
    v_mfma_f32_16x16x32_bf16 v[76:79], v[152:155], v[196:199], v[76:79]
    s_add_u32 m0, s95, 123968
    ds_read_b64 v[96:97], v44 offset:640
    ds_read_b64_tr_b16 a[116:117], v55 offset:49408
    v_mfma_f32_16x16x32_bf16 v[76:79], v[160:163], v[188:191], v[76:79]
    ds_read_b64 v[98:99], v44 offset:648
    ds_read_b64_tr_b16 a[118:119], v55 offset:50176
    v_mfma_f32_16x16x32_bf16 v[76:79], v[168:171], v[180:183], v[76:79]
    buffer_load_dwordx4 v53, s[24:27], s64 offen lds
    v_mfma_f32_16x16x32_bf16 v[76:79], v[176:179], v[172:175], v[76:79]
    ds_read_b128 v[116:119], v45 offset:1856
    ds_read_b64 v[104:105], v44 offset:1152
    v_mfma_f32_16x16x32_bf16 v[76:79], v[184:187], v[164:167], v[76:79]
    ds_read_b64 v[106:107], v44 offset:1160
    v_mfma_f32_16x16x32_bf16 v[76:79], v[192:195], v[156:159], v[76:79]
    s_waitcnt lgkmcnt(15)
    ds_read_b128 v[108:111], v45 offset:1344
    v_mfma_f32_16x16x32_bf16 v[80:83], v[152:155], v[204:207], v[80:83]
    ds_read_b64 v[112:113], v44 offset:1664
    v_mfma_f32_16x16x32_bf16 v[80:83], v[160:163], v[196:199], v[80:83]
    s_waitcnt vmcnt(6) lgkmcnt(5)
    s_barrier
    v_mfma_f32_16x16x32_bf16 v[80:83], v[168:171], v[188:191], v[80:83]
    buffer_store_dwordx2 v[10:11], v4, s[40:43], s28 offen sc1
    v_mfma_f32_16x16x32_bf16 v[80:83], v[176:179], v[180:183], v[80:83]
    ds_read_b64_tr_b16 a[120:121], v54 offset:0
    ds_read_b64 v[114:115], v44 offset:1672
    v_mfma_f32_16x16x32_bf16 v[80:83], v[184:187], v[172:175], v[80:83]
    s_add_u32 m0, s95, 134272
    ds_read_b128 v[100:103], v45 offset:832
    ds_read_b64_tr_b16 a[122:123], v54 offset:768
    v_mfma_f32_16x16x32_bf16 v[80:83], v[192:195], v[164:167], v[80:83]
    s_add_u32 s64, s69, 393216
    ds_read_b64 v[120:121], v44 offset:2176
    ds_read_b128 v[132:135], v45 offset:2880
    v_mfma_f32_16x16x32_bf16 v[80:83], v[200:203], v[156:159], v[80:83]
    buffer_load_dwordx4 v51, s[24:27], s64 offen lds
    v_mfma_f32_16x16x32_bf16 v[84:87], v[152:155], v[212:215], v[84:87]
    ds_read_b64_tr_b16 a[124:125], v54 offset:3088
    ds_read_b64 v[122:123], v44 offset:2184
    v_mfma_f32_16x16x32_bf16 v[84:87], v[160:163], v[204:207], v[84:87]
    s_add_u32 m0, s95, 135296
    ds_read_b64 v[128:129], v44 offset:2688
    ds_read_b64_tr_b16 a[126:127], v54 offset:3856
    ds_read_b128 v[92:95], v45 offset:320
    v_mfma_f32_16x16x32_bf16 v[84:87], v[168:171], v[196:199], v[84:87]
    ds_read_b128 v[140:143], v45 offset:3392
    v_mfma_f32_16x16x32_bf16 v[84:87], v[176:179], v[188:191], v[84:87]
    buffer_load_dwordx4 v52, s[24:27], s64 offen lds
    v_mfma_f32_16x16x32_bf16 v[84:87], v[184:187], v[180:183], v[84:87]
    ds_read_b64_tr_b16 a[128:129], v55 offset:0
    ds_read_b64 v[130:131], v44 offset:2696
    v_mfma_f32_16x16x32_bf16 v[84:87], v[192:195], v[172:175], v[84:87]
    s_add_u32 m0, s95, 136320
    ds_read_b64 v[136:137], v44 offset:3200
    ds_read_b128 v[148:151], v45 offset:3904
    ds_read_b64_tr_b16 a[130:131], v55 offset:768
    v_mfma_f32_16x16x32_bf16 v[84:87], v[200:203], v[164:167], v[84:87]
    ds_read_b64 v[138:139], v44 offset:3208
    v_mfma_f32_16x16x32_bf16 v[84:87], v[208:211], v[156:159], v[84:87]
    s_waitcnt lgkmcnt(7)
    buffer_load_dwordx4 v53, s[24:27], s64 offen lds
    v_mfma_f32_16x16x32_bf16 v[72:75], v[88:91], v[124:127], v[72:75]
    ds_read_b64 v[144:145], v44 offset:3712
    ds_read_b64 v[152:153], v44 offset:192
    v_mfma_f32_16x16x32_bf16 v[72:75], v[96:99], v[116:119], v[72:75]
    ds_read_b64 v[146:147], v44 offset:3720
    v_mfma_f32_16x16x32_bf16 v[72:75], v[104:107], v[108:111], v[72:75]
    s_waitcnt lgkmcnt(4)
    s_barrier
    v_mfma_f32_16x16x32_bf16 v[72:75], v[112:115], v[100:103], v[72:75]
    s_add_u32 m0, s95, 84864
    ds_read_b64 v[154:155], v44 offset:200
    ds_read_b128 v[188:191], v45 offset:2304
    v_mfma_f32_16x16x32_bf16 v[72:75], v[120:123], v[92:95], v[72:75]
    buffer_load_dwordx4 v51, s[24:27], s70 offen lds
    v_mfma_f32_16x16x32_bf16 v[76:79], v[88:91], v[132:135], v[76:79]
    ds_read_b64_tr_b16 a[132:133], v54 offset:12352
    ds_read_b64 v[160:161], v44 offset:704
    v_mfma_f32_16x16x32_bf16 v[76:79], v[96:99], v[124:127], v[76:79]
    ds_read_b64_tr_b16 a[134:135], v54 offset:13120
    ds_read_b64 v[162:163], v44 offset:712
    v_mfma_f32_16x16x32_bf16 v[76:79], v[104:107], v[116:119], v[76:79]
    s_add_u32 m0, s95, 85888
    ds_read_b128 v[180:183], v45 offset:1792
    ds_read_b64_tr_b16 a[136:137], v54 offset:15440
    v_mfma_f32_16x16x32_bf16 v[76:79], v[112:115], v[108:111], v[76:79]
    ds_read_b64 v[168:169], v44 offset:1216
    v_mfma_f32_16x16x32_bf16 v[76:79], v[120:123], v[100:103], v[76:79]
    buffer_load_dwordx4 v52, s[24:27], s70 offen lds
    v_mfma_f32_16x16x32_bf16 v[76:79], v[128:131], v[92:95], v[76:79]
    s_waitcnt lgkmcnt(12)
    ds_read_b64_tr_b16 a[138:139], v54 offset:16208
    ds_read_b64 v[170:171], v44 offset:1224
    v_mfma_f32_16x16x32_bf16 v[80:83], v[88:91], v[140:143], v[80:83]
    ds_read_b128 v[172:175], v45 offset:1280
    ds_read_b64_tr_b16 a[140:141], v55 offset:12352
    v_mfma_f32_16x16x32_bf16 v[80:83], v[96:99], v[132:135], v[80:83]
    s_add_u32 m0, s95, 86912
    ds_read_b64 v[176:177], v44 offset:1728
    v_mfma_f32_16x16x32_bf16 v[80:83], v[104:107], v[124:127], v[80:83]
    ds_read_b64_tr_b16 a[142:143], v55 offset:13120
    v_mfma_f32_16x16x32_bf16 v[80:83], v[112:115], v[116:119], v[80:83]
    buffer_load_dwordx4 v53, s[24:27], s70 offen lds
    v_mfma_f32_16x16x32_bf16 v[80:83], v[120:123], v[108:111], v[80:83]
    ds_read_b64 v[178:179], v44 offset:1736
    ds_read_b128 v[164:167], v45 offset:768
    v_mfma_f32_16x16x32_bf16 v[80:83], v[128:131], v[100:103], v[80:83]
    ds_read_b64 v[184:185], v44 offset:2240
    ds_read_b128 v[196:199], v45 offset:2816
    v_mfma_f32_16x16x32_bf16 v[80:83], v[136:139], v[92:95], v[80:83]
    s_waitcnt lgkmcnt(15)
    ds_read_b64 v[186:187], v44 offset:2248
    v_mfma_f32_16x16x32_bf16 v[84:87], v[88:91], v[148:151], v[84:87]
    ds_read_b64 v[192:193], v44 offset:2752
    v_mfma_f32_16x16x32_bf16 v[84:87], v[96:99], v[140:143], v[84:87]
    s_waitcnt vmcnt(10) lgkmcnt(6)
    ds_read_b128 v[156:159], v45 offset:256
    s_barrier
    v_mfma_f32_16x16x32_bf16 v[84:87], v[104:107], v[132:135], v[84:87]
    buffer_load_dwordx2 v[12:13], v9, s[40:43], s78 offen sc1
    v_mfma_f32_16x16x32_bf16 v[84:87], v[112:115], v[124:127], v[84:87]
    ds_read_b128 v[204:207], v45 offset:3328
    ds_read_b64_tr_b16 a[144:145], v54 offset:24704
    v_mfma_f32_16x16x32_bf16 v[84:87], v[120:123], v[116:119], v[84:87]
L_pg2:
    s_cbranch_execz L_pg6
    s_add_u32 m0, s95, 97216
    ds_read_b64 v[194:195], v44 offset:2760
    ds_read_b64 v[200:201], v44 offset:3264
    v_mfma_f32_16x16x32_bf16 v[84:87], v[128:131], v[108:111], v[84:87]
    s_add_u32 s64, s70, 98304
    ds_read_b64_tr_b16 a[146:147], v54 offset:25472
    ds_read_b128 v[212:215], v45 offset:3840
    v_mfma_f32_16x16x32_bf16 v[84:87], v[136:139], v[100:103], v[84:87]
    buffer_load_dwordx4 v51, s[24:27], s64 offen lds
    v_mfma_f32_16x16x32_bf16 v[84:87], v[144:147], v[92:95], v[84:87]
    s_waitcnt lgkmcnt(6)
    ds_read_b64 v[202:203], v44 offset:3272
    ds_read_b64_tr_b16 a[148:149], v54 offset:27792
    v_mfma_f32_16x16x32_bf16 v[72:75], v[152:155], v[188:191], v[72:75]
    s_add_u32 m0, s95, 98240
    ds_read_b64 v[208:209], v44 offset:3776
    ds_read_b64_tr_b16 a[150:151], v54 offset:28560
    v_mfma_f32_16x16x32_bf16 v[72:75], v[160:163], v[180:183], v[72:75]
    ds_read_b64 v[88:89], v44 offset:256
    v_mfma_f32_16x16x32_bf16 v[72:75], v[168:171], v[172:175], v[72:75]
    buffer_load_dwordx4 v52, s[24:27], s64 offen lds
    v_mfma_f32_16x16x32_bf16 v[72:75], v[176:179], v[164:167], v[72:75]
    ds_read_b64 v[210:211], v44 offset:3784
    ds_read_b64 v[90:91], v44 offset:264
    ds_read_b64_tr_b16 a[152:153], v55 offset:24704
    v_mfma_f32_16x16x32_bf16 v[72:75], v[184:187], v[156:159], v[72:75]
    s_waitcnt lgkmcnt(11)
    ds_read_b128 v[124:127], v45 offset:2240
    ds_read_b64_tr_b16 a[154:155], v55 offset:25472
    v_mfma_f32_16x16x32_bf16 v[76:79], v[152:155], v[196:199], v[76:79]
    s_add_u32 m0, s95, 99264
    ds_read_b64 v[96:97], v44 offset:768
    v_mfma_f32_16x16x32_bf16 v[76:79], v[160:163], v[188:191], v[76:79]
    buffer_load_dwordx4 v53, s[24:27], s64 offen lds
    v_mfma_f32_16x16x32_bf16 v[76:79], v[168:171], v[180:183], v[76:79]
    ds_read_b64 v[98:99], v44 offset:776
    ds_read_b128 v[116:119], v45 offset:1728
    v_mfma_f32_16x16x32_bf16 v[76:79], v[176:179], v[172:175], v[76:79]
    ds_read_b64 v[104:105], v44 offset:1280
    v_mfma_f32_16x16x32_bf16 v[76:79], v[184:187], v[164:167], v[76:79]
    s_waitcnt vmcnt(11) lgkmcnt(4)
    s_barrier
    v_mfma_f32_16x16x32_bf16 v[76:79], v[192:195], v[156:159], v[76:79]
    ds_read_b64 v[106:107], v44 offset:1288
    ds_read_b64_tr_b16 a[156:157], v54 offset:37056
    v_mfma_f32_16x16x32_bf16 v[80:83], v[152:155], v[204:207], v[80:83]
    s_add_u32 m0, s95, 109568
    ds_read_b128 v[108:111], v45 offset:1216
    s_add_u32 s64, s70, 196608
    v_mfma_f32_16x16x32_bf16 v[80:83], v[160:163], v[196:199], v[80:83]
    buffer_load_dwordx4 v51, s[24:27], s64 offen lds
    v_mfma_f32_16x16x32_bf16 v[80:83], v[168:171], v[188:191], v[80:83]
    ds_read_b64 v[112:113], v44 offset:1792
    ds_read_b64_tr_b16 a[158:159], v54 offset:37824
    v_mfma_f32_16x16x32_bf16 v[80:83], v[176:179], v[180:183], v[80:83]
    s_add_u32 m0, s95, 110592
    ds_read_b64 v[114:115], v44 offset:1800
    ds_read_b64_tr_b16 a[160:161], v54 offset:40144
    v_mfma_f32_16x16x32_bf16 v[80:83], v[184:187], v[172:175], v[80:83]
    ds_read_b128 v[100:103], v45 offset:704
    v_mfma_f32_16x16x32_bf16 v[80:83], v[192:195], v[164:167], v[80:83]
    buffer_load_dwordx4 v52, s[24:27], s64 offen lds
    v_mfma_f32_16x16x32_bf16 v[80:83], v[200:203], v[156:159], v[80:83]
    ds_read_b64 v[120:121], v44 offset:2304
    ds_read_b128 v[132:135], v45 offset:2752
    v_mfma_f32_16x16x32_bf16 v[84:87], v[152:155], v[212:215], v[84:87]
    ds_read_b64_tr_b16 a[162:163], v54 offset:40912
    ds_read_b64 v[122:123], v44 offset:2312
    v_mfma_f32_16x16x32_bf16 v[84:87], v[160:163], v[204:207], v[84:87]
    s_add_u32 m0, s95, 111616
    ds_read_b64_tr_b16 a[164:165], v55 offset:37056
    ds_read_b64 v[128:129], v44 offset:2816
    ds_read_b128 v[92:95], v45 offset:192
    v_mfma_f32_16x16x32_bf16 v[84:87], v[168:171], v[196:199], v[84:87]
    ds_read_b128 v[140:143], v45 offset:3264
    ds_read_b64_tr_b16 a[166:167], v55 offset:37824
    v_mfma_f32_16x16x32_bf16 v[84:87], v[176:179], v[188:191], v[84:87]
    buffer_load_dwordx4 v53, s[24:27], s64 offen lds
    v_mfma_f32_16x16x32_bf16 v[84:87], v[184:187], v[180:183], v[84:87]
    ds_read_b64 v[130:131], v44 offset:2824
    ds_read_b64 v[136:137], v44 offset:3328
    v_mfma_f32_16x16x32_bf16 v[84:87], v[192:195], v[172:175], v[84:87]
    ds_read_b128 v[148:151], v45 offset:3776
    v_mfma_f32_16x16x32_bf16 v[84:87], v[200:203], v[164:167], v[84:87]
    ds_read_b64 v[138:139], v44 offset:3336
    v_mfma_f32_16x16x32_bf16 v[84:87], v[208:211], v[156:159], v[84:87]
    s_waitcnt lgkmcnt(6)
    ds_read_b64 v[144:145], v44 offset:3840
    v_mfma_f32_16x16x32_bf16 v[72:75], v[88:91], v[124:127], v[72:75]
    s_waitcnt vmcnt(10) lgkmcnt(5)
    s_barrier
    v_mfma_f32_16x16x32_bf16 v[72:75], v[96:99], v[116:119], v[72:75]
    buffer_store_dwordx2 v[10:11], v50, s[40:43], 0 offen sc1
    v_mfma_f32_16x16x32_bf16 v[72:75], v[104:107], v[108:111], v[72:75]
    ds_read_b64 v[152:153], v44 offset:320
    ds_read_b64_tr_b16 a[168:169], v54 offset:49408
    v_mfma_f32_16x16x32_bf16 v[72:75], v[112:115], v[100:103], v[72:75]
    s_add_u32 m0, s95, 121920
    ds_read_b64 v[146:147], v44 offset:3848
    ds_read_b64 v[154:155], v44 offset:328
    v_mfma_f32_16x16x32_bf16 v[72:75], v[120:123], v[92:95], v[72:75]
    s_waitcnt lgkmcnt(8)
    ds_read_b128 v[188:191], v45 offset:2176
    ds_read_b64_tr_b16 a[170:171], v54 offset:50176
    v_mfma_f32_16x16x32_bf16 v[76:79], v[88:91], v[132:135], v[76:79]
    s_add_u32 s64, s70, 294912
    buffer_load_dwordx4 v51, s[24:27], s64 offen lds
    v_mfma_f32_16x16x32_bf16 v[76:79], v[96:99], v[124:127], v[76:79]
    ds_read_b64 v[160:161], v44 offset:832
    ds_read_b64_tr_b16 a[172:173], v54 offset:52496
    v_mfma_f32_16x16x32_bf16 v[76:79], v[104:107], v[116:119], v[76:79]
    s_add_u32 m0, s95, 122944
    ds_read_b64 v[162:163], v44 offset:840
    ds_read_b64_tr_b16 a[174:175], v54 offset:53264
    v_mfma_f32_16x16x32_bf16 v[76:79], v[112:115], v[108:111], v[76:79]
    ds_read_b128 v[180:183], v45 offset:1664
    ds_read_b64 v[168:169], v44 offset:1344
    v_mfma_f32_16x16x32_bf16 v[76:79], v[120:123], v[100:103], v[76:79]
    buffer_load_dwordx4 v52, s[24:27], s64 offen lds
    v_mfma_f32_16x16x32_bf16 v[76:79], v[128:131], v[92:95], v[76:79]
    s_waitcnt lgkmcnt(13)
    ds_read_b64_tr_b16 a[176:177], v55 offset:49408
    ds_read_b64 v[170:171], v44 offset:1352
    v_mfma_f32_16x16x32_bf16 v[80:83], v[88:91], v[140:143], v[80:83]
    s_add_u32 m0, s95, 123968
    ds_read_b64_tr_b16 a[178:179], v55 offset:50176
    ds_read_b128 v[172:175], v45 offset:1152
    v_mfma_f32_16x16x32_bf16 v[80:83], v[96:99], v[132:135], v[80:83]
    ds_read_b64 v[176:177], v44 offset:1856
    v_mfma_f32_16x16x32_bf16 v[80:83], v[104:107], v[124:127], v[80:83]
    buffer_load_dwordx4 v53, s[24:27], s64 offen lds
    v_mfma_f32_16x16x32_bf16 v[80:83], v[112:115], v[116:119], v[80:83]
    ds_read_b64 v[178:179], v44 offset:1864
    v_mfma_f32_16x16x32_bf16 v[80:83], v[120:123], v[108:111], v[80:83]
    ds_read_b128 v[164:167], v45 offset:640
    v_mfma_f32_16x16x32_bf16 v[80:83], v[128:131], v[100:103], v[80:83]
    s_waitcnt vmcnt(11) lgkmcnt(4)
    s_barrier
    v_mfma_f32_16x16x32_bf16 v[80:83], v[136:139], v[92:95], v[80:83]
    ds_read_b64 v[184:185], v44 offset:2368
    s_nop 0
    ds_read_b128 v[196:199], v45 offset:2688
    s_add_u32 m0, s95, 134272
    s_add_u32 s64, s70, 393216
    buffer_load_dwordx4 v51, s[24:27], s64 offen lds
    s_add_u32 m0, s95, 135296
    v_mfma_f32_16x16x32_bf16 v[84:87], v[88:91], v[148:151], v[84:87]
    ds_read_b64 v[186:187], v44 offset:2376
    buffer_load_dwordx4 v52, s[24:27], s64 offen lds
    v_mfma_f32_16x16x32_bf16 v[84:87], v[96:99], v[140:143], v[84:87]
    s_add_u32 m0, s95, 136320
    ds_read_b64_tr_b16 a[180:181], v54 offset:0
    ds_read_b64 v[192:193], v44 offset:2880
    ds_read_b128 v[156:159], v45 offset:128
    v_mfma_f32_16x16x32_bf16 v[84:87], v[104:107], v[132:135], v[84:87]
    buffer_load_dwordx4 v53, s[24:27], s64 offen lds
    v_mfma_f32_16x16x32_bf16 v[84:87], v[112:115], v[124:127], v[84:87]
    s_waitcnt vmcnt(13)
    ds_read_b128 v[204:207], v45 offset:3200
    ds_read_b64_tr_b16 a[182:183], v54 offset:768
    v_cmp_ne_u64 vcc, v[10:11], v[12:13]
    v_mfma_f32_16x16x32_bf16 v[84:87], v[120:123], v[116:119], v[84:87]
    ds_read_b64 v[194:195], v44 offset:2888
    ds_read_b64_tr_b16 a[184:185], v54 offset:3088
    v_mfma_f32_16x16x32_bf16 v[84:87], v[128:131], v[108:111], v[84:87]
    ds_read_b64 v[200:201], v44 offset:3392
    ds_read_b128 v[212:215], v45 offset:3712
    v_mfma_f32_16x16x32_bf16 v[84:87], v[136:139], v[100:103], v[84:87]
    s_cbranch_vccnz L_spin14
L_ok13:
    v_mfma_f32_16x16x32_bf16 v[84:87], v[144:147], v[92:95], v[84:87]
    s_waitcnt lgkmcnt(6)
    ds_read_b64_tr_b16 a[186:187], v54 offset:3856
    ds_read_b64 v[202:203], v44 offset:3400
    v_mfma_f32_16x16x32_bf16 v[72:75], v[152:155], v[188:191], v[72:75]
    s_add_u32 m0, s55, 147456
    ds_read_b64 v[208:209], v44 offset:3904
    ds_read_b64_tr_b16 a[188:189], v55 offset:0
    s_add_u32 s75, s30, 3809280
    buffer_load_dwordx4 v2, s[40:43], s75 offen offset:0 sc1 lds
    v_mfma_f32_16x16x32_bf16 v[72:75], v[160:163], v[180:183], v[72:75]
    ds_read_b64 v[88:89], v44 offset:384
    ds_read_b64_tr_b16 a[190:191], v55 offset:768
    v_mfma_f32_16x16x32_bf16 v[72:75], v[168:171], v[172:175], v[72:75]
    buffer_load_dwordx4 v2, s[40:43], s75 offen offset:1024 sc1 lds
    v_mfma_f32_16x16x32_bf16 v[72:75], v[176:179], v[164:167], v[72:75]
    s_add_u32 m0, s55, 155648
    ds_read_b64 v[210:211], v44 offset:3912
    ds_read_b64 v[90:91], v44 offset:392
    v_mfma_f32_16x16x32_bf16 v[72:75], v[184:187], v[156:159], v[72:75]
    s_waitcnt lgkmcnt(11)
    ds_read_b128 v[124:127], v45 offset:2112
    ds_read_b64 v[96:97], v44 offset:896
    s_add_u32 s75, s55, 180224
    buffer_load_dwordx4 v2, s[40:43], s75 offen offset:0 sc1 lds
    v_mfma_f32_16x16x32_bf16 v[76:79], v[152:155], v[196:199], v[76:79]
    ds_read_b64 v[98:99], v44 offset:904
    v_mfma_f32_16x16x32_bf16 v[76:79], v[160:163], v[188:191], v[76:79]
    buffer_load_dwordx4 v2, s[40:43], s75 offen offset:1024 sc1 lds
    v_mfma_f32_16x16x32_bf16 v[76:79], v[168:171], v[180:183], v[76:79]
    s_waitcnt vmcnt(14) lgkmcnt(5)
    s_barrier
    v_mfma_f32_16x16x32_bf16 v[76:79], v[176:179], v[172:175], v[76:79]
    ds_read_b128 v[116:119], v45 offset:1600
    ds_read_b64 v[104:105], v44 offset:1408
    v_mfma_f32_16x16x32_bf16 v[76:79], v[184:187], v[164:167], v[76:79]
    ds_read_b64_tr_b16 a[192:193], v54 offset:12352
    v_mfma_f32_16x16x32_bf16 v[76:79], v[192:195], v[156:159], v[76:79]
    ds_read_b64 v[106:107], v44 offset:1416
    ds_read_b64_tr_b16 a[194:195], v54 offset:13120
    v_mfma_f32_16x16x32_bf16 v[80:83], v[152:155], v[204:207], v[80:83]
    ds_read_b128 v[108:111], v45 offset:1088
    v_mfma_f32_16x16x32_bf16 v[80:83], v[160:163], v[196:199], v[80:83]
    ds_read_b64_tr_b16 a[196:197], v54 offset:15440
    ds_read_b64 v[112:113], v44 offset:1920
    v_mfma_f32_16x16x32_bf16 v[80:83], v[168:171], v[188:191], v[80:83]
    ds_read_b64 v[114:115], v44 offset:1928
    v_mfma_f32_16x16x32_bf16 v[80:83], v[176:179], v[180:183], v[80:83]
    ds_read_b64_tr_b16 a[198:199], v54 offset:16208
    v_mfma_f32_16x16x32_bf16 v[80:83], v[184:187], v[172:175], v[80:83]
    ds_read_b128 v[100:103], v45 offset:576
    v_mfma_f32_16x16x32_bf16 v[80:83], v[192:195], v[164:167], v[80:83]
    ds_read_b64_tr_b16 a[200:201], v55 offset:12352
    ds_read_b64 v[120:121], v44 offset:2432
    v_mfma_f32_16x16x32_bf16 v[80:83], v[200:203], v[156:159], v[80:83]
    s_waitcnt lgkmcnt(15)
    ds_read_b128 v[132:135], v45 offset:2624
    v_mfma_f32_16x16x32_bf16 v[84:87], v[152:155], v[212:215], v[84:87]
    ds_read_b64_tr_b16 a[202:203], v55 offset:13120
    ds_read_b64 v[122:123], v44 offset:2440
    v_mfma_f32_16x16x32_bf16 v[84:87], v[160:163], v[204:207], v[84:87]
    ds_read_b64 v[128:129], v44 offset:2944
    ds_read_b128 v[92:95], v45 offset:64
    v_mfma_f32_16x16x32_bf16 v[84:87], v[168:171], v[196:199], v[84:87]
    ds_read_b128 v[140:143], v45 offset:3136
    v_mfma_f32_16x16x32_bf16 v[84:87], v[176:179], v[188:191], v[84:87]
    ds_read_b64 v[130:131], v44 offset:2952
    v_mfma_f32_16x16x32_bf16 v[84:87], v[184:187], v[180:183], v[84:87]
    ds_read_b64 v[136:137], v44 offset:3456
    ds_read_b128 v[148:151], v45 offset:3648
    v_mfma_f32_16x16x32_bf16 v[84:87], v[192:195], v[172:175], v[84:87]
    s_waitcnt vmcnt(11) lgkmcnt(7)
    s_barrier
    v_mfma_f32_16x16x32_bf16 v[84:87], v[200:203], v[164:167], v[84:87]
    ds_read_b64 v[138:139], v44 offset:3464
    ds_read_b64_tr_b16 a[204:205], v54 offset:24704
    v_mfma_f32_16x16x32_bf16 v[84:87], v[208:211], v[156:159], v[84:87]
    s_waitcnt lgkmcnt(6)
    ds_read_b64 v[144:145], v44 offset:3968
    v_mfma_f32_16x16x32_bf16 v[72:75], v[88:91], v[124:127], v[72:75]
    ds_read_b64 v[152:153], v44 offset:448
    ds_read_b64_tr_b16 a[206:207], v54 offset:25472
    v_mfma_f32_16x16x32_bf16 v[72:75], v[96:99], v[116:119], v[72:75]
    ds_read_b64 v[146:147], v44 offset:3976
    v_mfma_f32_16x16x32_bf16 v[72:75], v[104:107], v[108:111], v[72:75]
    ds_read_b64 v[154:155], v44 offset:456
    ds_read_b64_tr_b16 a[208:209], v54 offset:27792
    v_mfma_f32_16x16x32_bf16 v[72:75], v[112:115], v[100:103], v[72:75]
    ds_read_b128 v[188:191], v45 offset:2048
    v_mfma_f32_16x16x32_bf16 v[72:75], v[120:123], v[92:95], v[72:75]
    s_waitcnt lgkmcnt(11)
    ds_read_b64 v[160:161], v44 offset:960
    ds_read_b64_tr_b16 a[210:211], v54 offset:28560
    v_mfma_f32_16x16x32_bf16 v[76:79], v[88:91], v[132:135], v[76:79]
    ds_read_b64 v[162:163], v44 offset:968
    v_mfma_f32_16x16x32_bf16 v[76:79], v[96:99], v[124:127], v[76:79]
    ds_read_b64_tr_b16 a[212:213], v55 offset:24704
    v_mfma_f32_16x16x32_bf16 v[76:79], v[104:107], v[116:119], v[76:79]
    ds_read_b128 v[180:183], v45 offset:1536
    v_mfma_f32_16x16x32_bf16 v[76:79], v[112:115], v[108:111], v[76:79]
    buffer_load_dwordx2 v[12:13], v27, s[40:43], 0 offen sc1
    v_mfma_f32_16x16x32_bf16 v[76:79], v[120:123], v[100:103], v[76:79]
    ds_read_b64 v[168:169], v44 offset:1472
    ds_read_b64_tr_b16 a[214:215], v55 offset:25472
    v_mfma_f32_16x16x32_bf16 v[76:79], v[128:131], v[92:95], v[76:79]
    s_waitcnt lgkmcnt(15)
    ds_read_b64 v[170:171], v44 offset:1480
    v_mfma_f32_16x16x32_bf16 v[80:83], v[88:91], v[140:143], v[80:83]
    ds_read_b128 v[172:175], v45 offset:1024
    v_mfma_f32_16x16x32_bf16 v[80:83], v[96:99], v[132:135], v[80:83]
    ds_read_b64 v[176:177], v44 offset:1984
    v_mfma_f32_16x16x32_bf16 v[80:83], v[104:107], v[124:127], v[80:83]
    ds_read_b64 v[178:179], v44 offset:1992
    v_mfma_f32_16x16x32_bf16 v[80:83], v[112:115], v[116:119], v[80:83]
    s_waitcnt vmcnt(8) lgkmcnt(4)
    s_barrier
    v_mfma_f32_16x16x32_bf16 v[80:83], v[120:123], v[108:111], v[80:83]
    ds_read_b128 v[164:167], v45 offset:512
    ds_read_b64_tr_b16 a[216:217], v54 offset:37056
    v_mfma_f32_16x16x32_bf16 v[80:83], v[128:131], v[100:103], v[80:83]
    ds_read_b64 v[184:185], v44 offset:2496
    ds_read_b128 v[196:199], v45 offset:2560
    v_mfma_f32_16x16x32_bf16 v[80:83], v[136:139], v[92:95], v[80:83]
    ds_read_b64_tr_b16 a[218:219], v54 offset:37824
    v_mfma_f32_16x16x32_bf16 v[84:87], v[88:91], v[148:151], v[84:87]
    ds_read_b64 v[186:187], v44 offset:2504
    v_mfma_f32_16x16x32_bf16 v[84:87], v[96:99], v[140:143], v[84:87]
    ds_read_b64 v[192:193], v44 offset:3008
    ds_read_b128 v[156:159], v45 offset:0
    v_mfma_f32_16x16x32_bf16 v[84:87], v[104:107], v[132:135], v[84:87]
    ds_read_b64_tr_b16 a[220:221], v54 offset:40144
    ds_read_b128 v[204:207], v45 offset:3072
    v_mfma_f32_16x16x32_bf16 v[84:87], v[112:115], v[124:127], v[84:87]
    ds_read_b64_tr_b16 a[222:223], v54 offset:40912
    ds_read_b64 v[194:195], v44 offset:3016
    v_mfma_f32_16x16x32_bf16 v[84:87], v[120:123], v[116:119], v[84:87]
    ds_read_b64 v[200:201], v44 offset:3520
    ds_read_b128 v[212:215], v45 offset:3584
    v_mfma_f32_16x16x32_bf16 v[84:87], v[128:131], v[108:111], v[84:87]
    ds_read_b64_tr_b16 a[224:225], v55 offset:37056
    v_mfma_f32_16x16x32_bf16 v[84:87], v[136:139], v[100:103], v[84:87]
    ds_read_b64 v[202:203], v44 offset:3528
    v_mfma_f32_16x16x32_bf16 v[84:87], v[144:147], v[92:95], v[84:87]
    s_waitcnt lgkmcnt(8)
    ds_read_b64_tr_b16 a[226:227], v55 offset:37824
    ds_read_b64 v[208:209], v44 offset:4032
    v_mfma_f32_16x16x32_bf16 v[72:75], v[152:155], v[188:191], v[72:75]
    ds_read_b64 v[210:211], v44 offset:4040
    v_mfma_f32_16x16x32_bf16 v[72:75], v[160:163], v[180:183], v[72:75]
    v_mfma_f32_16x16x32_bf16 v[72:75], v[168:171], v[172:175], v[72:75]
    v_mfma_f32_16x16x32_bf16 v[72:75], v[176:179], v[164:167], v[72:75]
    v_mfma_f32_16x16x32_bf16 v[72:75], v[184:187], v[156:159], v[72:75]
    s_waitcnt lgkmcnt(2) vmcnt(1)
    s_barrier
    v_mfma_f32_16x16x32_bf16 v[76:79], v[152:155], v[196:199], v[76:79]
    ds_read_b64 v[120:121], v47 offset:0
    ds_read_b64_tr_b16 a[228:229], v54 offset:49408
    v_mfma_f32_16x16x32_bf16 v[76:79], v[160:163], v[188:191], v[76:79]
    ds_read_b64 v[122:123], v47 offset:2048
    v_mfma_f32_16x16x32_bf16 v[76:79], v[168:171], v[180:183], v[76:79]
    ds_read_b64 v[124:125], v47 offset:4096
    v_mfma_f32_16x16x32_bf16 v[76:79], v[176:179], v[172:175], v[76:79]
    ds_read_b64_tr_b16 a[230:231], v54 offset:50176
    v_mfma_f32_16x16x32_bf16 v[76:79], v[184:187], v[164:167], v[76:79]
    s_waitcnt vmcnt(0)
    ds_read_b64 v[126:127], v47 offset:6144
    v_mfma_f32_16x16x32_bf16 v[76:79], v[192:195], v[156:159], v[76:79]
    ds_read_b128 v[216:219], v48 offset:0
    v_cmp_ne_u64 vcc, v[10:11], v[12:13]
    v_mfma_f32_16x16x32_bf16 v[80:83], v[152:155], v[204:207], v[80:83]
    ds_read_b128 v[220:223], v48 offset:1024
    ds_read_b64_tr_b16 a[232:233], v54 offset:52496
    v_mfma_f32_16x16x32_bf16 v[80:83], v[160:163], v[196:199], v[80:83]
    ds_read_b128 v[224:227], v48 offset:2048
    v_mfma_f32_16x16x32_bf16 v[80:83], v[168:171], v[188:191], v[80:83]
    s_cbranch_vccnz L_spin18
L_ok17:
    v_mfma_f32_16x16x32_bf16 v[80:83], v[176:179], v[180:183], v[80:83]
    s_waitcnt lgkmcnt(10)
    ds_read_b128 v[228:231], v48 offset:3072
    ds_read_b64_tr_b16 a[234:235], v54 offset:53264
    v_mfma_f32_16x16x32_bf16 v[80:83], v[184:187], v[172:175], v[80:83]
    s_add_u32 m0, s84, 81920
    ds_read_b128 v[232:235], v48 offset:4096
    v_mfma_f32_16x16x32_bf16 v[80:83], v[192:195], v[164:167], v[80:83]
    buffer_load_dwordx4 v2, s[40:43], s79 offen offset:0 sc1 lds
    v_mfma_f32_16x16x32_bf16 v[80:83], v[200:203], v[156:159], v[80:83]
    ds_read_b128 v[236:239], v48 offset:5120
    ds_read_b128 v[240:243], v48 offset:6144
    v_mfma_f32_16x16x32_bf16 v[84:87], v[152:155], v[212:215], v[84:87]
    ds_read_b64_tr_b16 a[236:237], v55 offset:49408
    ds_read_b128 v[244:247], v48 offset:7168
    v_mfma_f32_16x16x32_bf16 v[84:87], v[160:163], v[204:207], v[84:87]
    ds_read_b64 v[128:129], v46 offset:2048
    v_mfma_f32_16x16x32_bf16 v[84:87], v[168:171], v[196:199], v[84:87]
    buffer_load_dwordx4 v2, s[40:43], s79 offen offset:1024 sc1 lds
    v_mfma_f32_16x16x32_bf16 v[84:87], v[176:179], v[188:191], v[84:87]
    ds_read_b64_tr_b16 a[238:239], v55 offset:50176
    ds_read_b64 v[130:131], v46 offset:2560
    ds_read_b64 v[132:133], v46 offset:3072
    v_mfma_f32_16x16x32_bf16 v[84:87], v[184:187], v[180:183], v[84:87]
    ds_read_b64 v[134:135], v46 offset:3584
    v_mfma_f32_16x16x32_bf16 v[84:87], v[192:195], v[172:175], v[84:87]
    buffer_load_dwordx4 v2, s[40:43], s79 offen offset:2048 sc1 lds
    v_mfma_f32_16x16x32_bf16 v[84:87], v[200:203], v[164:167], v[84:87]
    v_mfma_f32_16x16x32_bf16 v[84:87], v[208:211], v[156:159], v[84:87]
    buffer_load_dwordx4 v2, s[40:43], s79 offen offset:3072 sc1 lds
    s_waitcnt lgkmcnt(3)
    v_lshlrev_b32 v136, 16, v120
    s_add_u32 m0, s84, 98304
    v_and_b32 v137, s59, v120
    v_lshlrev_b32 v138, 16, v121
    v_and_b32 v139, s59, v121
    v_lshlrev_b32 v140, 16, v122
    v_and_b32 v141, s59, v122
    v_lshlrev_b32 v142, 16, v123
    v_and_b32 v143, s59, v123
    v_lshlrev_b32 v144, 16, v124
    v_and_b32 v145, s59, v124
    v_lshlrev_b32 v146, 16, v125
    v_and_b32 v147, s59, v125
    buffer_load_dwordx4 v2, s[40:43], s80 offen offset:0 sc1 lds
    v_lshlrev_b32 v148, 16, v126
    v_and_b32 v149, s59, v126
    v_lshlrev_b32 v150, 16, v127
    v_and_b32_e64 v151, s59, v127
    v_pk_fma_f32 v[216:217], v[136:137], v[216:217], v[220:221]
    v_pk_fma_f32 v[218:219], v[138:139], v[218:219], v[222:223]
    v_pk_fma_f32 v[224:225], v[140:141], v[224:225], v[228:229]
    v_pk_fma_f32 v[226:227], v[142:143], v[226:227], v[230:231]
    v_pk_fma_f32 v[232:233], v[144:145], v[232:233], v[236:237]
    v_pk_fma_f32 v[234:235], v[146:147], v[234:235], v[238:239]
    v_pk_fma_f32 v[240:241], v[148:149], v[240:241], v[244:245]
    v_pk_fma_f32 v[242:243], v[150:151], v[242:243], v[246:247]
    buffer_load_dwordx4 v2, s[40:43], s80 offen offset:1024 sc1 lds
    s_waitcnt lgkmcnt(0)
    v_and_b32 v220, s59, v129
    v_lshlrev_b32 v221, 16, v129
    v_and_b32 v222, s59, v128
    v_lshlrev_b32 v223, 16, v128
    v_and_b32 v228, s59, v131
    v_lshlrev_b32 v229, 16, v131
    v_and_b32 v230, s59, v130
    v_lshlrev_b32 v231, 16, v130
    v_and_b32 v236, s59, v133
    v_lshlrev_b32 v237, 16, v133
    v_and_b32 v238, s59, v132
    buffer_load_dwordx4 v2, s[40:43], s80 offen offset:2048 sc1 lds
    v_lshlrev_b32 v239, 16, v132
    v_and_b32 v244, s59, v135
    v_lshlrev_b32 v245, 16, v135
    v_and_b32 v246, s59, v134
    v_lshlrev_b32_e64 v247, 16, v134
    v_pk_fma_f32 v[72:73], v[220:221], s[20:21], v[72:73]
    v_pk_fma_f32 v[74:75], v[222:223], s[20:21], v[74:75]
    v_pk_fma_f32 v[76:77], v[228:229], s[20:21], v[76:77]
    v_pk_fma_f32 v[78:79], v[230:231], s[20:21], v[78:79]
    v_pk_fma_f32 v[80:81], v[236:237], s[20:21], v[80:81]
    v_pk_fma_f32 v[82:83], v[238:239], s[20:21], v[82:83]
    v_pk_fma_f32 v[84:85], v[244:245], s[20:21], v[84:85]
    buffer_load_dwordx4 v2, s[40:43], s80 offen offset:3072 sc1 lds
    v_pk_fma_f32 v[86:87], v[246:247], s[20:21], v[86:87]
    v_pk_fma_f32 v[136:137], v[216:217], v[72:73], v[136:137]
    v_pk_fma_f32 v[138:139], v[218:219], v[74:75], v[138:139]
    v_pk_fma_f32 v[140:141], v[224:225], v[76:77], v[140:141]
    v_pk_fma_f32 v[142:143], v[226:227], v[78:79], v[142:143]
    v_pk_fma_f32 v[144:145], v[232:233], v[80:81], v[144:145]
    v_pk_fma_f32 v[146:147], v[234:235], v[82:83], v[146:147]
    v_pk_fma_f32 v[148:149], v[240:241], v[84:85], v[148:149]
    v_pk_fma_f32 v[150:151], v[242:243], v[86:87], v[150:151]
    v_cvt_pk_bf16_f32 v128, v136, v137
    v_cvt_pk_bf16_f32 v129, v138, v139
    v_cvt_pk_bf16_f32 v130, v140, v141
    v_cvt_pk_bf16_f32 v131, v142, v143
    v_cvt_pk_bf16_f32 v132, v144, v145
    v_cvt_pk_bf16_f32 v133, v146, v147
    v_cvt_pk_bf16_f32 v134, v148, v149
    v_cvt_pk_bf16_f32 v135, v150, v151
    s_add_u32 s74, s31, 1310720
    v_permlane16_swap_b32 v128, v130
    v_permlane16_swap_b32 v129, v131
    buffer_store_dwordx4 v[128:131], v49, s[40:43], s74 offen sc1
    s_add_u32 s74, s31, 1966080
    v_permlane16_swap_b32 v132, v134
    v_permlane16_swap_b32 v133, v135
    buffer_store_dwordx4 v[132:135], v49, s[40:43], s74 offen sc1
L_join:
    s_waitcnt vmcnt(6)
    s_barrier
    ds_read_b64_tr_b16 v[124:125], v16 offset:0
    ds_read_b64_tr_b16 v[126:127], v16 offset:512
    ds_read_b64_tr_b16 v[128:129], v16 offset:4096
    ds_read_b64_tr_b16 v[130:131], v16 offset:4608
    ds_read_b64_tr_b16 v[132:133], v17 offset:0
    ds_read_b64_tr_b16 v[134:135], v17 offset:512
    ds_read_b64_tr_b16 v[136:137], v17 offset:4096
    ds_read_b64_tr_b16 v[138:139], v17 offset:4608
    s_waitcnt lgkmcnt(4)
    v_mfma_f32_16x16x32_bf16 v[76:79], a[0:3], v[124:127], 0
    s_add_u32 m0, s84, 114688
    buffer_load_dwordx2 v[14:15], v29, s[40:43], 0 offen sc1
    v_mfma_f32_16x16x32_bf16 v[76:79], a[12:15], v[128:131], v[76:79]
    ds_read_b64_tr_b16 v[140:141], v18 offset:0
    v_mfma_f32_16x16x32_bf16 v[80:83], a[4:7], v[124:127], 0
    ds_read_b64_tr_b16 v[142:143], v18 offset:512
    v_mfma_f32_16x16x32_bf16 v[80:83], a[16:19], v[128:131], v[80:83]
    ds_read_b64_tr_b16 v[144:145], v18 offset:4096
    v_mfma_f32_16x16x32_bf16 v[84:87], a[8:11], v[124:127], 0
    buffer_load_dwordx4 v2, s[40:43], s81 offen offset:0 sc1 lds
    v_mfma_f32_16x16x32_bf16 v[84:87], a[20:23], v[128:131], v[84:87]
    ds_read_b64_tr_b16 v[146:147], v18 offset:4608
    v_mfma_f32_16x16x32_bf16 v[56:59], v[40:43], v[124:127], 0
    v_mfma_f32_16x16x32_bf16 v[56:59], v[40:43], v[128:131], v[56:59]
    v_mfma_f32_16x16x32_bf16 v[60:63], v[124:127], v[124:127], 0
    ds_read_b64_tr_b16 v[148:149], v19 offset:0
    v_mfma_f32_16x16x32_bf16 v[60:63], v[128:131], v[128:131], v[60:63]
    s_waitcnt lgkmcnt(5)
    buffer_load_dwordx4 v2, s[40:43], s81 offen offset:1024 sc1 lds
    v_mfma_f32_16x16x32_bf16 v[88:91], a[0:3], v[132:135], 0
    ds_read_b64_tr_b16 v[150:151], v19 offset:512
    v_mfma_f32_16x16x32_bf16 v[88:91], a[12:15], v[136:139], v[88:91]
    ds_read_b64_tr_b16 v[152:153], v19 offset:4096
    v_mfma_f32_16x16x32_bf16 v[92:95], a[4:7], v[132:135], 0
    ds_read_b64_tr_b16 v[154:155], v19 offset:4608
    v_mfma_f32_16x16x32_bf16 v[92:95], a[16:19], v[136:139], v[92:95]
    v_mfma_f32_16x16x32_bf16 v[96:99], a[8:11], v[132:135], 0
    ds_read_b64_tr_b16 v[124:125], v16 offset:8192
    v_mfma_f32_16x16x32_bf16 v[96:99], a[20:23], v[136:139], v[96:99]
    s_waitcnt lgkmcnt(5)
    ds_read_b64_tr_b16 v[126:127], v16 offset:8704
    v_mfma_f32_16x16x32_bf16 v[100:103], a[0:3], v[140:143], 0
    ds_read_b64_tr_b16 v[128:129], v16 offset:12288
    v_mfma_f32_16x16x32_bf16 v[100:103], a[12:15], v[144:147], v[100:103]
    ds_read_b64_tr_b16 v[130:131], v16 offset:12800
    v_mfma_f32_16x16x32_bf16 v[104:107], a[4:7], v[140:143], 0
    buffer_load_dwordx4 v2, s[40:43], s81 offen offset:2048 sc1 lds
    v_mfma_f32_16x16x32_bf16 v[104:107], a[16:19], v[144:147], v[104:107]
    v_mfma_f32_16x16x32_bf16 v[108:111], a[8:11], v[140:143], 0
    ds_read_b64_tr_b16 v[132:133], v17 offset:8192
    v_mfma_f32_16x16x32_bf16 v[108:111], a[20:23], v[144:147], v[108:111]
    s_waitcnt lgkmcnt(5)
    ds_read_b64_tr_b16 v[134:135], v17 offset:8704
    v_mfma_f32_16x16x32_bf16 v[112:115], a[0:3], v[148:151], 0
    ds_read_b64_tr_b16 v[136:137], v17 offset:12288
    v_mfma_f32_16x16x32_bf16 v[112:115], a[12:15], v[152:155], v[112:115]
    ds_read_b64_tr_b16 v[138:139], v17 offset:12800
    v_mfma_f32_16x16x32_bf16 v[116:119], a[4:7], v[148:151], 0
    v_mfma_f32_16x16x32_bf16 v[116:119], a[16:19], v[152:155], v[116:119]
    v_mfma_f32_16x16x32_bf16 v[120:123], a[8:11], v[148:151], 0
    ds_read_b64_tr_b16 v[140:141], v18 offset:8192
    v_mfma_f32_16x16x32_bf16 v[120:123], a[20:23], v[152:155], v[120:123]
    s_waitcnt lgkmcnt(5)
    buffer_load_dwordx4 v2, s[40:43], s81 offen offset:3072 sc1 lds
    v_mfma_f32_16x16x32_bf16 v[76:79], a[24:27], v[124:127], v[76:79]
    ds_read_b64_tr_b16 v[142:143], v18 offset:8704
    v_mfma_f32_16x16x32_bf16 v[76:79], a[36:39], v[128:131], v[76:79]
    ds_read_b64_tr_b16 v[144:145], v18 offset:12288
    v_mfma_f32_16x16x32_bf16 v[80:83], a[28:31], v[124:127], v[80:83]
    ds_read_b64_tr_b16 v[146:147], v18 offset:12800
    v_mfma_f32_16x16x32_bf16 v[80:83], a[40:43], v[128:131], v[80:83]
    v_mfma_f32_16x16x32_bf16 v[84:87], a[32:35], v[124:127], v[84:87]
    v_mfma_f32_16x16x32_bf16 v[84:87], a[44:47], v[128:131], v[84:87]
    v_mfma_f32_16x16x32_bf16 v[56:59], v[40:43], v[124:127], v[56:59]
    s_add_u32 m0, s84, 131072
    v_mfma_f32_16x16x32_bf16 v[56:59], v[40:43], v[128:131], v[56:59]
    v_mfma_f32_16x16x32_bf16 v[60:63], v[124:127], v[124:127], v[60:63]
    buffer_load_dwordx4 v2, s[40:43], s82 offen offset:0 sc1 lds
    v_mfma_f32_16x16x32_bf16 v[60:63], v[128:131], v[128:131], v[60:63]
    s_waitcnt lgkmcnt(4)
    ds_read_b64_tr_b16 v[148:149], v19 offset:8192
    v_mfma_f32_16x16x32_bf16 v[88:91], a[24:27], v[132:135], v[88:91]
    ds_read_b64_tr_b16 v[150:151], v19 offset:8704
    v_mfma_f32_16x16x32_bf16 v[88:91], a[36:39], v[136:139], v[88:91]
    ds_read_b64_tr_b16 v[152:153], v19 offset:12288
    v_mfma_f32_16x16x32_bf16 v[92:95], a[28:31], v[132:135], v[92:95]
    ds_read_b64_tr_b16 v[154:155], v19 offset:12800
    v_mfma_f32_16x16x32_bf16 v[92:95], a[40:43], v[136:139], v[92:95]
    s_waitcnt vmcnt(6)
    s_barrier
    v_mfma_f32_16x16x32_bf16 v[96:99], a[32:35], v[132:135], v[96:99]
    buffer_store_dwordx2 v[10:11], v6, s[40:43], 0 offen sc1
    v_mfma_f32_16x16x32_bf16 v[96:99], a[44:47], v[136:139], v[96:99]
    s_waitcnt lgkmcnt(4)
    ds_read_b64_tr_b16 v[124:125], v16 offset:16384
    v_mfma_f32_16x16x32_bf16 v[100:103], a[24:27], v[140:143], v[100:103]
L_pg3:
    s_cbranch_execz L_pgret
    s_waitcnt vmcnt(6)
    ds_read_b64_tr_b16 v[126:127], v16 offset:16896
    v_mfma_f32_16x16x32_bf16 v[100:103], a[36:39], v[144:147], v[100:103]
    ds_read_b64_tr_b16 v[128:129], v16 offset:20480
    v_cmp_ne_u64 vcc, v[10:11], v[14:15]
    v_mfma_f32_16x16x32_bf16 v[104:107], a[28:31], v[140:143], v[104:107]
    buffer_load_dwordx4 v2, s[40:43], s82 offen offset:1024 sc1 lds
    v_mfma_f32_16x16x32_bf16 v[104:107], a[40:43], v[144:147], v[104:107]
    ds_read_b64_tr_b16 v[130:131], v16 offset:20992
    v_mfma_f32_16x16x32_bf16 v[108:111], a[32:35], v[140:143], v[108:111]
    s_cbranch_vccnz L_spin34
L_ok33:
    v_mfma_f32_16x16x32_bf16 v[108:111], a[44:47], v[144:147], v[108:111]
    s_waitcnt lgkmcnt(4)
    ds_read_b64_tr_b16 v[132:133], v17 offset:16384
    v_mfma_f32_16x16x32_bf16 v[112:115], a[24:27], v[148:151], v[112:115]
    buffer_load_dwordx4 v[160:163], v30, s[40:43], s88 offen sc1
    v_mfma_f32_16x16x32_bf16 v[112:115], a[36:39], v[152:155], v[112:115]
    ds_read_b64_tr_b16 v[134:135], v17 offset:16896
    v_mfma_f32_16x16x32_bf16 v[116:119], a[28:31], v[148:151], v[116:119]
    ds_read_b64_tr_b16 v[136:137], v17 offset:20480
    v_mfma_f32_16x16x32_bf16 v[116:119], a[40:43], v[152:155], v[116:119]
    ds_read_b64_tr_b16 v[138:139], v17 offset:20992
    v_mfma_f32_16x16x32_bf16 v[120:123], a[32:35], v[148:151], v[120:123]
    buffer_load_dwordx4 v2, s[40:43], s82 offen offset:2048 sc1 lds
    v_mfma_f32_16x16x32_bf16 v[120:123], a[44:47], v[152:155], v[120:123]
    s_waitcnt lgkmcnt(4)
    ds_read_b64_tr_b16 v[140:141], v18 offset:16384
    v_mfma_f32_16x16x32_bf16 v[76:79], a[48:51], v[124:127], v[76:79]
    ds_read_b64_tr_b16 v[142:143], v18 offset:16896
    v_mfma_f32_16x16x32_bf16 v[76:79], a[60:63], v[128:131], v[76:79]
    ds_read_b64_tr_b16 v[144:145], v18 offset:20480
    v_mfma_f32_16x16x32_bf16 v[80:83], a[52:55], v[124:127], v[80:83]
    buffer_load_dwordx4 v[222:225], v2, s[40:43], s89 offen offset:0 sc1
    v_mfma_f32_16x16x32_bf16 v[80:83], a[64:67], v[128:131], v[80:83]
    ds_read_b64_tr_b16 v[146:147], v18 offset:20992
    v_mfma_f32_16x16x32_bf16 v[84:87], a[56:59], v[124:127], v[84:87]
    v_mfma_f32_16x16x32_bf16 v[84:87], a[68:71], v[128:131], v[84:87]
    v_mfma_f32_16x16x32_bf16 v[56:59], v[40:43], v[124:127], v[56:59]
    buffer_load_dwordx4 v2, s[40:43], s82 offen offset:3072 sc1 lds
    v_mfma_f32_16x16x32_bf16 v[60:63], v[124:127], v[124:127], v[60:63]
    s_waitcnt lgkmcnt(4)
    ds_read_b64_tr_b16 v[148:149], v19 offset:16384
    v_mfma_f32_16x16x32_bf16 v[88:91], a[48:51], v[132:135], v[88:91]
    ds_read_b64_tr_b16 v[150:151], v19 offset:16896
    v_mfma_f32_16x16x32_bf16 v[88:91], a[60:63], v[136:139], v[88:91]
    ds_read_b64_tr_b16 v[152:153], v19 offset:20480
    v_mfma_f32_16x16x32_bf16 v[92:95], a[52:55], v[132:135], v[92:95]
    buffer_load_dwordx4 v[226:229], v2, s[40:43], s89 offen offset:1024 sc1
    v_mfma_f32_16x16x32_bf16 v[92:95], a[64:67], v[136:139], v[92:95]
    ds_read_b64_tr_b16 v[154:155], v19 offset:20992
    v_mfma_f32_16x16x32_bf16 v[96:99], a[56:59], v[132:135], v[96:99]
    ds_read_b64_tr_b16 v[124:125], v16 offset:24576
    v_mfma_f32_16x16x32_bf16 v[96:99], a[68:71], v[136:139], v[96:99]
    s_waitcnt lgkmcnt(5)
    ds_read_b64_tr_b16 v[126:127], v16 offset:25088
    v_mfma_f32_16x16x32_bf16 v[100:103], a[48:51], v[140:143], v[100:103]
    s_add_u32 m0, s84, 147456
    ds_read_b64_tr_b16 v[128:129], v16 offset:28672
    v_cndmask_b32 v58, v60, v61, s[48:49]
    v_mfma_f32_16x16x32_bf16 v[100:103], a[60:63], v[144:147], v[100:103]
    buffer_load_dwordx4 v2, s[40:43], s83 offen offset:0 sc1 lds
    v_mfma_f32_16x16x32_bf16 v[104:107], a[52:55], v[140:143], v[104:107]
    ds_read_b64_tr_b16 v[130:131], v16 offset:29184
    v_mov_b32 v57, v10
    v_mfma_f32_16x16x32_bf16 v[104:107], a[64:67], v[144:147], v[104:107]
    v_cndmask_b32 v58, v58, v62, s[50:51]
    v_mov_b32_e64 v59, v11
    v_mfma_f32_16x16x32_bf16 v[108:111], a[56:59], v[140:143], v[108:111]
    ds_read_b64_tr_b16 v[132:133], v17 offset:24576
    v_cndmask_b32 v58, v58, v63, s[52:53]
    v_mfma_f32_16x16x32_bf16 v[108:111], a[68:71], v[144:147], v[108:111]
    s_waitcnt lgkmcnt(5)
    buffer_store_dwordx4 v[56:59], v26, s[40:43], s85 offen sc1
    v_mfma_f32_16x16x32_bf16 v[112:115], a[48:51], v[148:151], v[112:115]
    ds_read_b64_tr_b16 v[134:135], v17 offset:25088
    v_mfma_f32_16x16x32_bf16 v[112:115], a[60:63], v[152:155], v[112:115]
    ds_read_b64_tr_b16 v[136:137], v17 offset:28672
    v_mfma_f32_16x16x32_bf16 v[116:119], a[52:55], v[148:151], v[116:119]
    ds_read_b64_tr_b16 v[138:139], v17 offset:29184
    v_mfma_f32_16x16x32_bf16 v[116:119], a[64:67], v[152:155], v[116:119]
    buffer_load_dwordx4 v[230:233], v2, s[40:43], s89 offen offset:2048 sc1
    v_mfma_f32_16x16x32_bf16 v[120:123], a[56:59], v[148:151], v[120:123]
    ds_read_b64_tr_b16 v[140:141], v18 offset:24576
    v_mfma_f32_16x16x32_bf16 v[120:123], a[68:71], v[152:155], v[120:123]
    s_waitcnt lgkmcnt(5)
    ds_read_b64_tr_b16 v[142:143], v18 offset:25088
    v_mfma_f32_16x16x32_bf16 v[76:79], a[72:75], v[124:127], v[76:79]
    ds_read_b64_tr_b16 v[144:145], v18 offset:28672
    v_mfma_f32_16x16x32_bf16 v[76:79], a[84:87], v[128:131], v[76:79]
    buffer_load_dwordx4 v2, s[40:43], s83 offen offset:1024 sc1 lds
    v_mfma_f32_16x16x32_bf16 v[80:83], a[76:79], v[124:127], v[80:83]
    ds_read_b64_tr_b16 v[146:147], v18 offset:29184
    v_mfma_f32_16x16x32_bf16 v[80:83], a[88:91], v[128:131], v[80:83]
    v_mfma_f32_16x16x32_bf16 v[84:87], a[80:83], v[124:127], v[84:87]
    ds_read_b64_tr_b16 v[148:149], v19 offset:24576
    v_mfma_f32_16x16x32_bf16 v[84:87], a[92:95], v[128:131], v[84:87]
    s_waitcnt lgkmcnt(5)
    buffer_load_dwordx4 v[234:237], v2, s[40:43], s89 offen offset:3072 sc1
    v_mfma_f32_16x16x32_bf16 v[88:91], a[72:75], v[132:135], v[88:91]
    ds_read_b64_tr_b16 v[150:151], v19 offset:25088
    v_mfma_f32_16x16x32_bf16 v[88:91], a[84:87], v[136:139], v[88:91]
    ds_read_b64_tr_b16 v[152:153], v19 offset:28672
    v_mfma_f32_16x16x32_bf16 v[92:95], a[76:79], v[132:135], v[92:95]
    ds_read_b64_tr_b16 v[154:155], v19 offset:29184
    v_mfma_f32_16x16x32_bf16 v[92:95], a[88:91], v[136:139], v[92:95]
    s_waitcnt vmcnt(13)
    s_barrier
    v_mfma_f32_16x16x32_bf16 v[96:99], a[80:83], v[132:135], v[96:99]
    buffer_load_dwordx4 v2, s[40:43], s83 offen offset:2048 sc1 lds
    v_mfma_f32_16x16x32_bf16 v[96:99], a[92:95], v[136:139], v[96:99]
    s_waitcnt lgkmcnt(4)
    ds_read_b64_tr_b16 v[124:125], v16 offset:32768
    v_mfma_f32_16x16x32_bf16 v[100:103], a[72:75], v[140:143], v[100:103]
    s_add_u32 s89, s89, 4096
    ds_read_b64_tr_b16 v[126:127], v16 offset:33280
    v_mfma_f32_16x16x32_bf16 v[100:103], a[84:87], v[144:147], v[100:103]
    ds_read_b64_tr_b16 v[128:129], v16 offset:36864
    v_mfma_f32_16x16x32_bf16 v[104:107], a[76:79], v[140:143], v[104:107]
    buffer_load_dwordx4 v[238:241], v2, s[40:43], s89 offen offset:0 sc1
    v_mfma_f32_16x16x32_bf16 v[104:107], a[88:91], v[144:147], v[104:107]
    ds_read_b64_tr_b16 v[130:131], v16 offset:37376
    v_mfma_f32_16x16x32_bf16 v[108:111], a[80:83], v[140:143], v[108:111]
    ds_read_b64_tr_b16 v[132:133], v17 offset:32768
    v_mfma_f32_16x16x32_bf16 v[108:111], a[92:95], v[144:147], v[108:111]
    s_waitcnt lgkmcnt(5)
    ds_read_b64_tr_b16 v[134:135], v17 offset:33280
    v_mfma_f32_16x16x32_bf16 v[112:115], a[72:75], v[148:151], v[112:115]
    buffer_load_dwordx4 v2, s[40:43], s83 offen offset:3072 sc1 lds
    v_mfma_f32_16x16x32_bf16 v[112:115], a[84:87], v[152:155], v[112:115]
    ds_read_b64_tr_b16 v[136:137], v17 offset:36864
    v_mfma_f32_16x16x32_bf16 v[116:119], a[76:79], v[148:151], v[116:119]
    ds_read_b64_tr_b16 v[138:139], v17 offset:37376
    v_mfma_f32_16x16x32_bf16 v[116:119], a[88:91], v[152:155], v[116:119]
    v_mfma_f32_16x16x32_bf16 v[120:123], a[80:83], v[148:151], v[120:123]
    ds_read_b64_tr_b16 v[140:141], v18 offset:32768
    v_mfma_f32_16x16x32_bf16 v[120:123], a[92:95], v[152:155], v[120:123]
    s_waitcnt lgkmcnt(5)
    buffer_load_dwordx4 v[242:245], v2, s[40:43], s89 offen offset:1024 sc1
    v_mfma_f32_16x16x32_bf16 v[76:79], a[96:99], v[124:127], v[76:79]
    s_waitcnt vmcnt(13)
    ds_read_b64_tr_b16 v[142:143], v18 offset:33280
    v_mfma_f32_16x16x32_bf16 v[76:79], a[108:111], v[128:131], v[76:79]
    ds_read_b64_tr_b16 v[144:145], v18 offset:36864
    v_mfma_f32_16x16x32_bf16 v[80:83], a[100:103], v[124:127], v[80:83]
    ds_read_b64_tr_b16 v[146:147], v18 offset:37376
    v_mov_b32_dpp v44, v160 row_newbcast:0 row_mask:0xf bank_mask:0xf
    v_mfma_f32_16x16x32_bf16 v[80:83], a[112:115], v[128:131], v[80:83]
    v_mfma_f32_16x16x32_bf16 v[84:87], a[104:107], v[124:127], v[84:87]
    ds_read_b64_tr_b16 v[148:149], v19 offset:32768
    v_mov_b32_dpp v45, v161 row_newbcast:0 row_mask:0xf bank_mask:0xf
    v_mfma_f32_16x16x32_bf16 v[84:87], a[116:119], v[128:131], v[84:87]
    s_waitcnt lgkmcnt(5)
    ds_read_b64_tr_b16 v[150:151], v19 offset:33280
    v_mfma_f32_16x16x32_bf16 v[88:91], a[96:99], v[132:135], v[88:91]
    ds_read_b64_tr_b16 v[152:153], v19 offset:36864
    v_mov_b32_dpp v46, v162 row_newbcast:0 row_mask:0xf bank_mask:0xf
    v_mfma_f32_16x16x32_bf16 v[88:91], a[108:111], v[136:139], v[88:91]
    ds_read_b64_tr_b16 v[154:155], v19 offset:37376
    v_mfma_f32_16x16x32_bf16 v[92:95], a[100:103], v[132:135], v[92:95]
    v_mov_b32_dpp v47, v163 row_newbcast:0 row_mask:0xf bank_mask:0xf
    v_mfma_f32_16x16x32_bf16 v[92:95], a[112:115], v[136:139], v[92:95]
    buffer_load_dwordx4 v[246:249], v2, s[40:43], s89 offen offset:2048 sc1
    v_mfma_f32_16x16x32_bf16 v[96:99], a[104:107], v[132:135], v[96:99]
    ds_read_b64_tr_b16 v[124:125], v16 offset:40960
    v_mov_b32_dpp v48, v160 row_newbcast:1 row_mask:0xf bank_mask:0xf
    v_mfma_f32_16x16x32_bf16 v[96:99], a[116:119], v[136:139], v[96:99]
    s_waitcnt lgkmcnt(5)
    ds_read_b64_tr_b16 v[126:127], v16 offset:41472
    v_mfma_f32_16x16x32_bf16 v[100:103], a[96:99], v[140:143], v[100:103]
    s_movk_i32 s76, 20480
    ds_read_b64_tr_b16 v[128:129], v16 offset:45056
    v_mov_b32_dpp v49, v161 row_newbcast:1 row_mask:0xf bank_mask:0xf
    v_mfma_f32_16x16x32_bf16 v[100:103], a[108:111], v[144:147], v[100:103]
    buffer_load_dwordx2 v[12:13], v27, s[40:43], s76 offen sc1
    v_mfma_f32_16x16x32_bf16 v[104:107], a[100:103], v[140:143], v[104:107]
    ds_read_b64_tr_b16 v[130:131], v16 offset:45568
    v_mov_b32_dpp v50, v162 row_newbcast:1 row_mask:0xf bank_mask:0xf
    v_mfma_f32_16x16x32_bf16 v[104:107], a[112:115], v[144:147], v[104:107]
    v_mov_b32_dpp v51, v163 row_newbcast:1 row_mask:0xf bank_mask:0xf
    v_mfma_f32_16x16x32_bf16 v[108:111], a[104:107], v[140:143], v[108:111]
    ds_read_b64_tr_b16 v[132:133], v17 offset:40960
    v_mfma_f32_16x16x32_bf16 v[108:111], a[116:119], v[144:147], v[108:111]
    s_waitcnt lgkmcnt(5)
    ds_read_b64_tr_b16 v[134:135], v17 offset:41472
    v_mov_b32_dpp v52, v160 row_newbcast:2 row_mask:0xf bank_mask:0xf
    v_mfma_f32_16x16x32_bf16 v[112:115], a[96:99], v[148:151], v[112:115]
    ds_read_b64_tr_b16 v[136:137], v17 offset:45056
    v_mfma_f32_16x16x32_bf16 v[112:115], a[108:111], v[152:155], v[112:115]
    buffer_load_dwordx4 v[250:253], v2, s[40:43], s89 offen offset:3072 sc1
    v_mfma_f32_16x16x32_bf16 v[116:119], a[100:103], v[148:151], v[116:119]
    ds_read_b64_tr_b16 v[138:139], v17 offset:45568
    v_mov_b32_dpp v53, v161 row_newbcast:2 row_mask:0xf bank_mask:0xf
    v_mfma_f32_16x16x32_bf16 v[116:119], a[112:115], v[152:155], v[116:119]
    v_mov_b32_dpp v54, v162 row_newbcast:2 row_mask:0xf bank_mask:0xf
    v_mfma_f32_16x16x32_bf16 v[120:123], a[104:107], v[148:151], v[120:123]
    ds_read_b64_tr_b16 v[140:141], v18 offset:40960
    v_mfma_f32_16x16x32_bf16 v[120:123], a[116:119], v[152:155], v[120:123]
    s_waitcnt lgkmcnt(5)
    ds_read_b64_tr_b16 v[142:143], v18 offset:41472
    v_mov_b32_dpp v55, v163 row_newbcast:2 row_mask:0xf bank_mask:0xf
    v_mfma_f32_16x16x32_bf16 v[76:79], a[120:123], v[124:127], v[76:79]
    ds_read_b64_tr_b16 v[144:145], v18 offset:45056
    v_mfma_f32_16x16x32_bf16 v[76:79], a[132:135], v[128:131], v[76:79]
    ds_read_b64_tr_b16 v[146:147], v18 offset:45568
    v_mfma_f32_16x16x32_bf16 v[80:83], a[124:127], v[124:127], v[80:83]
    s_add_u32 s89, s89, 4096
    v_mfma_f32_16x16x32_bf16 v[80:83], a[136:139], v[128:131], v[80:83]
    v_mfma_f32_16x16x32_bf16 v[84:87], a[128:131], v[124:127], v[84:87]
    ds_read_b64_tr_b16 v[148:149], v19 offset:40960
    v_mfma_f32_16x16x32_bf16 v[84:87], a[140:143], v[128:131], v[84:87]
    s_waitcnt lgkmcnt(5)
    buffer_load_dwordx4 a[240:243], v2, s[40:43], s89 offen offset:0 sc1
    v_mfma_f32_16x16x32_bf16 v[88:91], a[120:123], v[132:135], v[88:91]
    ds_read_b64_tr_b16 v[150:151], v19 offset:41472
    v_mfma_f32_16x16x32_bf16 v[88:91], a[132:135], v[136:139], v[88:91]
    ds_read_b64_tr_b16 v[152:153], v19 offset:45056
    v_mfma_f32_16x16x32_bf16 v[92:95], a[124:127], v[132:135], v[92:95]
    ds_read_b64_tr_b16 v[154:155], v19 offset:45568
    v_mfma_f32_16x16x32_bf16 v[92:95], a[136:139], v[136:139], v[92:95]
    s_waitcnt vmcnt(14)
    s_barrier
    v_mfma_f32_16x16x32_bf16 v[96:99], a[128:131], v[132:135], v[96:99]
    buffer_load_dwordx4 v[156:159], v2, s[40:43], s85 offen offset:0 sc1
    v_mfma_f32_16x16x32_bf16 v[96:99], a[140:143], v[136:139], v[96:99]
    s_waitcnt lgkmcnt(4)
    ds_read_b64_tr_b16 v[124:125], v16 offset:49152
    v_mfma_f32_16x16x32_bf16 v[100:103], a[120:123], v[140:143], v[100:103]
    ds_read_b64_tr_b16 v[126:127], v16 offset:49664
    v_mfma_f32_16x16x32_bf16 v[100:103], a[132:135], v[144:147], v[100:103]
    ds_read_b64_tr_b16 v[128:129], v16 offset:53248
    v_mfma_f32_16x16x32_bf16 v[104:107], a[124:127], v[140:143], v[104:107]
    ds_read_b64_tr_b16 v[130:131], v16 offset:53760
    v_mfma_f32_16x16x32_bf16 v[104:107], a[136:139], v[144:147], v[104:107]
    buffer_load_dwordx4 a[244:247], v2, s[40:43], s89 offen offset:1024 sc1
    v_mfma_f32_16x16x32_bf16 v[108:111], a[128:131], v[140:143], v[108:111]
    ds_read_b64_tr_b16 v[132:133], v17 offset:49152
    v_mfma_f32_16x16x32_bf16 v[108:111], a[140:143], v[144:147], v[108:111]
    s_waitcnt lgkmcnt(5)
    ds_read_b64_tr_b16 v[134:135], v17 offset:49664
    v_mfma_f32_16x16x32_bf16 v[112:115], a[120:123], v[148:151], v[112:115]
    ds_read_b64_tr_b16 v[136:137], v17 offset:53248
    v_mfma_f32_16x16x32_bf16 v[112:115], a[132:135], v[152:155], v[112:115]
    ds_read_b64_tr_b16 v[138:139], v17 offset:53760
    v_mfma_f32_16x16x32_bf16 v[116:119], a[124:127], v[148:151], v[116:119]
    v_mfma_f32_16x16x32_bf16 v[116:119], a[136:139], v[152:155], v[116:119]
    v_mfma_f32_16x16x32_bf16 v[120:123], a[128:131], v[148:151], v[120:123]
    ds_read_b64_tr_b16 v[140:141], v18 offset:49152
    v_mfma_f32_16x16x32_bf16 v[120:123], a[140:143], v[152:155], v[120:123]
    s_waitcnt lgkmcnt(5)
    ds_read_b64_tr_b16 v[142:143], v18 offset:49664
    v_mfma_f32_16x16x32_bf16 v[76:79], a[144:147], v[124:127], v[76:79]
    s_waitcnt vmcnt(4)
    ds_read_b64_tr_b16 v[144:145], v18 offset:53248
    v_mfma_f32_16x16x32_bf16 v[76:79], a[156:159], v[128:131], v[76:79]
    ds_read_b64_tr_b16 v[146:147], v18 offset:53760
    v_cmp_ne_u64 vcc, v[10:11], v[12:13]
    v_mfma_f32_16x16x32_bf16 v[80:83], a[148:151], v[124:127], v[80:83]
    v_mfma_f32_16x16x32_bf16 v[80:83], a[160:163], v[128:131], v[80:83]
    v_mfma_f32_16x16x32_bf16 v[84:87], a[152:155], v[124:127], v[84:87]
    s_cbranch_vccnz L_spin38
L_ok37:
    v_mfma_f32_16x16x32_bf16 v[84:87], a[164:167], v[128:131], v[84:87]
    s_waitcnt lgkmcnt(4)
    ds_read_b64_tr_b16 v[148:149], v19 offset:49152
    s_add_u32 m0, s84, 0
    v_mfma_f32_16x16x32_bf16 v[88:91], a[144:147], v[132:135], v[88:91]
    buffer_load_dwordx4 v3, s[40:43], s79 offen offset:0 sc1 lds
    v_mfma_f32_16x16x32_bf16 v[88:91], a[156:159], v[136:139], v[88:91]
    ds_read_b64_tr_b16 v[150:151], v19 offset:49664
    v_mfma_f32_16x16x32_bf16 v[92:95], a[148:151], v[132:135], v[92:95]
    ds_read_b64_tr_b16 v[152:153], v19 offset:53248
    v_mfma_f32_16x16x32_bf16 v[92:95], a[160:163], v[136:139], v[92:95]
    ds_read_b64_tr_b16 v[154:155], v19 offset:53760
    v_mfma_f32_16x16x32_bf16 v[96:99], a[152:155], v[132:135], v[96:99]
    buffer_load_dwordx4 v3, s[40:43], s79 offen offset:1024 sc1 lds
    v_mfma_f32_16x16x32_bf16 v[96:99], a[164:167], v[136:139], v[96:99]
    s_waitcnt lgkmcnt(4)
    ds_read_b64_tr_b16 v[124:125], v16 offset:57344
    v_mfma_f32_16x16x32_bf16 v[100:103], a[144:147], v[140:143], v[100:103]
    ds_read_b64_tr_b16 v[126:127], v16 offset:57856
    v_mfma_f32_16x16x32_bf16 v[100:103], a[156:159], v[144:147], v[100:103]
    ds_read_b64_tr_b16 v[128:129], v16 offset:61440
    v_mfma_f32_16x16x32_bf16 v[104:107], a[148:151], v[140:143], v[104:107]
    buffer_load_dwordx4 v3, s[40:43], s79 offen offset:2048 sc1 lds
    v_mfma_f32_16x16x32_bf16 v[104:107], a[160:163], v[144:147], v[104:107]
    ds_read_b64_tr_b16 v[130:131], v16 offset:61952
    v_mfma_f32_16x16x32_bf16 v[108:111], a[152:155], v[140:143], v[108:111]
    ds_read_b64_tr_b16 v[132:133], v17 offset:57344
    v_mfma_f32_16x16x32_bf16 v[108:111], a[164:167], v[144:147], v[108:111]
    s_waitcnt lgkmcnt(5)
    ds_read_b64_tr_b16 v[134:135], v17 offset:57856
    v_mfma_f32_16x16x32_bf16 v[112:115], a[144:147], v[148:151], v[112:115]
    ds_read_b64_tr_b16 v[136:137], v17 offset:61440
    v_mfma_f32_16x16x32_bf16 v[112:115], a[156:159], v[152:155], v[112:115]
    buffer_load_dwordx4 v3, s[40:43], s79 offen offset:3072 sc1 lds
    v_mfma_f32_16x16x32_bf16 v[116:119], a[148:151], v[148:151], v[116:119]
    ds_read_b64_tr_b16 v[138:139], v17 offset:61952
    v_mfma_f32_16x16x32_bf16 v[116:119], a[160:163], v[152:155], v[116:119]
    v_mfma_f32_16x16x32_bf16 v[120:123], a[152:155], v[148:151], v[120:123]
    ds_read_b64_tr_b16 v[140:141], v18 offset:57344
    v_mfma_f32_16x16x32_bf16 v[120:123], a[164:167], v[152:155], v[120:123]
    s_waitcnt lgkmcnt(5)
    ds_read_b64_tr_b16 v[142:143], v18 offset:57856
    v_mfma_f32_16x16x32_bf16 v[76:79], a[168:171], v[124:127], v[76:79]
    s_add_u32 m0, s84, 16384
    ds_read_b64_tr_b16 v[144:145], v18 offset:61440
    v_mfma_f32_16x16x32_bf16 v[76:79], a[180:183], v[128:131], v[76:79]
    buffer_load_dwordx4 v3, s[40:43], s80 offen offset:0 sc1 lds
    v_mfma_f32_16x16x32_bf16 v[80:83], a[172:175], v[124:127], v[80:83]
    ds_read_b64_tr_b16 v[146:147], v18 offset:61952
    v_mfma_f32_16x16x32_bf16 v[80:83], a[184:187], v[128:131], v[80:83]
    v_mfma_f32_16x16x32_bf16 v[84:87], a[176:179], v[124:127], v[84:87]
    ds_read_b64_tr_b16 v[148:149], v19 offset:57344
    v_mfma_f32_16x16x32_bf16 v[84:87], a[188:191], v[128:131], v[84:87]
    s_waitcnt lgkmcnt(5)
    ds_read_b64_tr_b16 v[150:151], v19 offset:57856
    v_mfma_f32_16x16x32_bf16 v[88:91], a[168:171], v[132:135], v[88:91]
    s_waitcnt vmcnt(6)
    ds_read_b64_tr_b16 v[152:153], v19 offset:61440
    v_mfma_f32_16x16x32_bf16 v[88:91], a[180:183], v[136:139], v[88:91]
    buffer_load_dwordx4 v3, s[40:43], s80 offen offset:1024 sc1 lds
    v_mfma_f32_16x16x32_bf16 v[92:95], a[172:175], v[132:135], v[92:95]
    ds_read_b64_tr_b16 v[154:155], v19 offset:61952
    v_xor_b32 v157, v10, v157
    v_mfma_f32_16x16x32_bf16 v[92:95], a[184:187], v[136:139], v[92:95]
    s_barrier
    v_mfma_f32_16x16x32_bf16 v[96:99], a[176:179], v[132:135], v[96:99]
    v_add_u32 v16, 0x10000, v16
    v_bitop3_b32 v157, v159, v11, v157 bitop3:0xbe
    v_mfma_f32_16x16x32_bf16 v[96:99], a[188:191], v[136:139], v[96:99]
    s_waitcnt lgkmcnt(4)
    ds_read_b64_tr_b16 v[124:125], v16 offset:0
    v_cmp_ne_u32 vcc, 0, v157
    v_mfma_f32_16x16x32_bf16 v[100:103], a[168:171], v[140:143], v[100:103]
    ds_read_b64_tr_b16 v[126:127], v16 offset:512
    v_mfma_f32_16x16x32_bf16 v[100:103], a[180:183], v[144:147], v[100:103]
    buffer_load_dwordx4 v3, s[40:43], s80 offen offset:2048 sc1 lds
    v_mfma_f32_16x16x32_bf16 v[104:107], a[172:175], v[140:143], v[104:107]
    s_cbranch_vccnz L_spin42
L_ok41:
    v_mfma_f32_16x16x32_bf16 v[104:107], a[184:187], v[144:147], v[104:107]
    ds_read_b64_tr_b16 v[128:129], v16 offset:4096
    v_mov_b32 v157, v156
    v_mfma_f32_16x16x32_bf16 v[108:111], a[176:179], v[140:143], v[108:111]
    ds_read_b64_tr_b16 v[130:131], v16 offset:4608
    v_add_u32 v17, 0x10000, v17
    v_mfma_f32_16x16x32_bf16 v[108:111], a[188:191], v[144:147], v[108:111]
    s_waitcnt lgkmcnt(4)
    ds_read_b64_tr_b16 v[132:133], v17 offset:0
    v_mov_b32 v159, v158
    v_mfma_f32_16x16x32_bf16 v[112:115], a[168:171], v[148:151], v[112:115]
    ds_read_b64_tr_b16 v[134:135], v17 offset:512
    v_permlane32_swap_b32 v156, v157
    v_mfma_f32_16x16x32_bf16 v[112:115], a[180:183], v[152:155], v[112:115]
    buffer_load_dwordx4 v3, s[40:43], s80 offen offset:3072 sc1 lds
    v_mfma_f32_16x16x32_bf16 v[116:119], a[172:175], v[148:151], v[116:119]
    ds_read_b64_tr_b16 v[136:137], v17 offset:4096
    v_permlane32_swap_b32 v158, v159
    v_mfma_f32_16x16x32_bf16 v[116:119], a[184:187], v[152:155], v[116:119]
    ds_read_b64_tr_b16 v[138:139], v17 offset:4608
    v_add_f32_e64 v156, v156, v157
    v_mfma_f32_16x16x32_bf16 v[120:123], a[176:179], v[148:151], v[120:123]
    v_add_u32 v18, 0x10000, v18
    v_add_f32 v158, v158, v159
    v_mfma_f32_16x16x32_bf16 v[120:123], a[188:191], v[152:155], v[120:123]
    s_waitcnt lgkmcnt(4)
    ds_read_b64_tr_b16 v[140:141], v18 offset:0
    v_mov_b32_e64 v157, v156
    v_mfma_f32_16x16x32_bf16 v[76:79], a[192:195], v[124:127], v[76:79]
    s_add_u32 m0, s84, 32768
    ds_read_b64_tr_b16 v[142:143], v18 offset:512
    v_mov_b32_e64 v159, v158
    v_mfma_f32_16x16x32_bf16 v[76:79], a[204:207], v[128:131], v[76:79]
    buffer_load_dwordx4 v3, s[40:43], s81 offen offset:0 sc1 lds
    v_mfma_f32_16x16x32_bf16 v[80:83], a[196:199], v[124:127], v[80:83]
    ds_read_b64_tr_b16 v[144:145], v18 offset:4096
    v_permlane16_swap_b32 v156, v157
    v_mfma_f32_16x16x32_bf16 v[80:83], a[208:211], v[128:131], v[80:83]
    ds_read_b64_tr_b16 v[146:147], v18 offset:4608
    v_permlane16_swap_b32 v158, v159
    v_mfma_f32_16x16x32_bf16 v[84:87], a[200:203], v[124:127], v[84:87]
    v_add_u32 v19, 0x10000, v19
    v_add_f32_e64 v156, v156, v157
    v_mfma_f32_16x16x32_bf16 v[84:87], a[212:215], v[128:131], v[84:87]
    s_waitcnt lgkmcnt(4)
    ds_read_b64_tr_b16 v[148:149], v19 offset:0
    v_add_f32 v158, v158, v159
    v_mfma_f32_16x16x32_bf16 v[88:91], a[192:195], v[132:135], v[88:91]
    ds_read_b64_tr_b16 v[150:151], v19 offset:512
    v_mul_f32 v196, 0x3acccccd, v156
    v_mfma_f32_16x16x32_bf16 v[88:91], a[204:207], v[136:139], v[88:91]
    buffer_load_dwordx4 v3, s[40:43], s81 offen offset:1024 sc1 lds
    v_mfma_f32_16x16x32_bf16 v[92:95], a[196:199], v[132:135], v[92:95]
    ds_read_b64_tr_b16 v[152:153], v19 offset:4096
    v_mul_f32 v200, 0x3acccccd, v158
    v_mfma_f32_16x16x32_bf16 v[92:95], a[208:211], v[136:139], v[92:95]
    ds_read_b64_tr_b16 v[154:155], v19 offset:4608
    v_fma_f32 v200, -v196, v196, v200
    v_mfma_f32_16x16x32_bf16 v[96:99], a[200:203], v[132:135], v[96:99]
    ds_read_b64_tr_b16 v[124:125], v16 offset:8192
    v_max_f32 v200, 0, v200
    v_mfma_f32_16x16x32_bf16 v[96:99], a[212:215], v[136:139], v[96:99]
    s_waitcnt lgkmcnt(5)
    ds_read_b64_tr_b16 v[126:127], v16 offset:8704
    v_cvt_pk_bf16_f32 v196, v196, v196
    v_mfma_f32_16x16x32_bf16 v[100:103], a[192:195], v[140:143], v[100:103]
    ds_read_b64_tr_b16 v[128:129], v16 offset:12288
    v_lshlrev_b32_e64 v196, 16, v196
    v_mfma_f32_16x16x32_bf16 v[100:103], a[204:207], v[144:147], v[100:103]
    buffer_load_dwordx4 v3, s[40:43], s81 offen offset:2048 sc1 lds
    v_mfma_f32_16x16x32_bf16 v[104:107], a[196:199], v[140:143], v[104:107]
    ds_read_b64_tr_b16 v[130:131], v16 offset:12800
    v_cvt_pk_bf16_f32 v200, v200, v200
    v_mfma_f32_16x16x32_bf16 v[104:107], a[208:211], v[144:147], v[104:107]
    v_lshlrev_b32_e64 v200, 16, v200
    v_add_f32 v200, 0x3727c5ac, v200
    v_mfma_f32_16x16x32_bf16 v[108:111], a[200:203], v[140:143], v[108:111]
    ds_read_b64_tr_b16 v[132:133], v17 offset:8192
    v_cvt_pk_bf16_f32 v200, v200, v200
    v_lshlrev_b32 v200, 16, v200
    v_mfma_f32_16x16x32_bf16 v[108:111], a[212:215], v[144:147], v[108:111]
    s_waitcnt lgkmcnt(5)
    v_sqrt_f32 v200, v200
    v_mfma_f32_16x16x32_bf16 v[112:115], a[192:195], v[148:151], v[112:115]
    ds_read_b64_tr_b16 v[134:135], v17 offset:8704
    v_cvt_pk_bf16_f32 v199, v200, v200
    v_lshlrev_b32 v199, 16, v199
    v_mfma_f32_16x16x32_bf16 v[112:115], a[204:207], v[152:155], v[112:115]
    v_rcp_f32 v200, v199
    v_mfma_f32_16x16x32_bf16 v[116:119], a[196:199], v[148:151], v[116:119]
    buffer_load_dwordx4 v3, s[40:43], s81 offen offset:3072 sc1 lds
    v_mul_f32 v199, v199, v199
    v_mul_f32 v197, 0xc0135761, v200
    v_mfma_f32_16x16x32_bf16 v[116:119], a[208:211], v[152:155], v[116:119]
    ds_read_b64_tr_b16 v[136:137], v17 offset:12288
    v_mul_f32_e64 v198, v200, v200
    v_mul_f32 v200, 0xbdd2d3e8, v200
    v_mfma_f32_16x16x32_bf16 v[120:123], a[200:203], v[148:151], v[120:123]
    ds_read_b64_tr_b16 v[140:141], v18 offset:8192
    v_mul_f32_e64 v198, v198, v200
    v_mfma_f32_16x16x32_bf16 v[120:123], a[212:215], v[152:155], v[120:123]
    s_waitcnt lgkmcnt(4)
    ds_write_b128 v23, v[196:199] offset:0
    s_add_u32 s85, s85, 65536
    v_mfma_f32_16x16x32_bf16 v[76:79], a[216:219], v[124:127], v[76:79]
    s_add_u32 m0, s84, 49152
    ds_read_b64_tr_b16 v[138:139], v17 offset:12800
    v_mfma_f32_16x16x32_bf16 v[76:79], a[228:231], v[128:131], v[76:79]
    buffer_load_dwordx4 v3, s[40:43], s82 offen offset:0 sc1 lds
    v_mfma_f32_16x16x32_bf16 v[80:83], a[220:223], v[124:127], v[80:83]
    ds_read_b64_tr_b16 v[142:143], v18 offset:8704
    v_mfma_f32_16x16x32_bf16 v[80:83], a[232:235], v[128:131], v[80:83]
    ds_read_b64_tr_b16 v[144:145], v18 offset:12288
    v_mfma_f32_16x16x32_bf16 v[84:87], a[224:227], v[124:127], v[84:87]
    ds_read_b64_tr_b16 v[148:149], v19 offset:8192
    v_mfma_f32_16x16x32_bf16 v[84:87], a[236:239], v[128:131], v[84:87]
    s_waitcnt lgkmcnt(3)
    ds_read_b64_tr_b16 v[146:147], v18 offset:12800
    v_mfma_f32_16x16x32_bf16 v[88:91], a[216:219], v[132:135], v[88:91]
    s_barrier
    v_mfma_f32_16x16x32_bf16 v[88:91], a[228:231], v[136:139], v[88:91]
    buffer_load_dwordx4 v3, s[40:43], s82 offen offset:1024 sc1 lds
    v_mfma_f32_16x16x32_bf16 v[92:95], a[220:223], v[132:135], v[92:95]
    ds_read_b64_tr_b16 v[150:151], v19 offset:8704
    v_mfma_f32_16x16x32_bf16 v[92:95], a[232:235], v[136:139], v[92:95]
    ds_read_b64_tr_b16 v[152:153], v19 offset:12288
    ds_read_b128 v[172:175], v24 offset:0
    v_mfma_f32_16x16x32_bf16 v[96:99], a[224:227], v[132:135], v[96:99]
    ds_read_b128 v[176:179], v24 offset:256
    v_mfma_f32_16x16x32_bf16 v[96:99], a[236:239], v[136:139], v[96:99]
    s_waitcnt lgkmcnt(4)
    ds_read_b64_tr_b16 v[154:155], v19 offset:12800
    v_mfma_f32_16x16x32_bf16 v[100:103], a[216:219], v[140:143], v[100:103]
    ds_read_b128 v[180:183], v24 offset:512
    v_mfma_f32_16x16x32_bf16 v[100:103], a[228:231], v[144:147], v[100:103]
    buffer_load_dwordx4 v3, s[40:43], s82 offen offset:2048 sc1 lds
    v_mfma_f32_16x16x32_bf16 v[104:107], a[220:223], v[140:143], v[104:107]
    ds_read_b128 v[184:187], v24 offset:768
    v_mfma_f32_16x16x32_bf16 v[104:107], a[232:235], v[144:147], v[104:107]
    ds_read_b128 v[188:191], v25 offset:0
    v_mfma_f32_16x16x32_bf16 v[108:111], a[224:227], v[140:143], v[108:111]
    ds_read_b128 v[192:195], v25 offset:512
    v_mfma_f32_16x16x32_bf16 v[108:111], a[236:239], v[144:147], v[108:111]
    s_waitcnt lgkmcnt(4)
    v_mfma_f32_16x16x32_bf16 v[112:115], a[216:219], v[148:151], v[112:115]
    v_mfma_f32_16x16x32_bf16 v[112:115], a[228:231], v[152:155], v[112:115]
    buffer_load_dwordx4 v3, s[40:43], s82 offen offset:3072 sc1 lds
    v_mfma_f32_16x16x32_bf16 v[116:119], a[220:223], v[148:151], v[116:119]
    v_mfma_f32_16x16x32_bf16 v[116:119], a[232:235], v[152:155], v[116:119]
    v_mfma_f32_16x16x32_bf16 v[120:123], a[224:227], v[148:151], v[120:123]
    v_mfma_f32_16x16x32_bf16 v[120:123], a[236:239], v[152:155], v[120:123]
    s_waitcnt lgkmcnt(0)
    v_pk_fma_f32 v[76:77], v[44:45], v[172:173], v[76:77] op_sel_hi:[1,0,1] neg_lo:[0,1,0] neg_hi:[0,1,0]
    s_add_u32 m0, s84, 65536
    v_pk_fma_f32 v[78:79], v[46:47], v[172:173], v[78:79] op_sel_hi:[1,0,1] neg_lo:[0,1,0] neg_hi:[0,1,0]
    v_pk_fma_f32 v[80:81], v[48:49], v[172:173], v[80:81] op_sel_hi:[1,0,1] neg_lo:[0,1,0] neg_hi:[0,1,0]
    v_pk_fma_f32 v[82:83], v[50:51], v[172:173], v[82:83] op_sel_hi:[1,0,1] neg_lo:[0,1,0] neg_hi:[0,1,0]
    v_pk_fma_f32 v[84:85], v[52:53], v[172:173], v[84:85] op_sel_hi:[1,0,1] neg_lo:[0,1,0] neg_hi:[0,1,0]
    v_pk_fma_f32 v[86:87], v[54:55], v[172:173], v[86:87] op_sel_hi:[1,0,1] neg_lo:[0,1,0] neg_hi:[0,1,0]
    v_pk_fma_f32 v[88:89], v[44:45], v[176:177], v[88:89] op_sel_hi:[1,0,1] neg_lo:[0,1,0] neg_hi:[0,1,0]
    v_pk_fma_f32 v[90:91], v[46:47], v[176:177], v[90:91] op_sel_hi:[1,0,1] neg_lo:[0,1,0] neg_hi:[0,1,0]
    v_pk_fma_f32 v[92:93], v[48:49], v[176:177], v[92:93] op_sel_hi:[1,0,1] neg_lo:[0,1,0] neg_hi:[0,1,0]
    v_pk_fma_f32 v[94:95], v[50:51], v[176:177], v[94:95] op_sel_hi:[1,0,1] neg_lo:[0,1,0] neg_hi:[0,1,0]
    v_pk_fma_f32 v[96:97], v[52:53], v[176:177], v[96:97] op_sel_hi:[1,0,1] neg_lo:[0,1,0] neg_hi:[0,1,0]
    v_pk_fma_f32 v[98:99], v[54:55], v[176:177], v[98:99] op_sel_hi:[1,0,1] neg_lo:[0,1,0] neg_hi:[0,1,0]
    v_pk_fma_f32 v[100:101], v[44:45], v[180:181], v[100:101] op_sel_hi:[1,0,1] neg_lo:[0,1,0] neg_hi:[0,1,0]
    v_pk_fma_f32 v[102:103], v[46:47], v[180:181], v[102:103] op_sel_hi:[1,0,1] neg_lo:[0,1,0] neg_hi:[0,1,0]
    v_pk_fma_f32 v[104:105], v[48:49], v[180:181], v[104:105] op_sel_hi:[1,0,1] neg_lo:[0,1,0] neg_hi:[0,1,0]
    buffer_load_dwordx4 v3, s[40:43], s83 offen offset:0 sc1 lds
    v_pk_fma_f32 v[106:107], v[50:51], v[180:181], v[106:107] op_sel_hi:[1,0,1] neg_lo:[0,1,0] neg_hi:[0,1,0]
    v_pk_fma_f32 v[108:109], v[52:53], v[180:181], v[108:109] op_sel_hi:[1,0,1] neg_lo:[0,1,0] neg_hi:[0,1,0]
    v_pk_fma_f32 v[110:111], v[54:55], v[180:181], v[110:111] op_sel_hi:[1,0,1] neg_lo:[0,1,0] neg_hi:[0,1,0]
    v_pk_fma_f32 v[112:113], v[44:45], v[184:185], v[112:113] op_sel_hi:[1,0,1] neg_lo:[0,1,0] neg_hi:[0,1,0]
    v_pk_fma_f32 v[114:115], v[46:47], v[184:185], v[114:115] op_sel_hi:[1,0,1] neg_lo:[0,1,0] neg_hi:[0,1,0]
    v_pk_fma_f32 v[116:117], v[48:49], v[184:185], v[116:117] op_sel_hi:[1,0,1] neg_lo:[0,1,0] neg_hi:[0,1,0]
    v_pk_fma_f32 v[118:119], v[50:51], v[184:185], v[118:119] op_sel_hi:[1,0,1] neg_lo:[0,1,0] neg_hi:[0,1,0]
    v_pk_fma_f32 v[120:121], v[52:53], v[184:185], v[120:121] op_sel_hi:[1,0,1] neg_lo:[0,1,0] neg_hi:[0,1,0]
    v_pk_fma_f32 v[122:123], v[54:55], v[184:185], v[122:123] op_sel_hi:[1,0,1] neg_lo:[0,1,0] neg_hi:[0,1,0]
    v_permlane32_swap_b32 v84, v96
    v_permlane32_swap_b32 v85, v97
    v_permlane32_swap_b32 v86, v98
    v_permlane32_swap_b32 v87, v99
    v_permlane32_swap_b32 v108, v120
    buffer_load_dwordx4 v3, s[40:43], s83 offen offset:1024 sc1 lds
    v_permlane32_swap_b32 v109, v121
    v_permlane32_swap_b32 v110, v122
    v_permlane32_swap_b32 v111, v123
    v_pk_mul_f32 v[196:197], v[76:77], v[76:77]
    v_pk_mul_f32 v[200:201], v[78:79], v[78:79]
    v_pk_mul_f32 v[204:205], v[88:89], v[88:89]
    v_pk_mul_f32 v[208:209], v[90:91], v[90:91]
    v_pk_fma_f32 v[196:197], v[196:197], v[174:175], v[172:173] op_sel:[0,0,1] op_sel_hi:[1,0,1]
    v_pk_fma_f32 v[200:201], v[200:201], v[174:175], v[172:173] op_sel:[0,0,1] op_sel_hi:[1,0,1]
    v_pk_fma_f32 v[204:205], v[204:205], v[178:179], v[176:177] op_sel:[0,0,1] op_sel_hi:[1,0,1]
    v_pk_fma_f32 v[208:209], v[208:209], v[178:179], v[176:177] op_sel:[0,0,1] op_sel_hi:[1,0,1]
    v_pk_mul_f32 v[196:197], v[196:197], v[76:77]
    v_pk_mul_f32 v[200:201], v[200:201], v[78:79]
    v_pk_mul_f32 v[204:205], v[204:205], v[88:89]
    buffer_load_dwordx4 v3, s[40:43], s83 offen offset:2048 sc1 lds
    v_pk_mul_f32 v[208:209], v[208:209], v[90:91]
    v_exp_f32 v196, v196
    v_exp_f32 v197, v197
    v_pk_mul_f32 v[198:199], v[76:77], v[80:81]
    v_exp_f32 v200, v200
    v_exp_f32 v201, v201
    v_pk_mul_f32 v[202:203], v[78:79], v[82:83]
    v_exp_f32 v204, v204
    v_exp_f32 v205, v205
    buffer_load_dwordx4 v3, s[40:43], s83 offen offset:3072 sc1 lds
    v_pk_mul_f32 v[206:207], v[88:89], v[92:93]
    v_exp_f32 v208, v208
    v_exp_f32 v209, v209
    v_pk_mul_f32 v[210:211], v[90:91], v[94:95]
    v_pk_fma_f32 v[196:197], v[196:197], v[174:175], v[174:175] op_sel:[0,1,1] op_sel_hi:[1,1,1]
    v_pk_fma_f32 v[200:201], v[200:201], v[174:175], v[174:175] op_sel:[0,1,1] op_sel_hi:[1,1,1]
L_pg4:
    s_cbranch_execz L_pgret
    v_pk_fma_f32 v[204:205], v[204:205], v[178:179], v[178:179] op_sel:[0,1,1] op_sel_hi:[1,1,1]
    v_pk_fma_f32 v[208:209], v[208:209], v[178:179], v[178:179] op_sel:[0,1,1] op_sel_hi:[1,1,1]
    v_rcp_f32 v196, v196
    v_rcp_f32 v197, v197
    s_add_u32 m0, s93, 0
    v_rcp_f32 v200, v200
    v_rcp_f32 v201, v201
    v_rcp_f32 v204, v204
    v_rcp_f32 v205, v205
    v_rcp_f32 v208, v208
    v_rcp_f32 v209, v209
    v_pk_mul_f32 v[196:197], v[196:197], v[198:199]
    v_pk_mul_f32 v[200:201], v[200:201], v[202:203]
    s_add_u32 s71, s92, 0
    v_pk_mul_f32 v[204:205], v[204:205], v[206:207]
    v_pk_mul_f32 v[208:209], v[208:209], v[210:211]
    v_cvt_pk_bf16_f32 v64, v196, v197
    v_cvt_pk_bf16_f32 v65, v200, v201
    v_cvt_pk_bf16_f32 v66, v204, v205
    v_cvt_pk_bf16_f32 v67, v208, v209
    s_nop 0
    v_permlane16_swap_b32 v64, v66
    v_permlane16_swap_b32 v65, v67
    buffer_store_dwordx4 v[64:67], v20, s[40:43], s86 offen offset:0 sc1
    v_pk_mul_f32 v[196:197], v[100:101], v[100:101]
    v_pk_mul_f32 v[200:201], v[102:103], v[102:103]
    v_pk_mul_f32 v[204:205], v[112:113], v[112:113]
    v_pk_mul_f32 v[208:209], v[114:115], v[114:115]
    v_pk_fma_f32 v[196:197], v[196:197], v[182:183], v[180:181] op_sel:[0,0,1] op_sel_hi:[1,0,1]
    buffer_load_dwordx4 v31, s[40:43], s71 offen sc1 lds
    v_pk_fma_f32 v[200:201], v[200:201], v[182:183], v[180:181] op_sel:[0,0,1] op_sel_hi:[1,0,1]
    v_pk_fma_f32 v[204:205], v[204:205], v[186:187], v[184:185] op_sel:[0,0,1] op_sel_hi:[1,0,1]
    v_pk_fma_f32 v[208:209], v[208:209], v[186:187], v[184:185] op_sel:[0,0,1] op_sel_hi:[1,0,1]
    v_pk_mul_f32 v[196:197], v[196:197], v[100:101]
    v_pk_mul_f32 v[200:201], v[200:201], v[102:103]
    v_pk_mul_f32 v[204:205], v[204:205], v[112:113]
    v_pk_mul_f32 v[208:209], v[208:209], v[114:115]
    v_exp_f32 v196, v196
    v_exp_f32 v197, v197
    v_pk_mul_f32 v[198:199], v[100:101], v[104:105]
    v_exp_f32 v200, v200
    s_add_u32 m0, s93, 1024
    v_exp_f32 v201, v201
    v_pk_mul_f32 v[202:203], v[102:103], v[106:107]
    v_exp_f32 v204, v204
    v_exp_f32 v205, v205
    v_pk_mul_f32 v[206:207], v[112:113], v[116:117]
    v_exp_f32 v208, v208
    v_exp_f32 v209, v209
    v_pk_mul_f32 v[210:211], v[114:115], v[118:119]
    v_pk_fma_f32 v[196:197], v[196:197], v[182:183], v[182:183] op_sel:[0,1,1] op_sel_hi:[1,1,1]
    s_add_u32 s71, s92, 2048
    v_pk_fma_f32 v[200:201], v[200:201], v[182:183], v[182:183] op_sel:[0,1,1] op_sel_hi:[1,1,1]
    v_pk_fma_f32 v[204:205], v[204:205], v[186:187], v[186:187] op_sel:[0,1,1] op_sel_hi:[1,1,1]
    v_pk_fma_f32 v[208:209], v[208:209], v[186:187], v[186:187] op_sel:[0,1,1] op_sel_hi:[1,1,1]
    v_rcp_f32 v196, v196
    v_rcp_f32 v197, v197
    v_rcp_f32 v200, v200
    v_rcp_f32 v201, v201
    v_rcp_f32 v204, v204
    v_rcp_f32 v205, v205
    buffer_load_dwordx4 v31, s[40:43], s71 offen sc1 lds
    v_rcp_f32 v208, v208
    v_rcp_f32 v209, v209
    v_pk_mul_f32 v[196:197], v[196:197], v[198:199]
    v_pk_mul_f32 v[200:201], v[200:201], v[202:203]
    v_pk_mul_f32 v[204:205], v[204:205], v[206:207]
    v_pk_mul_f32 v[208:209], v[208:209], v[210:211]
    v_cvt_pk_bf16_f32 v68, v196, v197
    v_cvt_pk_bf16_f32 v69, v200, v201
    v_cvt_pk_bf16_f32 v70, v204, v205
    v_cvt_pk_bf16_f32 v71, v208, v209
    s_nop 0
    v_permlane16_swap_b32 v68, v70
    v_permlane16_swap_b32 v69, v71
    s_nop 0
    s_add_u32 m0, s93, 2048
    buffer_store_dwordx4 v[68:71], v21, s[40:43], s86 offen offset:0 sc1
    v_pk_mul_f32 v[196:197], v[84:85], v[84:85]
    v_pk_mul_f32 v[200:201], v[86:87], v[86:87]
    v_pk_mul_f32 v[204:205], v[108:109], v[108:109]
    v_pk_mul_f32 v[208:209], v[110:111], v[110:111]
    v_pk_fma_f32 v[196:197], v[196:197], v[190:191], v[188:189] op_sel:[0,0,1] op_sel_hi:[1,0,1]
    v_pk_fma_f32 v[200:201], v[200:201], v[190:191], v[188:189] op_sel:[0,0,1] op_sel_hi:[1,0,1]
    v_pk_fma_f32 v[204:205], v[204:205], v[194:195], v[192:193] op_sel:[0,0,1] op_sel_hi:[1,0,1]
    v_pk_fma_f32 v[208:209], v[208:209], v[194:195], v[192:193] op_sel:[0,0,1] op_sel_hi:[1,0,1]
    v_pk_mul_f32 v[196:197], v[196:197], v[84:85]
    v_pk_mul_f32 v[200:201], v[200:201], v[86:87]
    v_pk_mul_f32 v[204:205], v[204:205], v[108:109]
    v_pk_mul_f32 v[208:209], v[208:209], v[110:111]
    v_exp_f32 v196, v196
    s_add_u32 s71, s92, 4096
    v_exp_f32 v197, v197
    v_pk_mul_f32 v[198:199], v[84:85], v[96:97]
    v_exp_f32 v200, v200
    v_exp_f32 v201, v201
    v_pk_mul_f32 v[202:203], v[86:87], v[98:99]
    v_exp_f32 v204, v204
    v_exp_f32 v205, v205
    v_pk_mul_f32 v[206:207], v[108:109], v[120:121]
    buffer_load_dwordx4 v31, s[40:43], s71 offen sc1 lds
    v_exp_f32 v208, v208
    v_exp_f32 v209, v209
    v_pk_mul_f32 v[210:211], v[110:111], v[122:123]
    v_pk_fma_f32 v[196:197], v[196:197], v[190:191], v[190:191] op_sel:[0,1,1] op_sel_hi:[1,1,1]
    v_pk_fma_f32 v[200:201], v[200:201], v[190:191], v[190:191] op_sel:[0,1,1] op_sel_hi:[1,1,1]
    v_pk_fma_f32 v[204:205], v[204:205], v[194:195], v[194:195] op_sel:[0,1,1] op_sel_hi:[1,1,1]
    v_pk_fma_f32 v[208:209], v[208:209], v[194:195], v[194:195] op_sel:[0,1,1] op_sel_hi:[1,1,1]
    v_rcp_f32 v196, v196
    v_rcp_f32 v197, v197
    v_rcp_f32 v200, v200
    v_rcp_f32 v201, v201
    v_rcp_f32 v204, v204
    v_rcp_f32 v205, v205
    v_rcp_f32 v208, v208
    v_rcp_f32 v209, v209
    v_pk_mul_f32 v[196:197], v[196:197], v[198:199]
    v_pk_mul_f32 v[200:201], v[200:201], v[202:203]
    v_pk_mul_f32 v[204:205], v[204:205], v[206:207]
    v_pk_mul_f32 v[208:209], v[208:209], v[210:211]
    v_cvt_pk_bf16_f32 v72, v196, v197
    v_cvt_pk_bf16_f32 v73, v200, v201
    v_cvt_pk_bf16_f32 v74, v204, v205
    v_cvt_pk_bf16_f32 v75, v208, v209
    s_nop 0
    v_permlane16_swap_b32 v72, v74
    v_permlane16_swap_b32 v73, v75
    buffer_store_dwordx4 v[72:75], v22, s[40:43], s86 offen offset:512 sc1
    v_add_u32 v16, 4294819840, v16
    v_add_u32 v17, 4294819840, v17
    v_add_u32 v18, 4294819840, v18
    v_add_u32 v19, 4294819840, v19
    s_waitcnt vmcnt(22)
    s_barrier
    s_nop 0
    ds_read_b64_tr_b16 v[124:125], v16 offset:0
    ds_read_b64_tr_b16 v[126:127], v16 offset:512
    ds_read_b64_tr_b16 v[128:129], v16 offset:4096
    ds_read_b64_tr_b16 v[130:131], v16 offset:4608
    ds_read_b64_tr_b16 v[132:133], v17 offset:0
    ds_read_b64_tr_b16 v[134:135], v17 offset:512
    ds_read_b64_tr_b16 v[136:137], v17 offset:4096
    ds_read_b64_tr_b16 v[138:139], v17 offset:4608
    s_waitcnt lgkmcnt(4)
    v_mfma_f32_16x16x32_bf16 v[76:79], a[0:3], v[124:127], 0
    buffer_load_dwordx4 a[248:251], v2, s[40:43], s89 offen offset:2048 sc1
    v_mfma_f32_16x16x32_bf16 v[76:79], a[12:15], v[128:131], v[76:79]
    ds_read_b64_tr_b16 v[140:141], v18 offset:0
    v_mfma_f32_16x16x32_bf16 v[80:83], a[4:7], v[124:127], 0
    ds_read_b64_tr_b16 v[142:143], v18 offset:512
    v_mfma_f32_16x16x32_bf16 v[80:83], a[16:19], v[128:131], v[80:83]
    ds_read_b64_tr_b16 v[144:145], v18 offset:4096
    v_mfma_f32_16x16x32_bf16 v[84:87], a[8:11], v[124:127], 0
    ds_read_b64_tr_b16 v[146:147], v18 offset:4608
    v_mfma_f32_16x16x32_bf16 v[84:87], a[20:23], v[128:131], v[84:87]
    v_mfma_f32_16x16x32_bf16 v[56:59], v[40:43], v[124:127], 0
    v_mfma_f32_16x16x32_bf16 v[56:59], v[40:43], v[128:131], v[56:59]
    v_mfma_f32_16x16x32_bf16 v[60:63], v[124:127], v[124:127], 0
    ds_read_b64_tr_b16 v[148:149], v19 offset:0
    v_mfma_f32_16x16x32_bf16 v[60:63], v[128:131], v[128:131], v[60:63]
    s_waitcnt lgkmcnt(5)
    ds_read_b64_tr_b16 v[150:151], v19 offset:512
    v_mfma_f32_16x16x32_bf16 v[88:91], a[0:3], v[132:135], 0
    ds_read_b64_tr_b16 v[152:153], v19 offset:4096
    v_mfma_f32_16x16x32_bf16 v[88:91], a[12:15], v[136:139], v[88:91]
    ds_read_b64_tr_b16 v[154:155], v19 offset:4608
    v_mfma_f32_16x16x32_bf16 v[92:95], a[4:7], v[132:135], 0
    v_mfma_f32_16x16x32_bf16 v[92:95], a[16:19], v[136:139], v[92:95]
    v_mfma_f32_16x16x32_bf16 v[96:99], a[8:11], v[132:135], 0
    buffer_load_dwordx4 a[252:255], v2, s[40:43], s89 offen offset:3072 sc1
    v_mfma_f32_16x16x32_bf16 v[96:99], a[20:23], v[136:139], v[96:99]
    s_waitcnt lgkmcnt(4)
    ds_read_b64_tr_b16 v[124:125], v16 offset:8192
    v_mfma_f32_16x16x32_bf16 v[100:103], a[0:3], v[140:143], 0
    ds_read_b64_tr_b16 v[126:127], v16 offset:8704
    v_mfma_f32_16x16x32_bf16 v[100:103], a[12:15], v[144:147], v[100:103]
    ds_read_b64_tr_b16 v[128:129], v16 offset:12288
    v_mfma_f32_16x16x32_bf16 v[104:107], a[4:7], v[140:143], 0
    ds_read_b64_tr_b16 v[130:131], v16 offset:12800
    v_mfma_f32_16x16x32_bf16 v[104:107], a[16:19], v[144:147], v[104:107]
    v_mfma_f32_16x16x32_bf16 v[108:111], a[8:11], v[140:143], 0
    ds_read_b64_tr_b16 v[132:133], v17 offset:8192
    v_mfma_f32_16x16x32_bf16 v[108:111], a[20:23], v[144:147], v[108:111]
    s_waitcnt lgkmcnt(5)
    ds_read_b64_tr_b16 v[134:135], v17 offset:8704
    v_mfma_f32_16x16x32_bf16 v[112:115], a[0:3], v[148:151], 0
    ds_read_b64_tr_b16 v[136:137], v17 offset:12288
    v_mfma_f32_16x16x32_bf16 v[112:115], a[12:15], v[152:155], v[112:115]
    ds_read_b64_tr_b16 v[138:139], v17 offset:12800
    v_mfma_f32_16x16x32_bf16 v[116:119], a[4:7], v[148:151], 0
    v_mfma_f32_16x16x32_bf16 v[116:119], a[16:19], v[152:155], v[116:119]
    v_mfma_f32_16x16x32_bf16 v[120:123], a[8:11], v[148:151], 0
    s_add_u32 s89, s89, 4096
    ds_read_b64_tr_b16 v[140:141], v18 offset:8192
    v_mfma_f32_16x16x32_bf16 v[120:123], a[20:23], v[152:155], v[120:123]
    s_waitcnt lgkmcnt(5)
    ds_read_b64_tr_b16 v[142:143], v18 offset:8704
    v_mfma_f32_16x16x32_bf16 v[76:79], a[24:27], v[124:127], v[76:79]
    buffer_load_dwordx4 a[0:3], v2, s[40:43], s89 offen offset:0 sc1
    v_mfma_f32_16x16x32_bf16 v[76:79], a[36:39], v[128:131], v[76:79]
    ds_read_b64_tr_b16 v[144:145], v18 offset:12288
    v_mfma_f32_16x16x32_bf16 v[80:83], a[28:31], v[124:127], v[80:83]
    ds_read_b64_tr_b16 v[146:147], v18 offset:12800
    v_mfma_f32_16x16x32_bf16 v[80:83], a[40:43], v[128:131], v[80:83]
    v_mfma_f32_16x16x32_bf16 v[84:87], a[32:35], v[124:127], v[84:87]
    v_mfma_f32_16x16x32_bf16 v[84:87], a[44:47], v[128:131], v[84:87]
    buffer_load_dwordx4 a[4:7], v2, s[40:43], s89 offen offset:1024 sc1
    v_mfma_f32_16x16x32_bf16 v[56:59], v[40:43], v[124:127], v[56:59]
    v_mfma_f32_16x16x32_bf16 v[56:59], v[40:43], v[128:131], v[56:59]
    v_mfma_f32_16x16x32_bf16 v[60:63], v[124:127], v[124:127], v[60:63]
    ds_read_b64_tr_b16 v[148:149], v19 offset:8192
    v_mfma_f32_16x16x32_bf16 v[60:63], v[128:131], v[128:131], v[60:63]
    s_waitcnt lgkmcnt(5)
    ds_read_b64_tr_b16 v[150:151], v19 offset:8704
    v_mfma_f32_16x16x32_bf16 v[88:91], a[24:27], v[132:135], v[88:91]
    buffer_load_dwordx4 a[8:11], v2, s[40:43], s89 offen offset:2048 sc1
    v_mfma_f32_16x16x32_bf16 v[88:91], a[36:39], v[136:139], v[88:91]
    ds_read_b64_tr_b16 v[152:153], v19 offset:12288
    v_mfma_f32_16x16x32_bf16 v[92:95], a[28:31], v[132:135], v[92:95]
    ds_read_b64_tr_b16 v[154:155], v19 offset:12800
    v_mfma_f32_16x16x32_bf16 v[92:95], a[40:43], v[136:139], v[92:95]
    s_waitcnt vmcnt(5)
    s_barrier
    v_mfma_f32_16x16x32_bf16 v[96:99], a[32:35], v[132:135], v[96:99]
    buffer_store_dwordx2 v[10:11], v4, s[40:43], s87 offen sc1
    v_mfma_f32_16x16x32_bf16 v[96:99], a[44:47], v[136:139], v[96:99]
    s_waitcnt lgkmcnt(4)
    ds_read_b64_tr_b16 v[124:125], v16 offset:16384
    v_mfma_f32_16x16x32_bf16 v[100:103], a[24:27], v[140:143], v[100:103]
    ds_read_b64_tr_b16 v[126:127], v16 offset:16896
    v_mfma_f32_16x16x32_bf16 v[100:103], a[36:39], v[144:147], v[100:103]
    ds_read_b64_tr_b16 v[128:129], v16 offset:20480
    v_mfma_f32_16x16x32_bf16 v[104:107], a[28:31], v[140:143], v[104:107]
    buffer_load_dwordx4 a[12:15], v2, s[40:43], s89 offen offset:3072 sc1
    v_mfma_f32_16x16x32_bf16 v[104:107], a[40:43], v[144:147], v[104:107]
    s_add_u32 s89, s89, 4096
    ds_read_b64_tr_b16 v[130:131], v16 offset:20992
    v_mfma_f32_16x16x32_bf16 v[108:111], a[32:35], v[140:143], v[108:111]
    ds_read_b64_tr_b16 v[132:133], v17 offset:16384
    v_mfma_f32_16x16x32_bf16 v[108:111], a[44:47], v[144:147], v[108:111]
    s_waitcnt lgkmcnt(5)
    ds_read_b64_tr_b16 v[134:135], v17 offset:16896
    v_mfma_f32_16x16x32_bf16 v[112:115], a[24:27], v[148:151], v[112:115]
    buffer_load_dwordx4 a[16:19], v2, s[40:43], s89 offen offset:0 sc1
    v_mfma_f32_16x16x32_bf16 v[112:115], a[36:39], v[152:155], v[112:115]
    ds_read_b64_tr_b16 v[136:137], v17 offset:20480
    v_mfma_f32_16x16x32_bf16 v[116:119], a[28:31], v[148:151], v[116:119]
    ds_read_b64_tr_b16 v[138:139], v17 offset:20992
    v_mfma_f32_16x16x32_bf16 v[116:119], a[40:43], v[152:155], v[116:119]
    v_mfma_f32_16x16x32_bf16 v[120:123], a[32:35], v[148:151], v[120:123]
    buffer_load_dwordx4 a[20:23], v2, s[40:43], s89 offen offset:1024 sc1
    v_mfma_f32_16x16x32_bf16 v[120:123], a[44:47], v[152:155], v[120:123]
    s_waitcnt lgkmcnt(4)
    ds_read_b64_tr_b16 v[140:141], v18 offset:16384
    v_mfma_f32_16x16x32_bf16 v[76:79], a[48:51], v[124:127], v[76:79]
    s_add_u32 s87, s87, 32768
    ds_read_b64_tr_b16 v[142:143], v18 offset:16896
    v_mfma_f32_16x16x32_bf16 v[76:79], a[60:63], v[128:131], v[76:79]
    ds_read_b64_tr_b16 v[144:145], v18 offset:20480
    v_mfma_f32_16x16x32_bf16 v[80:83], a[52:55], v[124:127], v[80:83]
    buffer_load_dwordx4 a[24:27], v2, s[40:43], s89 offen offset:2048 sc1
    v_mfma_f32_16x16x32_bf16 v[80:83], a[64:67], v[128:131], v[80:83]
    ds_read_b64_tr_b16 v[146:147], v18 offset:20992
    v_mfma_f32_16x16x32_bf16 v[84:87], a[56:59], v[124:127], v[84:87]
    v_mfma_f32_16x16x32_bf16 v[84:87], a[68:71], v[128:131], v[84:87]
    s_add_u32 s86, s86, 3145728
    v_mfma_f32_16x16x32_bf16 v[56:59], v[40:43], v[124:127], v[56:59]
    buffer_load_dwordx4 a[28:31], v2, s[40:43], s89 offen offset:3072 sc1
    v_mfma_f32_16x16x32_bf16 v[60:63], v[124:127], v[124:127], v[60:63]
    s_waitcnt lgkmcnt(4)
    ds_read_b64_tr_b16 v[148:149], v19 offset:16384
    v_mfma_f32_16x16x32_bf16 v[88:91], a[48:51], v[132:135], v[88:91]
    s_add_u32 s89, s89, 4096
    ds_read_b64_tr_b16 v[150:151], v19 offset:16896
    v_mfma_f32_16x16x32_bf16 v[88:91], a[60:63], v[136:139], v[88:91]
    ds_read_b64_tr_b16 v[152:153], v19 offset:20480
    v_mfma_f32_16x16x32_bf16 v[92:95], a[52:55], v[132:135], v[92:95]
    buffer_load_dwordx4 a[32:35], v2, s[40:43], s89 offen offset:0 sc1
    v_mfma_f32_16x16x32_bf16 v[92:95], a[64:67], v[136:139], v[92:95]
    ds_read_b64_tr_b16 v[154:155], v19 offset:20992
    v_mfma_f32_16x16x32_bf16 v[96:99], a[56:59], v[132:135], v[96:99]
    ds_read_b64_tr_b16 v[124:125], v16 offset:24576
    v_mfma_f32_16x16x32_bf16 v[96:99], a[68:71], v[136:139], v[96:99]
    s_waitcnt lgkmcnt(5)
    ds_read_b64_tr_b16 v[126:127], v16 offset:25088
    v_mfma_f32_16x16x32_bf16 v[100:103], a[48:51], v[140:143], v[100:103]
    buffer_load_dwordx4 a[36:39], v2, s[40:43], s89 offen offset:1024 sc1
    v_mfma_f32_16x16x32_bf16 v[100:103], a[60:63], v[144:147], v[100:103]
    ds_read_b64_tr_b16 v[128:129], v16 offset:28672
    v_cndmask_b32 v58, v60, v61, s[48:49]
    v_mfma_f32_16x16x32_bf16 v[104:107], a[52:55], v[140:143], v[104:107]
    ds_read_b64_tr_b16 v[130:131], v16 offset:29184
    v_mov_b32 v57, v10
    v_mfma_f32_16x16x32_bf16 v[104:107], a[64:67], v[144:147], v[104:107]
    v_cndmask_b32 v58, v58, v62, s[50:51]
    v_mov_b32_e64 v59, v11
    v_mfma_f32_16x16x32_bf16 v[108:111], a[56:59], v[140:143], v[108:111]
    ds_read_b64_tr_b16 v[132:133], v17 offset:24576
    v_cndmask_b32 v58, v58, v63, s[52:53]
    v_mfma_f32_16x16x32_bf16 v[108:111], a[68:71], v[144:147], v[108:111]
    s_waitcnt lgkmcnt(5)
    buffer_store_dwordx4 v[56:59], v26, s[40:43], s85 offen sc1
    v_mfma_f32_16x16x32_bf16 v[112:115], a[48:51], v[148:151], v[112:115]
    ds_read_b64_tr_b16 v[134:135], v17 offset:25088
    v_mfma_f32_16x16x32_bf16 v[112:115], a[60:63], v[152:155], v[112:115]
    ds_read_b64_tr_b16 v[136:137], v17 offset:28672
    v_mfma_f32_16x16x32_bf16 v[116:119], a[52:55], v[148:151], v[116:119]
    ds_read_b64_tr_b16 v[138:139], v17 offset:29184
    v_mfma_f32_16x16x32_bf16 v[116:119], a[64:67], v[152:155], v[116:119]
    buffer_load_dwordx4 a[40:43], v2, s[40:43], s89 offen offset:2048 sc1
    v_mfma_f32_16x16x32_bf16 v[120:123], a[56:59], v[148:151], v[120:123]
    ds_read_b64_tr_b16 v[140:141], v18 offset:24576
    v_mfma_f32_16x16x32_bf16 v[120:123], a[68:71], v[152:155], v[120:123]
    s_waitcnt lgkmcnt(5)
    ds_read_b64_tr_b16 v[142:143], v18 offset:25088
    v_mfma_f32_16x16x32_bf16 v[76:79], a[72:75], v[124:127], v[76:79]
    ds_read_b64_tr_b16 v[144:145], v18 offset:28672
    v_mfma_f32_16x16x32_bf16 v[76:79], a[84:87], v[128:131], v[76:79]
    buffer_load_dwordx4 a[44:47], v2, s[40:43], s89 offen offset:3072 sc1
    v_mfma_f32_16x16x32_bf16 v[80:83], a[76:79], v[124:127], v[80:83]
    s_add_u32 s89, s89, 4096
    ds_read_b64_tr_b16 v[146:147], v18 offset:29184
    v_mfma_f32_16x16x32_bf16 v[80:83], a[88:91], v[128:131], v[80:83]
    v_mfma_f32_16x16x32_bf16 v[84:87], a[80:83], v[124:127], v[84:87]
    ds_read_b64_tr_b16 v[148:149], v19 offset:24576
    v_mfma_f32_16x16x32_bf16 v[84:87], a[92:95], v[128:131], v[84:87]
    s_waitcnt lgkmcnt(5)
    buffer_load_dwordx4 a[48:51], v2, s[40:43], s89 offen offset:0 sc1
    v_mfma_f32_16x16x32_bf16 v[88:91], a[72:75], v[132:135], v[88:91]
    ds_read_b64_tr_b16 v[150:151], v19 offset:25088
    v_mfma_f32_16x16x32_bf16 v[88:91], a[84:87], v[136:139], v[88:91]
    ds_read_b64_tr_b16 v[152:153], v19 offset:28672
    v_mfma_f32_16x16x32_bf16 v[92:95], a[76:79], v[132:135], v[92:95]
    ds_read_b64_tr_b16 v[154:155], v19 offset:29184
    v_mfma_f32_16x16x32_bf16 v[92:95], a[88:91], v[136:139], v[92:95]
    s_barrier
    v_mfma_f32_16x16x32_bf16 v[96:99], a[80:83], v[132:135], v[96:99]
    buffer_load_dwordx4 a[52:55], v2, s[40:43], s89 offen offset:1024 sc1
    v_mfma_f32_16x16x32_bf16 v[96:99], a[92:95], v[136:139], v[96:99]
    s_waitcnt lgkmcnt(4)
    ds_read_b64_tr_b16 v[124:125], v16 offset:32768
    v_mfma_f32_16x16x32_bf16 v[100:103], a[72:75], v[140:143], v[100:103]
    ds_read_b64_tr_b16 v[212:213], v32 offset:0
    v_mfma_f32_16x16x32_bf16 v[100:103], a[84:87], v[144:147], v[100:103]
    ds_read_b64_tr_b16 v[126:127], v16 offset:33280
    v_mfma_f32_16x16x32_bf16 v[104:107], a[76:79], v[140:143], v[104:107]
    buffer_load_dwordx4 a[56:59], v2, s[40:43], s89 offen offset:2048 sc1
    v_mfma_f32_16x16x32_bf16 v[104:107], a[88:91], v[144:147], v[104:107]
    ds_read_b64_tr_b16 v[128:129], v16 offset:36864
    v_mfma_f32_16x16x32_bf16 v[108:111], a[80:83], v[140:143], v[108:111]
    ds_read_b64_tr_b16 v[132:133], v17 offset:32768
    v_mfma_f32_16x16x32_bf16 v[108:111], a[92:95], v[144:147], v[108:111]
    s_waitcnt lgkmcnt(5)
    ds_read_b64_tr_b16 v[130:131], v16 offset:37376
    ds_read_b64_tr_b16 v[214:215], v32 offset:1024
    v_mfma_f32_16x16x32_bf16 v[112:115], a[72:75], v[148:151], v[112:115]
    buffer_load_dwordx4 a[60:63], v2, s[40:43], s89 offen offset:3072 sc1
    v_mfma_f32_16x16x32_bf16 v[112:115], a[84:87], v[152:155], v[112:115]
    s_add_u32 s89, s89, 4096
    ds_read_b64_tr_b16 v[134:135], v17 offset:33280
    v_mfma_f32_16x16x32_bf16 v[116:119], a[76:79], v[148:151], v[116:119]
    ds_read_b64_tr_b16 v[136:137], v17 offset:36864
    v_mfma_f32_16x16x32_bf16 v[116:119], a[88:91], v[152:155], v[116:119]
    ds_read_b64_tr_b16 v[138:139], v17 offset:37376
    v_mfma_f32_16x16x32_bf16 v[120:123], a[80:83], v[148:151], v[120:123]
    buffer_load_dwordx4 a[64:67], v2, s[40:43], s89 offen offset:0 sc1
    v_mfma_f32_16x16x32_bf16 v[120:123], a[92:95], v[152:155], v[120:123]
    s_waitcnt lgkmcnt(4)
    ds_read_b64_tr_b16 v[216:217], v32 offset:2048
    ds_read_b64_tr_b16 v[140:141], v18 offset:32768
    v_mfma_f32_16x16x32_bf16 v[76:79], a[96:99], v[124:127], v[76:79]
    ds_read_b64_tr_b16 v[142:143], v18 offset:33280
    v_mfma_f32_16x16x32_bf16 v[76:79], a[108:111], v[128:131], v[76:79]
    ds_read_b64_tr_b16 v[144:145], v18 offset:36864
    v_mfma_f32_16x16x32_bf16 v[80:83], a[100:103], v[124:127], v[80:83]
    buffer_load_dwordx4 a[68:71], v2, s[40:43], s89 offen offset:1024 sc1
    v_mfma_f32_16x16x32_bf16 v[80:83], a[112:115], v[128:131], v[80:83]
    ds_read_b64_tr_b16 v[218:219], v32 offset:3072
    v_mfma_f32_16x16x32_bf16 v[84:87], a[104:107], v[124:127], v[84:87]
    ds_read_b64_tr_b16 v[148:149], v19 offset:32768
    v_mfma_f32_16x16x32_bf16 v[84:87], a[116:119], v[128:131], v[84:87]
    s_waitcnt lgkmcnt(6)
    ds_read_b64_tr_b16 v[146:147], v18 offset:37376
    v_mfma_f32_16x16x32_bf16 v[88:91], a[96:99], v[132:135], v[88:91]
    buffer_load_dwordx4 a[72:75], v2, s[40:43], s89 offen offset:2048 sc1
    v_mfma_f32_16x16x32_bf16 v[88:91], a[108:111], v[136:139], v[88:91]
    ds_read_b64_tr_b16 v[150:151], v19 offset:33280
    v_mfma_f32_16x16x32_bf16 v[92:95], a[100:103], v[132:135], v[92:95]
    ds_read_b64_tr_b16 v[220:221], v32 offset:4096
    v_mfma_f32_16x16x32_bf16 v[92:95], a[112:115], v[136:139], v[92:95]
    ds_read_b64_tr_b16 v[152:153], v19 offset:36864
    v_mfma_f32_16x16x32_bf16 v[96:99], a[104:107], v[132:135], v[96:99]
    buffer_load_dwordx4 a[76:79], v2, s[40:43], s89 offen offset:3072 sc1
    v_mfma_f32_16x16x32_bf16 v[96:99], a[116:119], v[136:139], v[96:99]
    s_waitcnt lgkmcnt(3)
    ds_read_b64_tr_b16 v[124:125], v16 offset:40960
    ds_read_b64_tr_b16 v[154:155], v19 offset:37376
    v_mfma_f32_16x16x32_bf16 v[100:103], a[96:99], v[140:143], v[100:103]
    ds_read_b64_tr_b16 v[126:127], v16 offset:41472
    v_mfma_f32_16x16x32_bf16 v[100:103], a[108:111], v[144:147], v[100:103]
    s_add_u32 s89, s89, 4096
    ds_read_b64_tr_b16 v[128:129], v16 offset:45056
    v_mfma_f32_16x16x32_bf16 v[104:107], a[100:103], v[140:143], v[104:107]
    ds_read_b64_tr_b16 v[130:131], v16 offset:45568
    v_mfma_f32_16x16x32_bf16 v[104:107], a[112:115], v[144:147], v[104:107]
    buffer_load_dwordx4 a[80:83], v2, s[40:43], s89 offen offset:0 sc1
    v_mfma_f32_16x16x32_bf16 v[108:111], a[104:107], v[140:143], v[108:111]
    ds_read_b64_tr_b16 v[132:133], v17 offset:40960
    v_mfma_f32_16x16x32_bf16 v[108:111], a[116:119], v[144:147], v[108:111]
    s_waitcnt lgkmcnt(4)
    ds_read_b64_tr_b16 v[134:135], v17 offset:41472
    v_mfma_f32_16x16x32_bf16 v[112:115], a[96:99], v[148:151], v[112:115]
    ds_read_b64_tr_b16 v[136:137], v17 offset:45056
    v_mfma_f32_16x16x32_bf16 v[112:115], a[108:111], v[152:155], v[112:115]
    ds_read_b64_tr_b16 v[138:139], v17 offset:45568
    v_mfma_f32_16x16x32_bf16 v[116:119], a[100:103], v[148:151], v[116:119]
    buffer_load_dwordx4 a[84:87], v2, s[40:43], s89 offen offset:1024 sc1
    v_mfma_f32_16x16x32_bf16 v[116:119], a[112:115], v[152:155], v[116:119]
    v_mfma_f32_16x16x32_bf16 v[120:123], a[104:107], v[148:151], v[120:123]
    ds_read_b64_tr_b16 v[140:141], v18 offset:40960
    v_mfma_f32_16x16x32_bf16 v[120:123], a[116:119], v[152:155], v[120:123]
    s_waitcnt lgkmcnt(5)
    ds_read_b64_tr_b16 v[142:143], v18 offset:41472
    v_mfma_f32_16x16x32_bf16 v[76:79], a[120:123], v[124:127], v[76:79]
    buffer_load_dwordx4 a[88:91], v2, s[40:43], s89 offen offset:2048 sc1
    v_mfma_f32_16x16x32_bf16 v[76:79], a[132:135], v[128:131], v[76:79]
    ds_read_b64_tr_b16 v[144:145], v18 offset:45056
    v_mfma_f32_16x16x32_bf16 v[80:83], a[124:127], v[124:127], v[80:83]
    ds_read_b64_tr_b16 v[146:147], v18 offset:45568
    v_mfma_f32_16x16x32_bf16 v[80:83], a[136:139], v[128:131], v[80:83]
    v_mfma_f32_16x16x32_bf16 v[84:87], a[128:131], v[124:127], v[84:87]
    ds_read_b64_tr_b16 v[148:149], v19 offset:40960
    v_mfma_f32_16x16x32_bf16 v[84:87], a[140:143], v[128:131], v[84:87]
    s_waitcnt lgkmcnt(5)
    buffer_load_dwordx4 a[92:95], v2, s[40:43], s89 offen offset:3072 sc1
    v_mfma_f32_16x16x32_bf16 v[88:91], a[120:123], v[132:135], v[88:91]
    ds_read_b64_tr_b16 v[150:151], v19 offset:41472
    v_mfma_f32_16x16x32_bf16 v[88:91], a[132:135], v[136:139], v[88:91]
    s_add_u32 s89, s89, 4096
    ds_read_b64_tr_b16 v[152:153], v19 offset:45056
    v_mfma_f32_16x16x32_bf16 v[92:95], a[124:127], v[132:135], v[92:95]
    ds_read_b64_tr_b16 v[154:155], v19 offset:45568
    v_mfma_f32_16x16x32_bf16 v[92:95], a[136:139], v[136:139], v[92:95]
    s_barrier
    v_mfma_f32_16x16x32_bf16 v[96:99], a[128:131], v[132:135], v[96:99]
    buffer_load_dwordx4 v[156:159], v2, s[40:43], s85 offen offset:0 sc1
    v_mfma_f32_16x16x32_bf16 v[96:99], a[140:143], v[136:139], v[96:99]
    s_waitcnt lgkmcnt(4)
    ds_read_b64_tr_b16 v[124:125], v16 offset:49152
    v_mfma_f32_16x16x32_bf16 v[100:103], a[120:123], v[140:143], v[100:103]
    ds_read_b64_tr_b16 v[126:127], v16 offset:49664
    v_mfma_f32_16x16x32_bf16 v[100:103], a[132:135], v[144:147], v[100:103]
    ds_read_b64_tr_b16 v[128:129], v16 offset:53248
    v_mfma_f32_16x16x32_bf16 v[104:107], a[124:127], v[140:143], v[104:107]
    buffer_load_dwordx4 a[96:99], v2, s[40:43], s89 offen offset:0 sc1
    v_mfma_f32_16x16x32_bf16 v[104:107], a[136:139], v[144:147], v[104:107]
    ds_read_b64_tr_b16 v[130:131], v16 offset:53760
    v_mfma_f32_16x16x32_bf16 v[108:111], a[128:131], v[140:143], v[108:111]
    ds_read_b64_tr_b16 v[132:133], v17 offset:49152
    v_mfma_f32_16x16x32_bf16 v[108:111], a[140:143], v[144:147], v[108:111]
    s_waitcnt lgkmcnt(5)
    ds_read_b64_tr_b16 v[134:135], v17 offset:49664
    v_mfma_f32_16x16x32_bf16 v[112:115], a[120:123], v[148:151], v[112:115]
    buffer_load_dwordx4 a[100:103], v2, s[40:43], s89 offen offset:1024 sc1
    v_mfma_f32_16x16x32_bf16 v[112:115], a[132:135], v[152:155], v[112:115]
    ds_read_b64_tr_b16 v[136:137], v17 offset:53248
    v_mfma_f32_16x16x32_bf16 v[116:119], a[124:127], v[148:151], v[116:119]
    ds_read_b64_tr_b16 v[138:139], v17 offset:53760
    v_mfma_f32_16x16x32_bf16 v[116:119], a[136:139], v[152:155], v[116:119]
    v_mfma_f32_16x16x32_bf16 v[120:123], a[128:131], v[148:151], v[120:123]
    buffer_load_dwordx4 a[104:107], v2, s[40:43], s89 offen offset:2048 sc1
    v_mfma_f32_16x16x32_bf16 v[120:123], a[140:143], v[152:155], v[120:123]
    s_waitcnt lgkmcnt(4)
    ds_read_b64_tr_b16 v[140:141], v18 offset:49152
    v_mfma_f32_16x16x32_bf16 v[76:79], a[144:147], v[124:127], v[76:79]
    ds_read_b64_tr_b16 v[142:143], v18 offset:49664
    v_mfma_f32_16x16x32_bf16 v[76:79], a[156:159], v[128:131], v[76:79]
    ds_read_b64_tr_b16 v[144:145], v18 offset:53248
    v_mfma_f32_16x16x32_bf16 v[80:83], a[148:151], v[124:127], v[80:83]
    buffer_load_dwordx4 a[108:111], v2, s[40:43], s89 offen offset:3072 sc1
    v_mfma_f32_16x16x32_bf16 v[80:83], a[160:163], v[128:131], v[80:83]
    s_add_u32 s89, s89, 4096
    ds_read_b64_tr_b16 v[146:147], v18 offset:53760
    v_mfma_f32_16x16x32_bf16 v[84:87], a[152:155], v[124:127], v[84:87]
    ds_read_b64_tr_b16 v[148:149], v19 offset:49152
    v_mfma_f32_16x16x32_bf16 v[84:87], a[164:167], v[128:131], v[84:87]
    s_waitcnt lgkmcnt(5)
    ds_read_b64_tr_b16 v[150:151], v19 offset:49664
    v_mfma_f32_16x16x32_bf16 v[88:91], a[144:147], v[132:135], v[88:91]
    buffer_load_dwordx4 a[112:115], v2, s[40:43], s89 offen offset:0 sc1
    v_mfma_f32_16x16x32_bf16 v[88:91], a[156:159], v[136:139], v[88:91]
    ds_read_b64_tr_b16 v[152:153], v19 offset:53248
    v_mfma_f32_16x16x32_bf16 v[92:95], a[148:151], v[132:135], v[92:95]
    ds_read_b64_tr_b16 v[154:155], v19 offset:53760
    v_mfma_f32_16x16x32_bf16 v[92:95], a[160:163], v[136:139], v[92:95]
    v_mfma_f32_16x16x32_bf16 v[96:99], a[152:155], v[132:135], v[96:99]
    buffer_load_dwordx4 a[116:119], v2, s[40:43], s89 offen offset:1024 sc1
    v_mfma_f32_16x16x32_bf16 v[96:99], a[164:167], v[136:139], v[96:99]
    s_waitcnt lgkmcnt(4)
    ds_read_b64_tr_b16 v[124:125], v16 offset:57344
    v_mfma_f32_16x16x32_bf16 v[100:103], a[144:147], v[140:143], v[100:103]
    ds_read_b64_tr_b16 v[126:127], v16 offset:57856
    v_mfma_f32_16x16x32_bf16 v[100:103], a[156:159], v[144:147], v[100:103]
    ds_read_b64_tr_b16 v[128:129], v16 offset:61440
    v_mfma_f32_16x16x32_bf16 v[104:107], a[148:151], v[140:143], v[104:107]
    buffer_load_dwordx4 a[120:123], v2, s[40:43], s89 offen offset:2048 sc1
    v_mfma_f32_16x16x32_bf16 v[104:107], a[160:163], v[144:147], v[104:107]
    ds_read_b64_tr_b16 v[130:131], v16 offset:61952
    v_mfma_f32_16x16x32_bf16 v[108:111], a[152:155], v[140:143], v[108:111]
    ds_read_b64_tr_b16 v[132:133], v17 offset:57344
    v_mfma_f32_16x16x32_bf16 v[108:111], a[164:167], v[144:147], v[108:111]
    s_waitcnt lgkmcnt(5)
    ds_read_b64_tr_b16 v[134:135], v17 offset:57856
    v_mfma_f32_16x16x32_bf16 v[112:115], a[144:147], v[148:151], v[112:115]
    buffer_load_dwordx4 a[124:127], v2, s[40:43], s89 offen offset:3072 sc1
    v_mfma_f32_16x16x32_bf16 v[112:115], a[156:159], v[152:155], v[112:115]
    ds_read_b64_tr_b16 v[136:137], v17 offset:61440
    v_mfma_f32_16x16x32_bf16 v[116:119], a[148:151], v[148:151], v[116:119]
    s_add_u32 s89, s89, 4096
    ds_read_b64_tr_b16 v[138:139], v17 offset:61952
    v_mfma_f32_16x16x32_bf16 v[116:119], a[160:163], v[152:155], v[116:119]
    v_mfma_f32_16x16x32_bf16 v[120:123], a[152:155], v[148:151], v[120:123]
    ds_read_b64_tr_b16 v[140:141], v18 offset:57344
    v_mfma_f32_16x16x32_bf16 v[120:123], a[164:167], v[152:155], v[120:123]
    s_waitcnt lgkmcnt(5)
    buffer_load_dwordx4 a[128:131], v2, s[40:43], s89 offen offset:0 sc1
    v_mfma_f32_16x16x32_bf16 v[76:79], a[168:171], v[124:127], v[76:79]
    s_add_u32 s77, s94, 32768
    ds_read_b64_tr_b16 v[142:143], v18 offset:57856
    v_mfma_f32_16x16x32_bf16 v[76:79], a[180:183], v[128:131], v[76:79]
    ds_read_b64_tr_b16 v[144:145], v18 offset:61440
    v_mfma_f32_16x16x32_bf16 v[80:83], a[172:175], v[124:127], v[80:83]
    ds_read_b64_tr_b16 v[146:147], v18 offset:61952
    v_mfma_f32_16x16x32_bf16 v[80:83], a[184:187], v[128:131], v[80:83]
    buffer_load_dwordx2 v[12:13], v28, s[40:43], s94 offen sc1
    v_mfma_f32_16x16x32_bf16 v[84:87], a[176:179], v[124:127], v[84:87]
    ds_read_b64_tr_b16 v[148:149], v19 offset:57344
    v_mfma_f32_16x16x32_bf16 v[84:87], a[188:191], v[128:131], v[84:87]
    s_waitcnt lgkmcnt(5)
    ds_read_b64_tr_b16 v[150:151], v19 offset:57856
    v_mfma_f32_16x16x32_bf16 v[88:91], a[168:171], v[132:135], v[88:91]
    s_waitcnt vmcnt(10)
    ds_read_b64_tr_b16 v[152:153], v19 offset:61440
    v_mfma_f32_16x16x32_bf16 v[88:91], a[180:183], v[136:139], v[88:91]
    buffer_load_dwordx4 a[132:135], v2, s[40:43], s89 offen offset:1024 sc1
    v_mfma_f32_16x16x32_bf16 v[92:95], a[172:175], v[132:135], v[92:95]
    ds_read_b64_tr_b16 v[154:155], v19 offset:61952
    v_xor_b32 v157, v10, v157
    v_mfma_f32_16x16x32_bf16 v[92:95], a[184:187], v[136:139], v[92:95]
    s_barrier
    v_mfma_f32_16x16x32_bf16 v[96:99], a[176:179], v[132:135], v[96:99]
    v_add_u32 v16, 0x10000, v16
    v_bitop3_b32 v157, v159, v11, v157 bitop3:0xbe
    v_mfma_f32_16x16x32_bf16 v[96:99], a[188:191], v[136:139], v[96:99]
    s_waitcnt lgkmcnt(4)
    buffer_load_dwordx4 a[136:139], v2, s[40:43], s89 offen offset:2048 sc1
    v_mfma_f32_16x16x32_bf16 v[100:103], a[168:171], v[140:143], v[100:103]
    ds_read_b64_tr_b16 v[124:125], v16 offset:0
    v_cmp_ne_u32_e64 vcc, 0, v157
L_pg5:
    s_cbranch_execz L_pgret
    v_mfma_f32_16x16x32_bf16 v[100:103], a[180:183], v[144:147], v[100:103]
    ds_read_b64_tr_b16 v[126:127], v16 offset:512
    v_mfma_f32_16x16x32_bf16 v[104:107], a[172:175], v[140:143], v[104:107]
    ds_read_b64_tr_b16 v[128:129], v16 offset:4096
    v_mfma_f32_16x16x32_bf16 v[104:107], a[184:187], v[144:147], v[104:107]
    s_cbranch_vccnz L_spin48
L_ok47:
    v_mfma_f32_16x16x32_bf16 v[108:111], a[176:179], v[140:143], v[108:111]
    buffer_load_dwordx4 a[140:143], v2, s[40:43], s89 offen offset:3072 sc1
    v_mfma_f32_16x16x32_bf16 v[108:111], a[188:191], v[144:147], v[108:111]
    s_waitcnt lgkmcnt(3)
    ds_read_b64_tr_b16 v[130:131], v16 offset:4608
    v_add_u32 v17, 0x10000, v17
    v_mfma_f32_16x16x32_bf16 v[112:115], a[168:171], v[148:151], v[112:115]
    s_add_u32 s89, s89, 4096
    ds_read_b64_tr_b16 v[132:133], v17 offset:0
    v_mov_b32_e64 v157, v156
    v_mfma_f32_16x16x32_bf16 v[112:115], a[180:183], v[152:155], v[112:115]
    ds_read_b64_tr_b16 v[134:135], v17 offset:512
    v_mov_b32_e64 v159, v158
    v_mfma_f32_16x16x32_bf16 v[116:119], a[172:175], v[148:151], v[116:119]
    buffer_load_dwordx4 a[144:147], v2, s[40:43], s89 offen offset:0 sc1
    v_mfma_f32_16x16x32_bf16 v[116:119], a[184:187], v[152:155], v[116:119]
    ds_read_b64_tr_b16 v[136:137], v17 offset:4096
    v_permlane32_swap_b32 v156, v157
    v_mfma_f32_16x16x32_bf16 v[120:123], a[176:179], v[148:151], v[120:123]
    ds_read_b64_tr_b16 v[138:139], v17 offset:4608
    v_add_u32 v18, 0x10000, v18
    v_mfma_f32_16x16x32_bf16 v[120:123], a[188:191], v[152:155], v[120:123]
    s_waitcnt lgkmcnt(4)
    ds_read_b64_tr_b16 v[140:141], v18 offset:0
    v_permlane32_swap_b32 v158, v159
    v_mfma_f32_16x16x32_bf16 v[76:79], a[192:195], v[124:127], v[76:79]
    buffer_load_dwordx4 a[148:151], v2, s[40:43], s89 offen offset:1024 sc1
    v_mfma_f32_16x16x32_bf16 v[76:79], a[204:207], v[128:131], v[76:79]
    ds_read_b64_tr_b16 v[142:143], v18 offset:512
    v_add_f32 v156, v156, v157
    v_mfma_f32_16x16x32_bf16 v[80:83], a[196:199], v[124:127], v[80:83]
    ds_read_b64_tr_b16 v[144:145], v18 offset:4096
    v_add_f32 v158, v158, v159
    v_mfma_f32_16x16x32_bf16 v[80:83], a[208:211], v[128:131], v[80:83]
    ds_read_b64_tr_b16 v[146:147], v18 offset:4608
    v_mov_b32 v157, v156
    v_mfma_f32_16x16x32_bf16 v[84:87], a[200:203], v[124:127], v[84:87]
    buffer_load_dwordx4 a[152:155], v2, s[40:43], s89 offen offset:2048 sc1
    v_mfma_f32_16x16x32_bf16 v[84:87], a[212:215], v[128:131], v[84:87]
    s_waitcnt lgkmcnt(4)
    v_add_u32 v19, 0x10000, v19
    v_mov_b32 v159, v158
    v_mfma_f32_16x16x32_bf16 v[88:91], a[192:195], v[132:135], v[88:91]
    ds_read_b64_tr_b16 v[148:149], v19 offset:0
    v_permlane16_swap_b32 v156, v157
    v_mfma_f32_16x16x32_bf16 v[88:91], a[204:207], v[136:139], v[88:91]
    ds_read_b64_tr_b16 v[150:151], v19 offset:512
    v_permlane16_swap_b32 v158, v159
    v_mfma_f32_16x16x32_bf16 v[92:95], a[196:199], v[132:135], v[92:95]
    buffer_load_dwordx4 a[156:159], v2, s[40:43], s89 offen offset:3072 sc1
    v_mfma_f32_16x16x32_bf16 v[92:95], a[208:211], v[136:139], v[92:95]
    s_add_u32 s89, s89, 4096
    ds_read_b64_tr_b16 v[152:153], v19 offset:4096
    v_add_f32_e64 v156, v156, v157
    v_mfma_f32_16x16x32_bf16 v[96:99], a[200:203], v[132:135], v[96:99]
    ds_read_b64_tr_b16 v[124:125], v16 offset:8192
    v_add_f32 v158, v158, v159
    v_mfma_f32_16x16x32_bf16 v[96:99], a[212:215], v[136:139], v[96:99]
    s_waitcnt lgkmcnt(4)
    ds_read_b64_tr_b16 v[154:155], v19 offset:4608
    v_mul_f32 v196, 0x3acccccd, v156
    v_mfma_f32_16x16x32_bf16 v[100:103], a[192:195], v[140:143], v[100:103]
    buffer_load_dwordx4 a[160:163], v2, s[40:43], s89 offen offset:0 sc1
    v_mul_f32 v200, 0x3acccccd, v158
    v_fma_f32 v200, -v196, v196, v200
    v_mfma_f32_16x16x32_bf16 v[100:103], a[204:207], v[144:147], v[100:103]
    ds_read_b64_tr_b16 v[126:127], v16 offset:8704
    v_max_f32_e64 v200, 0, v200
    v_cvt_pk_bf16_f32 v196, v196, v196
    v_mfma_f32_16x16x32_bf16 v[104:107], a[196:199], v[140:143], v[104:107]
    ds_read_b64_tr_b16 v[128:129], v16 offset:12288
    v_lshlrev_b32_e64 v196, 16, v196
    v_cvt_pk_bf16_f32 v200, v200, v200
    v_mfma_f32_16x16x32_bf16 v[104:107], a[208:211], v[144:147], v[104:107]
    ds_read_b64_tr_b16 v[130:131], v16 offset:12800
    v_lshlrev_b32_e64 v200, 16, v200
    v_add_f32 v200, 0x3727c5ac, v200
    v_mfma_f32_16x16x32_bf16 v[108:111], a[200:203], v[140:143], v[108:111]
    buffer_load_dwordx4 a[164:167], v2, s[40:43], s89 offen offset:1024 sc1
    v_cvt_pk_bf16_f32 v200, v200, v200
    v_lshlrev_b32 v200, 16, v200
    v_mfma_f32_16x16x32_bf16 v[108:111], a[212:215], v[144:147], v[108:111]
    s_waitcnt lgkmcnt(3)
    v_sqrt_f32_e64 v200, v200
    v_mfma_f32_16x16x32_bf16 v[112:115], a[192:195], v[148:151], v[112:115]
    ds_read_b64_tr_b16 v[132:133], v17 offset:8192
    v_cvt_pk_bf16_f32 v199, v200, v200
    v_lshlrev_b32 v199, 16, v199
    v_mfma_f32_16x16x32_bf16 v[112:115], a[204:207], v[152:155], v[112:115]
    v_rcp_f32 v200, v199
    v_mfma_f32_16x16x32_bf16 v[116:119], a[196:199], v[148:151], v[116:119]
    ds_read_b64_tr_b16 v[134:135], v17 offset:8704
    v_mul_f32_e64 v199, v199, v199
    v_mul_f32 v197, 0xc0135761, v200
    v_mfma_f32_16x16x32_bf16 v[116:119], a[208:211], v[152:155], v[116:119]
    buffer_load_dwordx4 a[168:171], v2, s[40:43], s89 offen offset:2048 sc1
    v_mul_f32_e64 v198, v200, v200
    v_mul_f32 v200, 0xbdd2d3e8, v200
    v_mfma_f32_16x16x32_bf16 v[120:123], a[200:203], v[148:151], v[120:123]
    ds_read_b64_tr_b16 v[136:137], v17 offset:12288
    ds_read_b64_tr_b16 v[140:141], v18 offset:8192
    v_mul_f32_e64 v198, v198, v200
    v_mfma_f32_16x16x32_bf16 v[120:123], a[212:215], v[152:155], v[120:123]
    s_waitcnt lgkmcnt(4)
    ds_write_b128 v23, v[196:199] offset:4096
    v_mfma_f32_16x16x32_bf16 v[76:79], a[216:219], v[124:127], v[76:79]
    s_waitcnt vmcnt(10)
    ds_read_b64_tr_b16 v[138:139], v17 offset:12800
    v_mfma_f32_16x16x32_bf16 v[76:79], a[228:231], v[128:131], v[76:79]
    buffer_load_dwordx4 a[172:175], v2, s[40:43], s89 offen offset:3072 sc1
    v_mfma_f32_16x16x32_bf16 v[80:83], a[220:223], v[124:127], v[80:83]
    ds_read_b64_tr_b16 v[142:143], v18 offset:8704
    v_mfma_f32_16x16x32_bf16 v[80:83], a[232:235], v[128:131], v[80:83]
    ds_read_b64_tr_b16 v[144:145], v18 offset:12288
    v_mfma_f32_16x16x32_bf16 v[84:87], a[224:227], v[124:127], v[84:87]
    s_add_u32 s89, s89, 4096
    ds_read_b64_tr_b16 v[148:149], v19 offset:8192
    v_cmp_ne_u64 vcc, v[10:11], v[12:13]
    v_mfma_f32_16x16x32_bf16 v[84:87], a[236:239], v[128:131], v[84:87]
    s_waitcnt lgkmcnt(3)
    ds_read_b64_tr_b16 v[146:147], v18 offset:12800
    v_mfma_f32_16x16x32_bf16 v[88:91], a[216:219], v[132:135], v[88:91]
    s_barrier
    v_mfma_f32_16x16x32_bf16 v[88:91], a[228:231], v[136:139], v[88:91]
    buffer_load_dwordx4 a[176:179], v2, s[40:43], s89 offen offset:0 sc1
    v_mfma_f32_16x16x32_bf16 v[92:95], a[220:223], v[132:135], v[92:95]
    s_cbranch_vccnz L_spin52
L_ok51:
    v_mfma_f32_16x16x32_bf16 v[92:95], a[232:235], v[136:139], v[92:95]
    ds_read_b64_tr_b16 v[150:151], v19 offset:8704
    ds_read_b64_tr_b16 v[152:153], v19 offset:12288
    v_mfma_f32_16x16x32_bf16 v[96:99], a[224:227], v[132:135], v[96:99]
    ds_read_b128 v[172:175], v24 offset:4096
    v_mfma_f32_16x16x32_bf16 v[96:99], a[236:239], v[136:139], v[96:99]
    s_waitcnt lgkmcnt(3)
    buffer_load_dwordx4 a[180:183], v2, s[40:43], s89 offen offset:1024 sc1
    v_mfma_f32_16x16x32_bf16 v[100:103], a[216:219], v[140:143], v[100:103]
    ds_read_b128 v[176:179], v24 offset:4352
    ds_read_b64_tr_b16 v[154:155], v19 offset:12800
    v_mfma_f32_16x16x32_bf16 v[100:103], a[228:231], v[144:147], v[100:103]
    ds_read_b128 v[180:183], v24 offset:4608
    v_mfma_f32_16x16x32_bf16 v[104:107], a[220:223], v[140:143], v[104:107]
    ds_read_b128 v[184:187], v24 offset:4864
    v_mfma_f32_16x16x32_bf16 v[104:107], a[232:235], v[144:147], v[104:107]
    buffer_load_dwordx4 a[184:187], v2, s[40:43], s89 offen offset:2048 sc1
    v_mfma_f32_16x16x32_bf16 v[108:111], a[224:227], v[140:143], v[108:111]
    ds_read_b128 v[188:191], v25 offset:4096
    v_mfma_f32_16x16x32_bf16 v[108:111], a[236:239], v[144:147], v[108:111]
    s_waitcnt lgkmcnt(3)
    ds_read_b128 v[192:195], v25 offset:4608
    v_mfma_f32_16x16x32_bf16 v[112:115], a[216:219], v[148:151], v[112:115]
    v_mfma_f32_16x16x32_bf16 v[112:115], a[228:231], v[152:155], v[112:115]
    v_mfma_f32_16x16x32_bf16 v[116:119], a[220:223], v[148:151], v[116:119]
    buffer_load_dwordx4 a[188:191], v2, s[40:43], s89 offen offset:3072 sc1
    v_mfma_f32_16x16x32_bf16 v[116:119], a[232:235], v[152:155], v[116:119]
    v_mfma_f32_16x16x32_bf16 v[120:123], a[224:227], v[148:151], v[120:123]
    v_mfma_f32_16x16x32_bf16 v[120:123], a[236:239], v[152:155], v[120:123]
    s_waitcnt lgkmcnt(0)
    v_pk_fma_f32 v[76:77], v[44:45], v[172:173], v[76:77] op_sel_hi:[1,0,1] neg_lo:[0,1,0] neg_hi:[0,1,0]
    s_nop 0
    buffer_load_dwordx4 v[124:127], v2, s[40:43], s90 offen offset:0 sc1
    v_pk_fma_f32 v[78:79], v[46:47], v[172:173], v[78:79] op_sel_hi:[1,0,1] neg_lo:[0,1,0] neg_hi:[0,1,0]
    v_pk_fma_f32 v[80:81], v[48:49], v[172:173], v[80:81] op_sel_hi:[1,0,1] neg_lo:[0,1,0] neg_hi:[0,1,0]
    v_pk_fma_f32 v[82:83], v[50:51], v[172:173], v[82:83] op_sel_hi:[1,0,1] neg_lo:[0,1,0] neg_hi:[0,1,0]
    v_pk_fma_f32 v[84:85], v[52:53], v[172:173], v[84:85] op_sel_hi:[1,0,1] neg_lo:[0,1,0] neg_hi:[0,1,0]
    v_pk_fma_f32 v[86:87], v[54:55], v[172:173], v[86:87] op_sel_hi:[1,0,1] neg_lo:[0,1,0] neg_hi:[0,1,0]
    v_pk_fma_f32 v[88:89], v[44:45], v[176:177], v[88:89] op_sel_hi:[1,0,1] neg_lo:[0,1,0] neg_hi:[0,1,0]
    v_pk_fma_f32 v[90:91], v[46:47], v[176:177], v[90:91] op_sel_hi:[1,0,1] neg_lo:[0,1,0] neg_hi:[0,1,0]
    v_pk_fma_f32 v[92:93], v[48:49], v[176:177], v[92:93] op_sel_hi:[1,0,1] neg_lo:[0,1,0] neg_hi:[0,1,0]
    v_pk_fma_f32 v[94:95], v[50:51], v[176:177], v[94:95] op_sel_hi:[1,0,1] neg_lo:[0,1,0] neg_hi:[0,1,0]
    v_pk_fma_f32 v[96:97], v[52:53], v[176:177], v[96:97] op_sel_hi:[1,0,1] neg_lo:[0,1,0] neg_hi:[0,1,0]
    v_pk_fma_f32 v[98:99], v[54:55], v[176:177], v[98:99] op_sel_hi:[1,0,1] neg_lo:[0,1,0] neg_hi:[0,1,0]
    v_pk_fma_f32 v[100:101], v[44:45], v[180:181], v[100:101] op_sel_hi:[1,0,1] neg_lo:[0,1,0] neg_hi:[0,1,0]
    v_pk_fma_f32 v[102:103], v[46:47], v[180:181], v[102:103] op_sel_hi:[1,0,1] neg_lo:[0,1,0] neg_hi:[0,1,0]
    buffer_load_dwordx4 v[128:131], v2, s[40:43], s90 offen offset:1024 sc1
    v_pk_fma_f32 v[104:105], v[48:49], v[180:181], v[104:105] op_sel_hi:[1,0,1] neg_lo:[0,1,0] neg_hi:[0,1,0]
    v_pk_fma_f32 v[106:107], v[50:51], v[180:181], v[106:107] op_sel_hi:[1,0,1] neg_lo:[0,1,0] neg_hi:[0,1,0]
    v_pk_fma_f32 v[108:109], v[52:53], v[180:181], v[108:109] op_sel_hi:[1,0,1] neg_lo:[0,1,0] neg_hi:[0,1,0]
    v_pk_fma_f32 v[110:111], v[54:55], v[180:181], v[110:111] op_sel_hi:[1,0,1] neg_lo:[0,1,0] neg_hi:[0,1,0]
    v_pk_fma_f32 v[112:113], v[44:45], v[184:185], v[112:113] op_sel_hi:[1,0,1] neg_lo:[0,1,0] neg_hi:[0,1,0]
    v_pk_fma_f32 v[114:115], v[46:47], v[184:185], v[114:115] op_sel_hi:[1,0,1] neg_lo:[0,1,0] neg_hi:[0,1,0]
    v_pk_fma_f32 v[116:117], v[48:49], v[184:185], v[116:117] op_sel_hi:[1,0,1] neg_lo:[0,1,0] neg_hi:[0,1,0]
    v_pk_fma_f32 v[118:119], v[50:51], v[184:185], v[118:119] op_sel_hi:[1,0,1] neg_lo:[0,1,0] neg_hi:[0,1,0]
    v_pk_fma_f32 v[120:121], v[52:53], v[184:185], v[120:121] op_sel_hi:[1,0,1] neg_lo:[0,1,0] neg_hi:[0,1,0]
    v_pk_fma_f32 v[122:123], v[54:55], v[184:185], v[122:123] op_sel_hi:[1,0,1] neg_lo:[0,1,0] neg_hi:[0,1,0]
    v_permlane32_swap_b32 v84, v96
    v_permlane32_swap_b32 v85, v97
    v_permlane32_swap_b32 v86, v98
    v_permlane32_swap_b32 v87, v99
    buffer_load_dwordx4 v[132:135], v2, s[40:43], s90 offen offset:2048 sc1
    v_permlane32_swap_b32 v108, v120
    v_permlane32_swap_b32 v109, v121
    v_permlane32_swap_b32 v110, v122
    v_permlane32_swap_b32 v111, v123
    v_pk_mul_f32 v[196:197], v[76:77], v[76:77]
    v_pk_mul_f32 v[200:201], v[78:79], v[78:79]
    v_pk_mul_f32 v[204:205], v[88:89], v[88:89]
    v_pk_mul_f32 v[208:209], v[90:91], v[90:91]
    v_pk_fma_f32 v[196:197], v[196:197], v[174:175], v[172:173] op_sel:[0,0,1] op_sel_hi:[1,0,1]
    v_pk_fma_f32 v[200:201], v[200:201], v[174:175], v[172:173] op_sel:[0,0,1] op_sel_hi:[1,0,1]
    v_pk_fma_f32 v[204:205], v[204:205], v[178:179], v[176:177] op_sel:[0,0,1] op_sel_hi:[1,0,1]
    v_pk_fma_f32 v[208:209], v[208:209], v[178:179], v[176:177] op_sel:[0,0,1] op_sel_hi:[1,0,1]
    v_pk_mul_f32 v[196:197], v[196:197], v[76:77]
    v_pk_mul_f32 v[200:201], v[200:201], v[78:79]
    buffer_load_dwordx4 v[136:139], v2, s[40:43], s90 offen offset:3072 sc1
    s_add_u32 s90, s90, 4096
    v_pk_mul_f32 v[204:205], v[204:205], v[88:89]
    v_pk_mul_f32 v[208:209], v[208:209], v[90:91]
    v_exp_f32 v196, v196
    v_exp_f32 v197, v197
    v_pk_mul_f32 v[198:199], v[76:77], v[80:81]
    v_exp_f32 v200, v200
    v_exp_f32 v201, v201
    v_pk_mul_f32 v[202:203], v[78:79], v[82:83]
    v_exp_f32 v204, v204
    buffer_load_dwordx4 v[140:143], v2, s[40:43], s90 offen offset:0 sc1
    v_exp_f32 v205, v205
    v_pk_mul_f32 v[206:207], v[88:89], v[92:93]
    v_exp_f32 v208, v208
    v_exp_f32 v209, v209
    v_pk_mul_f32 v[210:211], v[90:91], v[94:95]
    v_pk_fma_f32 v[196:197], v[196:197], v[174:175], v[174:175] op_sel:[0,1,1] op_sel_hi:[1,1,1]
    v_pk_fma_f32 v[200:201], v[200:201], v[174:175], v[174:175] op_sel:[0,1,1] op_sel_hi:[1,1,1]
    v_pk_fma_f32 v[204:205], v[204:205], v[178:179], v[178:179] op_sel:[0,1,1] op_sel_hi:[1,1,1]
    v_pk_fma_f32 v[208:209], v[208:209], v[178:179], v[178:179] op_sel:[0,1,1] op_sel_hi:[1,1,1]
    v_rcp_f32 v196, v196
    buffer_load_dwordx4 v[144:147], v2, s[40:43], s90 offen offset:1024 sc1
    v_rcp_f32 v197, v197
    v_rcp_f32 v200, v200
    v_rcp_f32 v201, v201
    v_rcp_f32 v204, v204
    v_rcp_f32 v205, v205
    v_rcp_f32 v208, v208
    v_rcp_f32 v209, v209
    buffer_load_dwordx4 v[148:151], v2, s[40:43], s90 offen offset:2048 sc1
    v_pk_mul_f32 v[196:197], v[196:197], v[198:199]
    v_pk_mul_f32 v[200:201], v[200:201], v[202:203]
    v_pk_mul_f32 v[204:205], v[204:205], v[206:207]
    v_pk_mul_f32 v[208:209], v[208:209], v[210:211]
    v_cvt_pk_bf16_f32 v64, v196, v197
    v_cvt_pk_bf16_f32 v65, v200, v201
    v_cvt_pk_bf16_f32 v66, v204, v205
    v_cvt_pk_bf16_f32 v67, v208, v209
    s_nop 0
    v_permlane16_swap_b32 v64, v66
    v_permlane16_swap_b32 v65, v67
    buffer_store_dwordx4 v[64:67], v20, s[40:43], s86 offen offset:0 sc1
    v_pk_mul_f32 v[196:197], v[100:101], v[100:101]
    v_pk_mul_f32 v[200:201], v[102:103], v[102:103]
    s_nop 0
    buffer_load_dwordx4 v[152:155], v2, s[40:43], s90 offen offset:3072 sc1
    s_add_u32 s90, s90, 4096
    v_pk_mul_f32 v[204:205], v[112:113], v[112:113]
    v_pk_mul_f32 v[208:209], v[114:115], v[114:115]
    v_pk_fma_f32 v[196:197], v[196:197], v[182:183], v[180:181] op_sel:[0,0,1] op_sel_hi:[1,0,1]
    v_pk_fma_f32 v[200:201], v[200:201], v[182:183], v[180:181] op_sel:[0,0,1] op_sel_hi:[1,0,1]
    v_pk_fma_f32 v[204:205], v[204:205], v[186:187], v[184:185] op_sel:[0,0,1] op_sel_hi:[1,0,1]
    v_pk_fma_f32 v[208:209], v[208:209], v[186:187], v[184:185] op_sel:[0,0,1] op_sel_hi:[1,0,1]
    v_pk_mul_f32 v[196:197], v[196:197], v[100:101]
    v_pk_mul_f32 v[200:201], v[200:201], v[102:103]
    v_pk_mul_f32 v[204:205], v[204:205], v[112:113]
    v_pk_mul_f32 v[208:209], v[208:209], v[114:115]
    v_exp_f32 v196, v196
    v_exp_f32 v197, v197
    buffer_load_dwordx4 v[156:159], v2, s[40:43], s90 offen offset:0 sc1
    v_pk_mul_f32 v[198:199], v[100:101], v[104:105]
    v_exp_f32 v200, v200
    v_exp_f32 v201, v201
    v_pk_mul_f32 v[202:203], v[102:103], v[106:107]
    v_exp_f32 v204, v204
    v_exp_f32 v205, v205
    v_pk_mul_f32 v[206:207], v[112:113], v[116:117]
    v_exp_f32 v208, v208
    v_exp_f32 v209, v209
    buffer_load_dwordx4 v[160:163], v2, s[40:43], s90 offen offset:1024 sc1
    v_pk_mul_f32 v[210:211], v[114:115], v[118:119]
    v_pk_fma_f32 v[196:197], v[196:197], v[182:183], v[182:183] op_sel:[0,1,1] op_sel_hi:[1,1,1]
    v_pk_fma_f32 v[200:201], v[200:201], v[182:183], v[182:183] op_sel:[0,1,1] op_sel_hi:[1,1,1]
    v_pk_fma_f32 v[204:205], v[204:205], v[186:187], v[186:187] op_sel:[0,1,1] op_sel_hi:[1,1,1]
    v_pk_fma_f32 v[208:209], v[208:209], v[186:187], v[186:187] op_sel:[0,1,1] op_sel_hi:[1,1,1]
    v_rcp_f32 v196, v196
    v_rcp_f32 v197, v197
    v_rcp_f32 v200, v200
    v_rcp_f32 v201, v201
    buffer_load_dwordx4 v[164:167], v2, s[40:43], s90 offen offset:2048 sc1
    v_rcp_f32 v204, v204
    v_rcp_f32 v205, v205
    v_rcp_f32 v208, v208
    v_rcp_f32 v209, v209
    v_pk_mul_f32 v[196:197], v[196:197], v[198:199]
    v_pk_mul_f32 v[200:201], v[200:201], v[202:203]
    v_pk_mul_f32 v[204:205], v[204:205], v[206:207]
    v_pk_mul_f32 v[208:209], v[208:209], v[210:211]
    v_cvt_pk_bf16_f32 v68, v196, v197
    buffer_load_dwordx4 v[168:171], v2, s[40:43], s90 offen offset:3072 sc1
    s_add_u32 s90, s90, 40960
    v_cvt_pk_bf16_f32 v69, v200, v201
    v_cvt_pk_bf16_f32 v70, v204, v205
    v_cvt_pk_bf16_f32 v71, v208, v209
    s_nop 0
    v_permlane16_swap_b32 v68, v70
    v_permlane16_swap_b32 v69, v71
    buffer_store_dwordx4 v[68:71], v21, s[40:43], s86 offen offset:0 sc1
    s_nop 0
    v_pk_mul_f32 v[196:197], v[84:85], v[84:85]
    v_pk_mul_f32 v[200:201], v[86:87], v[86:87]
    v_pk_mul_f32 v[204:205], v[108:109], v[108:109]
    v_pk_mul_f32 v[208:209], v[110:111], v[110:111]
    v_pk_fma_f32 v[196:197], v[196:197], v[190:191], v[188:189] op_sel:[0,0,1] op_sel_hi:[1,0,1]
    v_pk_fma_f32 v[200:201], v[200:201], v[190:191], v[188:189] op_sel:[0,0,1] op_sel_hi:[1,0,1]
    v_pk_fma_f32 v[204:205], v[204:205], v[194:195], v[192:193] op_sel:[0,0,1] op_sel_hi:[1,0,1]
    v_pk_fma_f32 v[208:209], v[208:209], v[194:195], v[192:193] op_sel:[0,0,1] op_sel_hi:[1,0,1]
    v_pk_mul_f32 v[196:197], v[196:197], v[84:85]
    v_pk_mul_f32 v[200:201], v[200:201], v[86:87]
    v_pk_mul_f32 v[204:205], v[204:205], v[108:109]
    v_pk_mul_f32 v[208:209], v[208:209], v[110:111]
    v_exp_f32 v196, v196
    v_exp_f32 v197, v197
    v_pk_mul_f32 v[198:199], v[84:85], v[96:97]
    v_exp_f32 v200, v200
    v_exp_f32 v201, v201
    v_pk_mul_f32 v[202:203], v[86:87], v[98:99]
    v_exp_f32 v204, v204
    v_exp_f32 v205, v205
    v_pk_mul_f32 v[206:207], v[108:109], v[120:121]
    v_exp_f32 v208, v208
    v_exp_f32 v209, v209
    v_pk_mul_f32 v[210:211], v[110:111], v[122:123]
    v_pk_fma_f32 v[196:197], v[196:197], v[190:191], v[190:191] op_sel:[0,1,1] op_sel_hi:[1,1,1]
    v_pk_fma_f32 v[200:201], v[200:201], v[190:191], v[190:191] op_sel:[0,1,1] op_sel_hi:[1,1,1]
    v_pk_fma_f32 v[204:205], v[204:205], v[194:195], v[194:195] op_sel:[0,1,1] op_sel_hi:[1,1,1]
    v_pk_fma_f32 v[208:209], v[208:209], v[194:195], v[194:195] op_sel:[0,1,1] op_sel_hi:[1,1,1]
    v_rcp_f32 v196, v196
    v_rcp_f32 v197, v197
    v_rcp_f32 v200, v200
    v_rcp_f32 v201, v201
    v_rcp_f32 v204, v204
    v_rcp_f32 v205, v205
    v_rcp_f32 v208, v208
    v_rcp_f32 v209, v209
    v_pk_mul_f32 v[196:197], v[196:197], v[198:199]
    v_pk_mul_f32 v[200:201], v[200:201], v[202:203]
    v_pk_mul_f32 v[204:205], v[204:205], v[206:207]
    v_pk_mul_f32 v[208:209], v[208:209], v[210:211]
    v_cvt_pk_bf16_f32 v72, v196, v197
    v_cvt_pk_bf16_f32 v73, v200, v201
    v_cvt_pk_bf16_f32 v74, v204, v205
    v_cvt_pk_bf16_f32 v75, v208, v209
    s_nop 0
    v_permlane16_swap_b32 v72, v74
    v_permlane16_swap_b32 v73, v75
    buffer_store_dwordx4 v[72:75], v22, s[40:43], s86 offen offset:512 sc1
    s_cmp_eq_u32 s56, 0
    s_cselect_b32 s54, 0x10000, 0
    s_cselect_b32 s55, s59, 0
    v_mul_u32_u24 v172, s54, v212
    v_and_b32 v173, s55, v212
    v_mul_u32_u24 v174, s54, v213
    v_and_b32 v175, s55, v213
    v_mul_u32_u24 v176, s54, v214
    v_and_b32 v177, s55, v214
    v_mul_u32_u24 v178, s54, v215
    v_and_b32 v179, s55, v215
    v_mul_u32_u24 v180, s54, v216
    v_and_b32 v181, s55, v216
    v_mul_u32_u24 v182, s54, v217
    v_and_b32 v183, s55, v217
    v_mul_u32_u24 v184, s54, v218
    v_and_b32 v185, s55, v218
    v_mul_u32_u24 v186, s54, v219
    v_and_b32 v187, s55, v219
    v_mul_u32_u24 v188, s54, v220
    v_and_b32 v189, s55, v220
    v_mul_u32_u24 v190, s54, v221
    v_and_b32 v191, s55, v221
    s_waitcnt vmcnt(13)
    v_mfma_f32_16x16x32_bf16 v[172:175], v[222:225], v[124:127], v[172:175]
    buffer_load_dwordx4 v[76:79], v2, s[40:43], s90 offen offset:0 sc1
    v_mfma_f32_16x16x32_bf16 v[172:175], v[242:245], v[128:131], v[172:175]
    v_mfma_f32_16x16x32_bf16 v[176:179], v[226:229], v[124:127], v[176:179]
    v_mfma_f32_16x16x32_bf16 v[176:179], v[246:249], v[128:131], v[176:179]
    v_mfma_f32_16x16x32_bf16 v[180:183], v[230:233], v[124:127], v[180:183]
    s_cmp_eq_u32 s56, 1
    s_cselect_b32 s54, 0x10000, 0
    s_cselect_b32 s55, s59, 0
    v_mfma_f32_16x16x32_bf16 v[180:183], v[250:253], v[128:131], v[180:183]
    v_mfma_f32_16x16x32_bf16 v[184:187], v[234:237], v[124:127], v[184:187]
    buffer_load_dwordx4 v[80:83], v2, s[40:43], s90 offen offset:1024 sc1
    v_mfma_f32_16x16x32_bf16 v[184:187], a[240:243], v[128:131], v[184:187]
    v_mul_u32_u24_e64 v192, s54, v212
    v_mfma_f32_16x16x32_bf16 v[188:191], v[238:241], v[124:127], v[188:191]
    v_mfma_f32_16x16x32_bf16 v[188:191], a[244:247], v[128:131], v[188:191]
    s_waitcnt vmcnt(13)
    v_and_b32 v193, s55, v212
    v_mfma_f32_16x16x32_bf16 v[172:175], a[248:251], v[132:135], v[172:175]
    v_mfma_f32_16x16x32_bf16 v[172:175], a[12:15], v[136:139], v[172:175]
    buffer_load_dwordx4 v[84:87], v2, s[40:43], s90 offen offset:2048 sc1
    v_mfma_f32_16x16x32_bf16 v[176:179], a[252:255], v[132:135], v[176:179]
    v_mul_u32_u24_e64 v194, s54, v213
    v_mfma_f32_16x16x32_bf16 v[176:179], a[16:19], v[136:139], v[176:179]
    v_and_b32_e64 v195, s55, v213
    v_mfma_f32_16x16x32_bf16 v[180:183], a[0:3], v[132:135], v[180:183]
    v_mfma_f32_16x16x32_bf16 v[180:183], a[20:23], v[136:139], v[180:183]
    v_mfma_f32_16x16x32_bf16 v[184:187], a[4:7], v[132:135], v[184:187]
    buffer_load_dwordx4 v[88:91], v2, s[40:43], s90 offen offset:3072 sc1
    v_mfma_f32_16x16x32_bf16 v[184:187], a[24:27], v[136:139], v[184:187]
    v_mul_u32_u24_e64 v196, s54, v214
    v_mfma_f32_16x16x32_bf16 v[188:191], a[8:11], v[132:135], v[188:191]
    v_and_b32 v197, s55, v214
    v_mfma_f32_16x16x32_bf16 v[188:191], a[28:31], v[136:139], v[188:191]
    s_waitcnt vmcnt(13)
    v_mfma_f32_16x16x32_bf16 v[172:175], a[32:35], v[140:143], v[172:175]
    s_add_u32 s90, s90, 4096
    v_mul_u32_u24_e64 v198, s54, v215
    v_mfma_f32_16x16x32_bf16 v[172:175], a[52:55], v[144:147], v[172:175]
    buffer_load_dwordx4 v[92:95], v2, s[40:43], s90 offen offset:0 sc1
    v_mfma_f32_16x16x32_bf16 v[176:179], a[36:39], v[140:143], v[176:179]
    v_and_b32 v199, s55, v215
    v_mfma_f32_16x16x32_bf16 v[176:179], a[56:59], v[144:147], v[176:179]
    v_mfma_f32_16x16x32_bf16 v[180:183], a[40:43], v[140:143], v[180:183]
    s_waitcnt vmcnt(5)
    s_barrier
    v_mfma_f32_16x16x32_bf16 v[180:183], a[60:63], v[144:147], v[180:183]
    buffer_store_dwordx2 v[10:11], v4, s[40:43], s87 offen sc1
    v_mfma_f32_16x16x32_bf16 v[184:187], a[44:47], v[140:143], v[184:187]
    v_mul_u32_u24 v200, s54, v216
    v_mfma_f32_16x16x32_bf16 v[184:187], a[64:67], v[144:147], v[184:187]
    v_and_b32_e64 v201, s55, v216
    v_mfma_f32_16x16x32_bf16 v[188:191], a[48:51], v[140:143], v[188:191]
    v_mfma_f32_16x16x32_bf16 v[188:191], a[68:71], v[144:147], v[188:191]
    buffer_load_dwordx4 v[96:99], v2, s[40:43], s90 offen offset:1024 sc1
    v_mfma_f32_16x16x32_bf16 v[172:175], a[72:75], v[148:151], v[172:175]
    v_mul_u32_u24 v202, s54, v217
    v_mfma_f32_16x16x32_bf16 v[172:175], a[92:95], v[152:155], v[172:175]
    v_and_b32 v203, s55, v217
    v_mfma_f32_16x16x32_bf16 v[176:179], a[76:79], v[148:151], v[176:179]
    v_mfma_f32_16x16x32_bf16 v[176:179], a[96:99], v[152:155], v[176:179]
    buffer_load_dwordx4 v[100:103], v2, s[40:43], s90 offen offset:2048 sc1
    v_mfma_f32_16x16x32_bf16 v[180:183], a[80:83], v[148:151], v[180:183]
    v_mul_u32_u24 v204, s54, v218
    v_mfma_f32_16x16x32_bf16 v[180:183], a[100:103], v[152:155], v[180:183]
    v_mfma_f32_16x16x32_bf16 v[184:187], a[84:87], v[148:151], v[184:187]
    v_and_b32 v205, s55, v218
    v_mfma_f32_16x16x32_bf16 v[184:187], a[104:107], v[152:155], v[184:187]
    buffer_load_dwordx4 v[104:107], v2, s[40:43], s90 offen offset:3072 sc1
    v_mfma_f32_16x16x32_bf16 v[188:191], a[88:91], v[148:151], v[188:191]
    v_mul_u32_u24_e64 v206, s54, v219
    v_mfma_f32_16x16x32_bf16 v[188:191], a[108:111], v[152:155], v[188:191]
    v_mfma_f32_16x16x32_bf16 v[172:175], a[112:115], v[156:159], v[172:175]
    s_add_u32 s90, s90, 4096
    v_and_b32_e64 v207, s55, v219
    v_mfma_f32_16x16x32_bf16 v[172:175], a[132:135], v[160:163], v[172:175]
    buffer_load_dwordx4 v[108:111], v2, s[40:43], s90 offen offset:0 sc1
    v_mfma_f32_16x16x32_bf16 v[176:179], a[116:119], v[156:159], v[176:179]
    v_mfma_f32_16x16x32_bf16 v[176:179], a[136:139], v[160:163], v[176:179]
    v_mul_u32_u24_e64 v208, s54, v220
    v_mfma_f32_16x16x32_bf16 v[180:183], a[120:123], v[156:159], v[180:183]
    v_mfma_f32_16x16x32_bf16 v[180:183], a[140:143], v[160:163], v[180:183]
    v_and_b32_e64 v209, s55, v220
    v_mfma_f32_16x16x32_bf16 v[184:187], a[124:127], v[156:159], v[184:187]
    buffer_load_dwordx4 v[112:115], v2, s[40:43], s90 offen offset:1024 sc1
    v_mfma_f32_16x16x32_bf16 v[184:187], a[144:147], v[160:163], v[184:187]
    v_mul_u32_u24_e64 v210, s54, v221
    v_mfma_f32_16x16x32_bf16 v[188:191], a[128:131], v[156:159], v[188:191]
    v_mfma_f32_16x16x32_bf16 v[188:191], a[148:151], v[160:163], v[188:191]
    v_and_b32_e64 v211, s55, v221
    v_mfma_f32_16x16x32_bf16 v[172:175], a[152:155], v[164:167], v[172:175]
    v_mfma_f32_16x16x32_bf16 v[172:175], a[172:175], v[168:171], v[172:175]
    buffer_load_dwordx4 v[116:119], v2, s[40:43], s90 offen offset:2048 sc1
    v_mfma_f32_16x16x32_bf16 v[176:179], a[156:159], v[164:167], v[176:179]
    v_mfma_f32_16x16x32_bf16 v[176:179], a[176:179], v[168:171], v[176:179]
    v_mfma_f32_16x16x32_bf16 v[180:183], a[160:163], v[164:167], v[180:183]
    v_mfma_f32_16x16x32_bf16 v[180:183], a[180:183], v[168:171], v[180:183]
    v_mfma_f32_16x16x32_bf16 v[184:187], a[164:167], v[164:167], v[184:187]
    buffer_load_dwordx4 v[120:123], v2, s[40:43], s90 offen offset:3072 sc1
    v_mfma_f32_16x16x32_bf16 v[184:187], a[184:187], v[168:171], v[184:187]
    v_mfma_f32_16x16x32_bf16 v[188:191], a[168:171], v[164:167], v[188:191]
    v_mfma_f32_16x16x32_bf16 v[188:191], a[188:191], v[168:171], v[188:191]
    s_waitcnt vmcnt(11)
    v_mfma_f32_16x16x32_bf16 v[192:195], v[222:225], v[76:79], v[192:195]
    s_add_u32 s90, s90, 3088384
    v_mfma_f32_16x16x32_bf16 v[192:195], v[242:245], v[80:83], v[192:195]
    v_mfma_f32_16x16x32_bf16 v[196:199], v[226:229], v[76:79], v[196:199]
    v_mfma_f32_16x16x32_bf16 v[196:199], v[246:249], v[80:83], v[196:199]
    ds_write_b128 v33, v[172:175] offset:0
    v_mfma_f32_16x16x32_bf16 v[200:203], v[230:233], v[76:79], v[200:203]
    v_mfma_f32_16x16x32_bf16 v[200:203], v[250:253], v[80:83], v[200:203]
    v_mfma_f32_16x16x32_bf16 v[204:207], v[234:237], v[76:79], v[204:207]
    ds_write_b128 v33, v[176:179] offset:1120
    v_mfma_f32_16x16x32_bf16 v[204:207], a[240:243], v[80:83], v[204:207]
    v_mfma_f32_16x16x32_bf16 v[208:211], v[238:241], v[76:79], v[208:211]
    ds_write_b128 v33, v[180:183] offset:2240
    v_mfma_f32_16x16x32_bf16 v[208:211], a[244:247], v[80:83], v[208:211]
    s_waitcnt vmcnt(9)
    v_mfma_f32_16x16x32_bf16 v[192:195], a[248:251], v[84:87], v[192:195]
    buffer_load_dwordx2 v[12:13], v28, s[40:43], s77 offen sc1
    v_mfma_f32_16x16x32_bf16 v[192:195], a[12:15], v[88:91], v[192:195]
    ds_write_b128 v33, v[184:187] offset:3360
    v_mfma_f32_16x16x32_bf16 v[196:199], a[252:255], v[84:87], v[196:199]
    v_mfma_f32_16x16x32_bf16 v[196:199], a[16:19], v[88:91], v[196:199]
    ds_write_b128 v33, v[188:191] offset:4480
    v_mfma_f32_16x16x32_bf16 v[200:203], a[0:3], v[84:87], v[200:203]
    v_mfma_f32_16x16x32_bf16 v[200:203], a[20:23], v[88:91], v[200:203]
    v_mfma_f32_16x16x32_bf16 v[204:207], a[4:7], v[84:87], v[204:207]
    v_mfma_f32_16x16x32_bf16 v[204:207], a[24:27], v[88:91], v[204:207]
    v_mfma_f32_16x16x32_bf16 v[208:211], a[8:11], v[84:87], v[208:211]
    v_mfma_f32_16x16x32_bf16 v[208:211], a[28:31], v[88:91], v[208:211]
    s_waitcnt vmcnt(7)
    v_mfma_f32_16x16x32_bf16 v[192:195], a[32:35], v[92:95], v[192:195]
    s_waitcnt lgkmcnt(0)
    s_barrier
    v_mfma_f32_16x16x32_bf16 v[192:195], a[52:55], v[96:99], v[192:195]
    s_cmp_eq_u32 s56, 2
    s_cselect_b32 s54, 0x10000, 0
    s_cselect_b32 s55, s59, 0
    v_mfma_f32_16x16x32_bf16 v[196:199], a[36:39], v[92:95], v[196:199]
    ds_read_b128 v[40:43], v34 offset:0
    v_mfma_f32_16x16x32_bf16 v[196:199], a[56:59], v[96:99], v[196:199]
    ds_read_b128 v[44:47], v34 offset:256
    v_mul_u32_u24 v172, s54, v212
    v_mfma_f32_16x16x32_bf16 v[200:203], a[40:43], v[92:95], v[200:203]
    ds_read_b128 v[48:51], v34 offset:5600
    v_mfma_f32_16x16x32_bf16 v[200:203], a[60:63], v[96:99], v[200:203]
    ds_read_b128 v[52:55], v34 offset:5856
    v_and_b32_e64 v173, s55, v212
    v_mfma_f32_16x16x32_bf16 v[204:207], a[44:47], v[92:95], v[204:207]
    ds_read_b128 v[56:59], v34 offset:11200
    v_mfma_f32_16x16x32_bf16 v[204:207], a[64:67], v[96:99], v[204:207]
    ds_read_b128 v[60:63], v34 offset:11456
    v_mul_u32_u24 v174, s54, v213
    v_mfma_f32_16x16x32_bf16 v[208:211], a[48:51], v[92:95], v[208:211]
    s_waitcnt vmcnt(0)
    ds_read_b128 v[64:67], v34 offset:16800
    v_cmp_ne_u64_e64 vcc, v[10:11], v[12:13]
    v_mfma_f32_16x16x32_bf16 v[208:211], a[68:71], v[96:99], v[208:211]
    ds_read_b128 v[68:71], v34 offset:17056
    v_add_u32 v33, 22400, v33
    v_mfma_f32_16x16x32_bf16 v[192:195], a[72:75], v[100:103], v[192:195]
    v_add_u32 v34, 22400, v34
    v_and_b32 v175, s55, v213
    v_mfma_f32_16x16x32_bf16 v[192:195], a[92:95], v[104:107], v[192:195]
    s_cbranch_vccnz L_spin56
L_ok55:
    v_mfma_f32_16x16x32_bf16 v[196:199], a[76:79], v[100:103], v[196:199]
    buffer_load_dwordx4 v[124:127], v2, s[40:43], s90 offen offset:0 sc1
    v_mfma_f32_16x16x32_bf16 v[196:199], a[96:99], v[104:107], v[196:199]
    s_waitcnt lgkmcnt(4)
    v_mul_u32_u24 v176, s54, v214
    v_and_b32 v177, s55, v214
    v_mfma_f32_16x16x32_bf16 v[200:203], a[80:83], v[100:103], v[200:203]
    v_mul_u32_u24 v178, s54, v215
    v_add_f32 v40, v40, v48
    v_mfma_f32_16x16x32_bf16 v[200:203], a[100:103], v[104:107], v[200:203]
    v_and_b32 v179, s55, v215
    v_add_f32 v41, v41, v49
    v_mfma_f32_16x16x32_bf16 v[204:207], a[84:87], v[100:103], v[204:207]
    buffer_load_dwordx4 v[128:131], v2, s[40:43], s90 offen offset:1024 sc1
    v_mfma_f32_16x16x32_bf16 v[204:207], a[104:107], v[104:107], v[204:207]
    v_mul_u32_u24 v180, s54, v216
    v_add_f32 v42, v42, v50
    v_mfma_f32_16x16x32_bf16 v[208:211], a[88:91], v[100:103], v[208:211]
    v_add_f32 v43, v43, v51
    v_add_f32 v44, v44, v52
    v_mfma_f32_16x16x32_bf16 v[208:211], a[108:111], v[104:107], v[208:211]
    v_and_b32 v181, s55, v216
    v_add_f32 v45, v45, v53
    v_mfma_f32_16x16x32_bf16 v[192:195], a[112:115], v[108:111], v[192:195]
    buffer_load_dwordx4 v[132:135], v2, s[40:43], s90 offen offset:2048 sc1
    v_mfma_f32_16x16x32_bf16 v[192:195], a[132:135], v[112:115], v[192:195]
    v_mul_u32_u24 v182, s54, v217
    v_add_f32 v46, v46, v54
    v_mfma_f32_16x16x32_bf16 v[196:199], a[116:119], v[108:111], v[196:199]
    v_and_b32 v183, s55, v217
    v_add_f32 v47, v47, v55
    v_mfma_f32_16x16x32_bf16 v[196:199], a[136:139], v[112:115], v[196:199]
    s_waitcnt lgkmcnt(2)
    v_add_f32 v40, v40, v56
    v_add_f32 v41, v41, v57
    v_mfma_f32_16x16x32_bf16 v[200:203], a[120:123], v[108:111], v[200:203]
    buffer_load_dwordx4 v[136:139], v2, s[40:43], s90 offen offset:3072 sc1
    v_mfma_f32_16x16x32_bf16 v[200:203], a[140:143], v[112:115], v[200:203]
    s_add_u32 s90, s90, 4096
    v_mul_u32_u24 v184, s54, v218
    v_and_b32 v185, s55, v218
    v_mfma_f32_16x16x32_bf16 v[204:207], a[124:127], v[108:111], v[204:207]
    v_add_f32 v42, v42, v58
    v_add_f32 v43, v43, v59
    v_mfma_f32_16x16x32_bf16 v[204:207], a[144:147], v[112:115], v[204:207]
    v_mul_u32_u24 v186, s54, v219
    v_add_f32 v44, v44, v60
    v_mfma_f32_16x16x32_bf16 v[208:211], a[128:131], v[108:111], v[208:211]
    buffer_load_dwordx4 v[140:143], v2, s[40:43], s90 offen offset:0 sc1
L_pg6:
    s_cbranch_execz L_pgret
    v_mfma_f32_16x16x32_bf16 v[208:211], a[148:151], v[112:115], v[208:211]
    v_and_b32 v187, s55, v219
    v_add_f32 v45, v45, v61
    v_mfma_f32_16x16x32_bf16 v[192:195], a[152:155], v[116:119], v[192:195]
    v_add_f32 v46, v46, v62
    v_add_f32 v47, v47, v63
    v_mfma_f32_16x16x32_bf16 v[192:195], a[172:175], v[120:123], v[192:195]
    s_waitcnt lgkmcnt(0)
    v_mul_u32_u24 v188, s54, v220
    v_add_f32 v40, v40, v64
    v_mfma_f32_16x16x32_bf16 v[196:199], a[156:159], v[116:119], v[196:199]
    buffer_load_dwordx4 v[144:147], v2, s[40:43], s90 offen offset:1024 sc1
    v_mfma_f32_16x16x32_bf16 v[196:199], a[176:179], v[120:123], v[196:199]
    v_and_b32 v189, s55, v220
    v_add_f32 v41, v41, v65
    v_mfma_f32_16x16x32_bf16 v[200:203], a[160:163], v[116:119], v[200:203]
    v_mul_u32_u24 v190, s54, v221
    v_add_f32 v42, v42, v66
    v_mfma_f32_16x16x32_bf16 v[200:203], a[180:183], v[120:123], v[200:203]
    v_add_f32 v43, v43, v67
    v_add_f32 v44, v44, v68
    v_mfma_f32_16x16x32_bf16 v[204:207], a[164:167], v[116:119], v[204:207]
    buffer_load_dwordx4 v[148:151], v2, s[40:43], s90 offen offset:2048 sc1
    v_and_b32 v191, s55, v221
    v_mfma_f32_16x16x32_bf16 v[204:207], a[184:187], v[120:123], v[204:207]
    v_add_f32 v45, v45, v69
    v_add_f32_e64 v46, v46, v70
    v_mfma_f32_16x16x32_bf16 v[208:211], a[168:171], v[116:119], v[208:211]
    v_add_f32 v47, v47, v71
    v_cvt_pk_bf16_f32 v72, v40, v41
    v_mfma_f32_16x16x32_bf16 v[208:211], a[188:191], v[120:123], v[208:211]
    s_waitcnt vmcnt(5)
    buffer_load_dwordx4 v[152:155], v2, s[40:43], s90 offen offset:3072 sc1
    s_add_u32 s90, s90, 4096
    v_mfma_f32_16x16x32_bf16 v[172:175], v[222:225], v[124:127], v[172:175]
    v_cvt_pk_bf16_f32 v73, v42, v43
    v_cvt_pk_bf16_f32 v74, v44, v45
    v_mfma_f32_16x16x32_bf16 v[172:175], v[242:245], v[128:131], v[172:175]
    v_cvt_pk_bf16_f32 v75, v46, v47
    v_mfma_f32_16x16x32_bf16 v[176:179], v[226:229], v[124:127], v[176:179]
    v_mfma_f32_16x16x32_bf16 v[176:179], v[246:249], v[128:131], v[176:179]
    ds_write_b128 v33, v[192:195] offset:0
    v_mfma_f32_16x16x32_bf16 v[180:183], v[230:233], v[124:127], v[180:183]
    buffer_store_dwordx4 v[72:75], v35, s[36:39], s91 offen
    v_mfma_f32_16x16x32_bf16 v[180:183], v[250:253], v[128:131], v[180:183]
    v_mfma_f32_16x16x32_bf16 v[184:187], v[234:237], v[124:127], v[184:187]
    ds_write_b128 v33, v[196:199] offset:1120
    v_mfma_f32_16x16x32_bf16 v[184:187], a[240:243], v[128:131], v[184:187]
    v_mfma_f32_16x16x32_bf16 v[188:191], v[238:241], v[124:127], v[188:191]
    ds_write_b128 v33, v[200:203] offset:2240
    v_mfma_f32_16x16x32_bf16 v[188:191], a[244:247], v[128:131], v[188:191]
    s_waitcnt vmcnt(5)
    buffer_load_dwordx4 v[156:159], v2, s[40:43], s90 offen offset:0 sc1
    v_mfma_f32_16x16x32_bf16 v[172:175], a[248:251], v[132:135], v[172:175]
    v_mfma_f32_16x16x32_bf16 v[172:175], a[12:15], v[136:139], v[172:175]
    ds_write_b128 v33, v[204:207] offset:3360
    v_mfma_f32_16x16x32_bf16 v[176:179], a[252:255], v[132:135], v[176:179]
    v_mfma_f32_16x16x32_bf16 v[176:179], a[16:19], v[136:139], v[176:179]
    ds_write_b128 v33, v[208:211] offset:4480
    v_mfma_f32_16x16x32_bf16 v[180:183], a[0:3], v[132:135], v[180:183]
    buffer_load_dwordx4 v[160:163], v2, s[40:43], s90 offen offset:1024 sc1
    v_mfma_f32_16x16x32_bf16 v[180:183], a[20:23], v[136:139], v[180:183]
    s_add_u32 s91, s91, 40960
    v_mfma_f32_16x16x32_bf16 v[184:187], a[4:7], v[132:135], v[184:187]
    v_mfma_f32_16x16x32_bf16 v[184:187], a[24:27], v[136:139], v[184:187]
    v_mfma_f32_16x16x32_bf16 v[188:191], a[8:11], v[132:135], v[188:191]
    buffer_load_dwordx4 v[164:167], v2, s[40:43], s90 offen offset:2048 sc1
    v_mfma_f32_16x16x32_bf16 v[188:191], a[28:31], v[136:139], v[188:191]
    s_waitcnt vmcnt(6)
    v_mfma_f32_16x16x32_bf16 v[172:175], a[32:35], v[140:143], v[172:175]
    s_waitcnt lgkmcnt(0)
    s_barrier
    v_mfma_f32_16x16x32_bf16 v[172:175], a[52:55], v[144:147], v[172:175]
    s_cmp_eq_u32 s56, 3
    s_cselect_b32 s54, 0x10000, 0
    s_cselect_b32 s55, s59, 0
    v_mfma_f32_16x16x32_bf16 v[176:179], a[36:39], v[140:143], v[176:179]
    buffer_load_dwordx4 v[168:171], v2, s[40:43], s90 offen offset:3072 sc1
    v_mfma_f32_16x16x32_bf16 v[176:179], a[56:59], v[144:147], v[176:179]
    s_add_u32 s90, s90, 40960
    ds_read_b128 v[40:43], v34 offset:0
    ds_read_b128 v[44:47], v34 offset:256
    v_mfma_f32_16x16x32_bf16 v[180:183], a[40:43], v[140:143], v[180:183]
    ds_read_b128 v[48:51], v34 offset:5600
    v_mul_u32_u24 v192, s54, v212
    v_mfma_f32_16x16x32_bf16 v[180:183], a[60:63], v[144:147], v[180:183]
    ds_read_b128 v[52:55], v34 offset:5856
    v_and_b32 v193, s55, v212
    v_mfma_f32_16x16x32_bf16 v[184:187], a[44:47], v[140:143], v[184:187]
    buffer_load_dwordx4 v[76:79], v2, s[40:43], s90 offen offset:0 sc1
    v_mfma_f32_16x16x32_bf16 v[184:187], a[64:67], v[144:147], v[184:187]
    ds_read_b128 v[56:59], v34 offset:11200
    ds_read_b128 v[60:63], v34 offset:11456
    v_mfma_f32_16x16x32_bf16 v[188:191], a[48:51], v[140:143], v[188:191]
    ds_read_b128 v[64:67], v34 offset:16800
    v_mul_u32_u24_e64 v194, s54, v213
    v_mfma_f32_16x16x32_bf16 v[188:191], a[68:71], v[144:147], v[188:191]
    s_waitcnt vmcnt(6)
    ds_read_b128 v[68:71], v34 offset:17056
    v_add_u32 v33, 22400, v33
    v_mfma_f32_16x16x32_bf16 v[172:175], a[72:75], v[148:151], v[172:175]
    buffer_load_dwordx4 v[80:83], v2, s[40:43], s90 offen offset:1024 sc1
    v_mfma_f32_16x16x32_bf16 v[172:175], a[92:95], v[152:155], v[172:175]
    v_add_u32 v34, 22400, v34
    v_and_b32 v195, s55, v213
    v_mfma_f32_16x16x32_bf16 v[176:179], a[76:79], v[148:151], v[176:179]
    v_mul_u32_u24 v196, s54, v214
    v_and_b32 v197, s55, v214
    v_mfma_f32_16x16x32_bf16 v[176:179], a[96:99], v[152:155], v[176:179]
    s_waitcnt lgkmcnt(4)
    v_mul_u32_u24 v198, s54, v215
    v_mfma_f32_16x16x32_bf16 v[180:183], a[80:83], v[148:151], v[180:183]
    buffer_load_dwordx4 v[84:87], v2, s[40:43], s90 offen offset:2048 sc1
    v_mfma_f32_16x16x32_bf16 v[180:183], a[100:103], v[152:155], v[180:183]
    v_and_b32 v199, s55, v215
    v_add_f32 v40, v40, v48
    v_mfma_f32_16x16x32_bf16 v[184:187], a[84:87], v[148:151], v[184:187]
    v_add_f32 v41, v41, v49
    v_add_f32 v42, v42, v50
    v_mfma_f32_16x16x32_bf16 v[184:187], a[104:107], v[152:155], v[184:187]
    v_mul_u32_u24 v200, s54, v216
    v_add_f32 v43, v43, v51
    v_mfma_f32_16x16x32_bf16 v[188:191], a[88:91], v[148:151], v[188:191]
    buffer_load_dwordx4 v[88:91], v2, s[40:43], s90 offen offset:3072 sc1
    v_mfma_f32_16x16x32_bf16 v[188:191], a[108:111], v[152:155], v[188:191]
    s_waitcnt vmcnt(6)
    v_and_b32 v201, s55, v216
    s_add_u32 s90, s90, 4096
    v_mfma_f32_16x16x32_bf16 v[172:175], a[112:115], v[156:159], v[172:175]
    v_mul_u32_u24 v202, s54, v217
    v_add_f32 v44, v44, v52
    v_mfma_f32_16x16x32_bf16 v[172:175], a[132:135], v[160:163], v[172:175]
    v_add_f32 v45, v45, v53
    v_add_f32 v46, v46, v54
    v_mfma_f32_16x16x32_bf16 v[176:179], a[116:119], v[156:159], v[176:179]
    buffer_load_dwordx4 v[92:95], v2, s[40:43], s90 offen offset:0 sc1
    v_mfma_f32_16x16x32_bf16 v[176:179], a[136:139], v[160:163], v[176:179]
    v_and_b32 v203, s55, v217
    v_add_f32 v47, v47, v55
    v_mfma_f32_16x16x32_bf16 v[180:183], a[120:123], v[156:159], v[180:183]
    s_waitcnt lgkmcnt(2)
    v_mul_u32_u24 v204, s54, v218
    v_add_f32_e64 v40, v40, v56
    v_mfma_f32_16x16x32_bf16 v[180:183], a[140:143], v[160:163], v[180:183]
    v_and_b32 v205, s55, v218
    v_add_f32 v41, v41, v57
    v_mfma_f32_16x16x32_bf16 v[184:187], a[124:127], v[156:159], v[184:187]
    buffer_load_dwordx4 v[96:99], v2, s[40:43], s90 offen offset:1024 sc1
    v_mfma_f32_16x16x32_bf16 v[184:187], a[144:147], v[160:163], v[184:187]
    v_mul_u32_u24 v206, s54, v219
    v_add_f32 v42, v42, v58
    v_mfma_f32_16x16x32_bf16 v[188:191], a[128:131], v[156:159], v[188:191]
    v_add_f32 v43, v43, v59
    v_add_f32 v44, v44, v60
    v_mfma_f32_16x16x32_bf16 v[188:191], a[148:151], v[160:163], v[188:191]
    s_waitcnt vmcnt(6)
    v_and_b32 v207, s55, v219
    v_add_f32_e64 v45, v45, v61
    v_mfma_f32_16x16x32_bf16 v[172:175], a[152:155], v[164:167], v[172:175]
    buffer_load_dwordx4 v[100:103], v2, s[40:43], s90 offen offset:2048 sc1
    v_mfma_f32_16x16x32_bf16 v[172:175], a[172:175], v[168:171], v[172:175]
    v_mul_u32_u24 v208, s54, v220
    v_add_f32 v46, v46, v62
    v_mfma_f32_16x16x32_bf16 v[176:179], a[156:159], v[164:167], v[176:179]
    v_and_b32 v209, s55, v220
    v_add_f32 v47, v47, v63
    v_mfma_f32_16x16x32_bf16 v[176:179], a[176:179], v[168:171], v[176:179]
    s_waitcnt lgkmcnt(0)
    v_add_f32 v40, v40, v64
    v_add_f32_e64 v41, v41, v65
    v_mfma_f32_16x16x32_bf16 v[180:183], a[160:163], v[164:167], v[180:183]
    buffer_load_dwordx4 v[104:107], v2, s[40:43], s90 offen offset:3072 sc1
    v_mfma_f32_16x16x32_bf16 v[180:183], a[180:183], v[168:171], v[180:183]
    s_add_u32 s90, s90, 4096
    v_mul_u32_u24 v210, s54, v221
    v_add_f32 v42, v42, v66
    v_mfma_f32_16x16x32_bf16 v[184:187], a[164:167], v[164:167], v[184:187]
    v_and_b32 v211, s55, v221
    v_add_f32 v43, v43, v67
    v_mfma_f32_16x16x32_bf16 v[184:187], a[184:187], v[168:171], v[184:187]
    v_add_f32 v44, v44, v68
    v_add_f32 v45, v45, v69
    v_mfma_f32_16x16x32_bf16 v[188:191], a[168:171], v[164:167], v[188:191]
    buffer_load_dwordx4 v[108:111], v2, s[40:43], s90 offen offset:0 sc1
    v_mfma_f32_16x16x32_bf16 v[188:191], a[188:191], v[168:171], v[188:191]
    s_waitcnt vmcnt(7)
    v_add_f32 v46, v46, v70
    v_add_f32_e64 v47, v47, v71
    v_mfma_f32_16x16x32_bf16 v[192:195], v[222:225], v[76:79], v[192:195]
    v_cvt_pk_bf16_f32 v72, v40, v41
    v_cvt_pk_bf16_f32 v73, v42, v43
    v_mfma_f32_16x16x32_bf16 v[192:195], v[242:245], v[80:83], v[192:195]
    v_cvt_pk_bf16_f32 v74, v44, v45
    v_cvt_pk_bf16_f32 v75, v46, v47
    v_mfma_f32_16x16x32_bf16 v[196:199], v[226:229], v[76:79], v[196:199]
    buffer_load_dwordx4 v[112:115], v2, s[40:43], s90 offen offset:1024 sc1
    v_mfma_f32_16x16x32_bf16 v[196:199], v[246:249], v[80:83], v[196:199]
    ds_write_b128 v33, v[172:175] offset:0
    v_mfma_f32_16x16x32_bf16 v[200:203], v[230:233], v[76:79], v[200:203]
    v_mfma_f32_16x16x32_bf16 v[200:203], v[250:253], v[80:83], v[200:203]
    v_mfma_f32_16x16x32_bf16 v[204:207], v[234:237], v[76:79], v[204:207]
    buffer_load_dwordx4 v[116:119], v2, s[40:43], s90 offen offset:2048 sc1
    v_mfma_f32_16x16x32_bf16 v[204:207], a[240:243], v[80:83], v[204:207]
    ds_write_b128 v33, v[176:179] offset:1120
    v_mfma_f32_16x16x32_bf16 v[208:211], v[238:241], v[76:79], v[208:211]
    ds_write_b128 v33, v[180:183] offset:2240
    v_mfma_f32_16x16x32_bf16 v[208:211], a[244:247], v[80:83], v[208:211]
    s_waitcnt vmcnt(7)
    v_mfma_f32_16x16x32_bf16 v[192:195], a[248:251], v[84:87], v[192:195]
    buffer_load_dwordx4 v[120:123], v2, s[40:43], s90 offen offset:3072 sc1
    v_mfma_f32_16x16x32_bf16 v[192:195], a[12:15], v[88:91], v[192:195]
    ds_write_b128 v33, v[184:187] offset:3360
    v_mfma_f32_16x16x32_bf16 v[196:199], a[252:255], v[84:87], v[196:199]
    v_mfma_f32_16x16x32_bf16 v[196:199], a[16:19], v[88:91], v[196:199]
    ds_write_b128 v33, v[188:191] offset:4480
    v_mfma_f32_16x16x32_bf16 v[200:203], a[0:3], v[84:87], v[200:203]
    buffer_store_dwordx4 v[72:75], v35, s[36:39], s91 offen
    v_mfma_f32_16x16x32_bf16 v[200:203], a[20:23], v[88:91], v[200:203]
    s_add_u32 s91, s91, 1269760
    v_mfma_f32_16x16x32_bf16 v[204:207], a[4:7], v[84:87], v[204:207]
    v_mfma_f32_16x16x32_bf16 v[204:207], a[24:27], v[88:91], v[204:207]
    v_mfma_f32_16x16x32_bf16 v[208:211], a[8:11], v[84:87], v[208:211]
    v_mfma_f32_16x16x32_bf16 v[208:211], a[28:31], v[88:91], v[208:211]
    s_waitcnt vmcnt(7)
    v_mfma_f32_16x16x32_bf16 v[192:195], a[32:35], v[92:95], v[192:195]
    s_waitcnt lgkmcnt(0)
    s_barrier
    v_mfma_f32_16x16x32_bf16 v[192:195], a[52:55], v[96:99], v[192:195]
    ds_read_b128 v[40:43], v34 offset:0
    v_mfma_f32_16x16x32_bf16 v[196:199], a[36:39], v[92:95], v[196:199]
    ds_read_b128 v[44:47], v34 offset:256
    v_mfma_f32_16x16x32_bf16 v[196:199], a[56:59], v[96:99], v[196:199]
    ds_read_b128 v[48:51], v34 offset:5600
    v_mfma_f32_16x16x32_bf16 v[200:203], a[40:43], v[92:95], v[200:203]
    ds_read_b128 v[52:55], v34 offset:5856
    v_mfma_f32_16x16x32_bf16 v[200:203], a[60:63], v[96:99], v[200:203]
    ds_read_b128 v[56:59], v34 offset:11200
    v_mfma_f32_16x16x32_bf16 v[204:207], a[44:47], v[92:95], v[204:207]
    ds_read_b128 v[60:63], v34 offset:11456
    v_mfma_f32_16x16x32_bf16 v[204:207], a[64:67], v[96:99], v[204:207]
    ds_read_b128 v[64:67], v34 offset:16800
    v_mfma_f32_16x16x32_bf16 v[208:211], a[48:51], v[92:95], v[208:211]
    ds_read_b128 v[68:71], v34 offset:17056
    v_add_u32 v33, 22400, v33
    v_mfma_f32_16x16x32_bf16 v[208:211], a[68:71], v[96:99], v[208:211]
    s_waitcnt vmcnt(5)
    v_add_u32 v34, 22400, v34
    v_mfma_f32_16x16x32_bf16 v[192:195], a[72:75], v[100:103], v[192:195]
    v_mfma_f32_16x16x32_bf16 v[192:195], a[92:95], v[104:107], v[192:195]
    v_mfma_f32_16x16x32_bf16 v[196:199], a[76:79], v[100:103], v[196:199]
    v_mfma_f32_16x16x32_bf16 v[196:199], a[96:99], v[104:107], v[196:199]
    s_waitcnt lgkmcnt(4)
    v_mfma_f32_16x16x32_bf16 v[200:203], a[80:83], v[100:103], v[200:203]
    v_add_f32 v40, v40, v48
    v_add_f32 v41, v41, v49
    v_mfma_f32_16x16x32_bf16 v[200:203], a[100:103], v[104:107], v[200:203]
    v_add_f32 v42, v42, v50
    v_add_f32 v43, v43, v51
    v_mfma_f32_16x16x32_bf16 v[204:207], a[84:87], v[100:103], v[204:207]
    v_add_f32 v44, v44, v52
    v_add_f32 v45, v45, v53
    v_mfma_f32_16x16x32_bf16 v[204:207], a[104:107], v[104:107], v[204:207]
    v_add_f32 v46, v46, v54
    v_add_f32 v47, v47, v55
    v_mfma_f32_16x16x32_bf16 v[208:211], a[88:91], v[100:103], v[208:211]
    s_waitcnt lgkmcnt(2)
    v_add_f32 v40, v40, v56
    v_add_f32 v41, v41, v57
    v_mfma_f32_16x16x32_bf16 v[208:211], a[108:111], v[104:107], v[208:211]
    s_waitcnt vmcnt(3)
    v_add_f32 v42, v42, v58
    v_add_f32 v43, v43, v59
    v_mfma_f32_16x16x32_bf16 v[192:195], a[112:115], v[108:111], v[192:195]
    v_add_f32 v44, v44, v60
    v_add_f32 v45, v45, v61
    v_mfma_f32_16x16x32_bf16 v[192:195], a[132:135], v[112:115], v[192:195]
    v_add_f32 v46, v46, v62
    v_add_f32 v47, v47, v63
    v_mfma_f32_16x16x32_bf16 v[196:199], a[116:119], v[108:111], v[196:199]
    s_waitcnt lgkmcnt(0)
    v_add_f32 v40, v40, v64
    v_add_f32 v41, v41, v65
    v_mfma_f32_16x16x32_bf16 v[196:199], a[136:139], v[112:115], v[196:199]
    v_add_f32 v42, v42, v66
    v_add_f32 v43, v43, v67
    v_mfma_f32_16x16x32_bf16 v[200:203], a[120:123], v[108:111], v[200:203]
    v_add_f32 v44, v44, v68
    v_add_f32 v45, v45, v69
    v_mfma_f32_16x16x32_bf16 v[200:203], a[140:143], v[112:115], v[200:203]
    v_add_f32 v46, v46, v70
    v_add_f32_e64 v47, v47, v71
    v_mfma_f32_16x16x32_bf16 v[204:207], a[124:127], v[108:111], v[204:207]
    v_cvt_pk_bf16_f32 v72, v40, v41
    v_cvt_pk_bf16_f32 v73, v42, v43
    v_mfma_f32_16x16x32_bf16 v[204:207], a[144:147], v[112:115], v[204:207]
    v_cvt_pk_bf16_f32 v74, v44, v45
    v_cvt_pk_bf16_f32 v75, v46, v47
    v_mfma_f32_16x16x32_bf16 v[208:211], a[128:131], v[108:111], v[208:211]
    buffer_store_dwordx4 v[72:75], v35, s[36:39], s91 offen
    v_mfma_f32_16x16x32_bf16 v[208:211], a[148:151], v[112:115], v[208:211]
    s_waitcnt vmcnt(2)
    v_mfma_f32_16x16x32_bf16 v[192:195], a[152:155], v[116:119], v[192:195]
    v_mfma_f32_16x16x32_bf16 v[192:195], a[172:175], v[120:123], v[192:195]
    v_mfma_f32_16x16x32_bf16 v[196:199], a[156:159], v[116:119], v[196:199]
    v_mfma_f32_16x16x32_bf16 v[196:199], a[176:179], v[120:123], v[196:199]
    v_mfma_f32_16x16x32_bf16 v[200:203], a[160:163], v[116:119], v[200:203]
    v_mfma_f32_16x16x32_bf16 v[200:203], a[180:183], v[120:123], v[200:203]
    v_mfma_f32_16x16x32_bf16 v[204:207], a[164:167], v[116:119], v[204:207]
    v_mfma_f32_16x16x32_bf16 v[204:207], a[184:187], v[120:123], v[204:207]
    v_mfma_f32_16x16x32_bf16 v[208:211], a[168:171], v[116:119], v[208:211]
    s_add_u32 s91, s91, 40960
    v_mfma_f32_16x16x32_bf16 v[208:211], a[188:191], v[120:123], v[208:211]
    ds_write_b128 v33, v[192:195] offset:0
    ds_write_b128 v33, v[196:199] offset:1120
    s_nop 0
    ds_write_b128 v33, v[200:203] offset:2240
    s_nop 0
    ds_write_b128 v33, v[204:207] offset:3360
    s_nop 1
    ds_write_b128 v33, v[208:211] offset:4480
    s_waitcnt lgkmcnt(0)
    s_barrier
    ds_read_b128 v[40:43], v34 offset:0
    ds_read_b128 v[44:47], v34 offset:256
    ds_read_b128 v[48:51], v34 offset:5600
    ds_read_b128 v[52:55], v34 offset:5856
    ds_read_b128 v[56:59], v34 offset:11200
    ds_read_b128 v[60:63], v34 offset:11456
    ds_read_b128 v[64:67], v34 offset:16800
    ds_read_b128 v[68:71], v34 offset:17056
    s_waitcnt lgkmcnt(4)
    v_pk_add_f32 v[40:41], v[40:41], v[48:49]
    v_pk_add_f32 v[42:43], v[42:43], v[50:51]
    v_pk_add_f32 v[44:45], v[44:45], v[52:53]
    v_pk_add_f32 v[46:47], v[46:47], v[54:55]
    s_waitcnt lgkmcnt(2)
    v_pk_add_f32 v[40:41], v[40:41], v[56:57]
    v_pk_add_f32 v[42:43], v[42:43], v[58:59]
    v_pk_add_f32 v[44:45], v[44:45], v[60:61]
    v_pk_add_f32 v[46:47], v[46:47], v[62:63]
    s_waitcnt lgkmcnt(0)
    v_pk_add_f32 v[40:41], v[40:41], v[64:65]
    s_nop 0
    v_pk_add_f32 v[42:43], v[42:43], v[66:67]
    v_pk_add_f32 v[44:45], v[44:45], v[68:69]
    v_pk_add_f32 v[46:47], v[46:47], v[70:71]
    v_cvt_pk_bf16_f32 v72, v40, v41
    v_cvt_pk_bf16_f32 v73, v42, v43
    v_cvt_pk_bf16_f32 v74, v44, v45
    v_cvt_pk_bf16_f32 v75, v46, v47
    buffer_store_dwordx4 v[72:75], v35, s[36:39], s91 offen
    s_cmp_lg_u32 s2, 0
    s_cbranch_scc1 L_noep
    s_mov_b32 s71, 524032
    buffer_store_dwordx2 v[10:11], v4, s[40:43], s71 offen sc1
L_noep:
L_end:
    s_endpgm
L_prep:
    s_sub_u32 s54, s58, 20
    s_mov_b32 s42, 21364736
    s_mov_b32 s43, 0x00020000
    v_cmp_ne_u32 vcc, 0, v0
    s_mov_b32 s59, 0xffff0000
    s_nop 0
    v_cndmask_b32 v4, 0, v5, vcc
    s_cmp_ge_u32 s58, 28
    s_cbranch_scc1 L_dprep
    s_lshl3_add_u32 s55, s57, s54
    s_mov_b32 s22, 2621440
    s_mov_b32 s23, 0x00020000
    s_lshr_b32 s71, s56, 1
    s_lshl_b32 s71, s71, 2
    s_movk_i32 s72, 1280
    v_add_u32 v44, 0, v1
    v_mul_u32_u24 v45, 820, v44
    v_lshrrev_b32_e64 v45, 16, v45
    v_mul_u32_u24 v46, 80, v45
    v_sub_u32 v44, v44, v46
    v_or_b32 v46, s71, v45
    v_lshlrev_b32 v46, 1, v46
    v_xor_b32 v44, v44, v46
    v_lshlrev_b32_e64 v44, 4, v44
    v_mad_u32_u24 v110, v45, s72, v44
    v_add_u32 v44, 64, v1
    v_mul_u32_u24 v45, 820, v44
    v_lshrrev_b32 v45, 16, v45
    v_mul_u32_u24 v46, 80, v45
    v_sub_u32 v44, v44, v46
    v_or_b32 v46, s71, v45
    v_lshlrev_b32 v46, 1, v46
    v_xor_b32 v44, v44, v46
    v_lshlrev_b32_e64 v44, 4, v44
    v_mad_u32_u24 v111, v45, s72, v44
    v_add_u32 v44, 128, v1
    v_mul_u32_u24 v45, 820, v44
    v_lshrrev_b32 v45, 16, v45
    v_mul_u32_u24 v46, 80, v45
    v_sub_u32 v44, v44, v46
    v_or_b32 v46, s71, v45
    v_lshlrev_b32 v46, 1, v46
    v_xor_b32 v44, v44, v46
    v_lshlrev_b32 v44, 4, v44
    v_mad_u32_u24 v112, v45, s72, v44
    v_add_u32 v44, 192, v1
    v_mul_u32_u24 v45, 820, v44
    v_lshrrev_b32 v45, 16, v45
    v_mul_u32_u24 v46, 80, v45
    v_sub_u32 v44, v44, v46
    v_or_b32 v46, s71, v45
    v_lshlrev_b32 v46, 1, v46
    v_xor_b32 v44, v44, v46
    v_lshlrev_b32 v44, 4, v44
    v_mad_u32_u24 v113, v45, s72, v44
    v_add_u32 v44, 256, v1
    v_mul_u32_u24 v45, 820, v44
    v_lshrrev_b32 v45, 16, v45
    v_mul_u32_u24 v46, 80, v45
    v_sub_u32 v44, v44, v46
    v_or_b32 v46, s71, v45
    v_lshlrev_b32 v46, 1, v46
    v_xor_b32 v44, v44, v46
    v_lshlrev_b32 v44, 4, v44
    v_mad_u32_u24 v114, v45, s72, v44
    s_waitcnt lgkmcnt(0)
    s_load_dwordx2 s[44:45], s[40:41], 524032
    s_lshl2_add_u32 s71, s55, s56
    s_mul_i32 s71, s71, 5120
    s_mul_i32 s72, s56, 5120
    s_add_u32 m0, s72, 103040
    s_nop 0
    buffer_load_dwordx4 v110, s[20:23], s71 offen lds
    s_add_u32 m0, s72, 104064
    s_nop 0
    buffer_load_dwordx4 v111, s[20:23], s71 offen lds
    s_add_u32 m0, s72, 105088
    s_nop 0
    buffer_load_dwordx4 v112, s[20:23], s71 offen lds
    s_add_u32 m0, s72, 106112
    s_nop 0
    buffer_load_dwordx4 v113, s[20:23], s71 offen lds
    s_add_u32 m0, s72, 107136
    s_nop 0
    buffer_load_dwordx4 v114, s[20:23], s71 offen lds
    s_mul_i32 s71, s57, 12
    s_add_u32 s71, s71, s54
    s_lshl2_add_u32 s71, s71, s56
    s_lshl_b32 s71, s71, 10
    v_cmp_gt_u32 vcc, 16, v1
    v_lshlrev_b32 v44, 6, v1
    v_mov_b32 v45, 0
    v_cndmask_b32 v44, v5, v44, vcc
    buffer_atomic_add v45, v44, s[40:43], s71 offen sc1
    v_bfe_u32 v47, v1, 2, 2
    v_and_b32 v48, 3, v1
    v_and_b32 v44, 1, v8
    v_lshl_add_u32 v45, v44, 3, v47
    v_mul_u32_u24 v120, 1280, v45
    v_lshl_or_b32 v45, v44, 2, v47
    v_lshrrev_b32 v46, 1, v8
    s_lshl_b32 s71, s56, 1
    v_or_b32 v122, s71, v46
    v_xor_b32_e64 v45, v45, v122
    v_lshl_add_u32 v120, v45, 5, v120
    v_lshl_add_u32 v120, v48, 3, v120
    v_add_u32 v120, 103040, v120
    v_lshrrev_b32_e64 v45, 2, v7
    v_lshl_add_u32 v45, v46, 2, v45
    v_mul_u32_u24 v122, 16512, v45
    v_lshl_add_u32 v122, v44, 6, v122
    v_lshl_add_u32 v122, v48, 4, v122
    s_mul_i32 s71, s56, 5120
    s_add_u32 s71, s71, 103040
    v_mul_u32_u24 v121, 1280, v8
    v_lshl_add_u32 v121, v7, 4, v121
    v_add_u32 v121, s71, v121
    v_cmp_gt_u32 vcc, 2, v7
    v_lshlrev_b32_e64 v44, 10, v7
    v_lshl_add_u32 v44, v8, 2, v44
    v_cndmask_b32 v123, v5, v44, vcc
    v_mov_b32 v148, 0x3f803f80
    s_and_b32 s61, s57, 1
    s_lshl_b32 s61, s61, 3
    s_lshr_b32 s73, s58, 2
    s_add_u32 s61, s61, s73
    s_lshr_b32 s62, s57, 1
    s_lshl_b32 s62, s62, 2
    s_and_b32 s73, s58, 3
    s_add_u32 s62, s62, s73
    s_lshr_b32 s63, s62, 2
    s_mul_i32 s74, s62, 192
    s_add_u32 s73, s63, 0
    s_and_b32 s73, s73, 3
    s_mul_i32 s73, s73, 491520
    s_add_u32 s67, s74, s73
    s_add_u32 s73, s63, 1
    s_and_b32 s73, s73, 3
    s_mul_i32 s73, s73, 491520
    s_add_u32 s68, s74, s73
    s_add_u32 s73, s63, 2
    s_and_b32 s73, s73, 3
    s_mul_i32 s73, s73, 491520
    s_add_u32 s69, s74, s73
    s_add_u32 s73, s63, 3
    s_and_b32 s73, s73, 3
    s_mul_i32 s73, s73, 491520
    s_add_u32 s70, s74, s73
    s_lshr_b32 s73, s56, 1
    s_lshl_b32 s73, s73, 3
    s_movk_i32 s74, 3072
    s_mul_i32 s95, s56, 3088
    v_add_u32 v44, 0, v1
    v_mul_u32_u24 v45, 5462, v44
    v_lshrrev_b32 v45, 16, v45
    v_mul_u32_u24 v46, 12, v45
    v_sub_u32 v44, v44, v46
    v_lshlrev_b32 v44, 4, v44
    v_and_b32 v46, 8, v45
    v_add3_u32 v45, v45, v46, s73
    v_mad_u32_u24 v184, v45, s74, v44
    v_add_u32 v44, 64, v1
    v_mul_u32_u24 v45, 5462, v44
    v_lshrrev_b32 v45, 16, v45
    v_mul_u32_u24 v46, 12, v45
    v_sub_u32 v44, v44, v46
    v_lshlrev_b32 v44, 4, v44
    v_and_b32_e64 v46, 8, v45
    v_add3_u32 v45, v45, v46, s73
    v_mad_u32_u24 v185, v45, s74, v44
    v_add_u32 v44, 128, v1
    v_mul_u32_u24 v45, 5462, v44
    v_lshrrev_b32 v45, 16, v45
    v_mul_u32_u24 v46, 12, v45
    v_sub_u32 v44, v44, v46
    v_lshlrev_b32 v44, 4, v44
    v_and_b32_e64 v46, 8, v45
    v_add3_u32 v45, v45, v46, s73
    v_mad_u32_u24 v186, v45, s74, v44
    s_mov_b32 s26, 1966080
    s_mov_b32 s27, 0x00020000
    s_bitcmp1_b32 s56, 0
    s_cselect_b32 s24, s32, s24
    s_cselect_b32 s25, s33, s25
    v_bfe_u32 v46, v1, 2, 2
    v_and_b32 v44, 1, v8
    v_mul_u32_u24 v187, 6176, v44
    v_lshrrev_b32_e64 v44, 1, v8
    v_lshl_add_u32 v44, v44, 3, v46
    v_mul_u32_u24 v44, 192, v44
    s_mul_i32 s73, s56, 48
    s_add_u32 s73, s73, 0
    v_add3_u32 v187, v187, v44, s73
    v_and_b32 v46, 3, v1
    v_lshrrev_b32 v44, 1, v46
    v_mul_u32_u24 v44, 3088, v44
    v_and_b32_e64 v45, 1, v46
    v_lshl_add_u32 v44, v45, 3, v44
    v_add3_u32 v188, v187, v44, 32
    v_lshl_add_u32 v187, v46, 3, v187
    s_lshr_b32 s75, s56, 1
    s_lshl1_add_u32 s75, s54, s75
    v_add_u32 v44, 0, v1
    v_mul_u32_u24 v45, 10923, v44
    v_lshrrev_b32 v45, 16, v45
    v_mul_u32_u24 v46, 6, v45
    v_sub_u32 v44, v44, v46
    v_min_u32 v45, 9, v45
    v_mul_u32_u24 v45, 3072, v45
    v_lshl_add_u32 v151, v44, 7, v45
    s_and_b32 s72, s62, 3
    s_mul_i32 s72, s72, 192
    s_mul_i32 s7, s75, 30720
    s_sub_u32 s7, s7, s72
    s_waitcnt lgkmcnt(0)
    s_add_u32 s44, s44, 0x7f4a7c15
    s_addc_u32 s45, s45, 0x9e3779b9
    v_mov_b32 v10, s44
    v_mov_b32 v11, s45
    v_mov_b32_e64 v6, v5
    s_waitcnt vmcnt(1)
    s_barrier
    ds_read_b64_tr_b16 v[50:51], v120 offset:0
    ds_read_b64_tr_b16 v[52:53], v120 offset:5120
    ds_read_b64_tr_b16 v[54:55], v120 offset:256
    ds_read_b64_tr_b16 v[56:57], v120 offset:5376
    ds_read_b64_tr_b16 v[58:59], v120 offset:512
    ds_read_b64_tr_b16 v[60:61], v120 offset:5632
    ds_read_b64_tr_b16 v[62:63], v120 offset:768
    ds_read_b64_tr_b16 v[64:65], v120 offset:5888
    ds_read_b64_tr_b16 v[66:67], v120 offset:1024
    ds_read_b64_tr_b16 v[68:69], v120 offset:6144
    ds_read_b128 v[124:127], v121 offset:0
    ds_read_b128 v[128:131], v121 offset:256
    ds_read_b128 v[132:135], v121 offset:512
    ds_read_b128 v[136:139], v121 offset:768
    ds_read_b128 v[140:143], v121 offset:1024
    s_add_u32 s73, s55, 0
    s_mul_i32 s71, s56, 132096
    s_lshl_b32 s72, s73, 7
    s_add_u32 s71, s71, s72
    s_bfe_u32 s72, s73, 0x20001
    s_lshl_b32 s72, s72, 4
    v_xor_b32_e64 v46, s72, v122
    s_add_u32 s72, s71, 3801088
    s_waitcnt lgkmcnt(13)
    buffer_store_dwordx4 v[50:53], v46, s[40:43], s72 offen sc1
    s_add_u32 s72, s71, 4329472
    s_waitcnt lgkmcnt(11)
    buffer_store_dwordx4 v[54:57], v46, s[40:43], s72 offen sc1
    s_add_u32 s72, s71, 4857856
    s_waitcnt lgkmcnt(9)
    buffer_store_dwordx4 v[58:61], v46, s[40:43], s72 offen sc1
    s_add_u32 s72, s71, 5386240
    s_waitcnt lgkmcnt(7)
    buffer_store_dwordx4 v[62:65], v46, s[40:43], s72 offen sc1
    s_add_u32 s72, s71, 5914624
    s_waitcnt lgkmcnt(5)
    buffer_store_dwordx4 v[66:69], v46, s[40:43], s72 offen sc1
    v_mov_b32 v144, 0
    v_mov_b32 v145, 0
    v_mov_b32 v146, 0
    v_mov_b32 v147, 0
    s_waitcnt lgkmcnt(0)
    v_dot2c_f32_bf16 v144, v124, v148
    v_dot2c_f32_bf16 v146, v124, v124
    v_dot2c_f32_bf16 v145, v125, v148
    v_dot2c_f32_bf16 v147, v125, v125
    v_dot2c_f32_bf16 v144, v126, v148
    v_dot2c_f32_bf16 v146, v126, v126
    v_dot2c_f32_bf16 v145, v127, v148
    v_dot2c_f32_bf16 v147, v127, v127
    v_dot2c_f32_bf16 v144, v128, v148
    v_dot2c_f32_bf16 v146, v128, v128
    v_dot2c_f32_bf16 v145, v129, v148
    v_dot2c_f32_bf16 v147, v129, v129
    v_dot2c_f32_bf16 v144, v130, v148
    v_dot2c_f32_bf16 v146, v130, v130
    v_dot2c_f32_bf16 v145, v131, v148
    v_dot2c_f32_bf16 v147, v131, v131
    v_dot2c_f32_bf16 v144, v132, v148
    v_dot2c_f32_bf16 v146, v132, v132
    v_dot2c_f32_bf16 v145, v133, v148
    v_dot2c_f32_bf16 v147, v133, v133
    v_dot2c_f32_bf16 v144, v134, v148
    v_dot2c_f32_bf16 v146, v134, v134
    v_dot2c_f32_bf16 v145, v135, v148
    v_dot2c_f32_bf16 v147, v135, v135
    v_dot2c_f32_bf16 v144, v136, v148
    v_dot2c_f32_bf16 v146, v136, v136
    v_dot2c_f32_bf16 v145, v137, v148
    v_dot2c_f32_bf16 v147, v137, v137
    v_dot2c_f32_bf16 v144, v138, v148
    v_dot2c_f32_bf16 v146, v138, v138
    v_dot2c_f32_bf16 v145, v139, v148
    v_dot2c_f32_bf16 v147, v139, v139
    v_dot2c_f32_bf16 v144, v140, v148
    v_dot2c_f32_bf16 v146, v140, v140
    v_dot2c_f32_bf16 v145, v141, v148
    v_dot2c_f32_bf16 v147, v141, v141
    v_dot2c_f32_bf16 v144, v142, v148
    v_dot2c_f32_bf16 v146, v142, v142
    v_dot2c_f32_bf16 v145, v143, v148
    v_dot2c_f32_bf16 v147, v143, v143
    s_lshr_b32 s71, s73, 4
    s_lshl_b32 s71, s71, 11
    s_and_b32 s73, s73, 15
    s_lshl4_add_u32 s73, s56, s73
    s_lshl4_add_u32 s71, s73, s71
    s_add_u32 s71, s71, 172032
    v_add_f32 v144, v144, v145
    v_add_f32 v146, v146, v147
    s_nop 0
    v_add_f32_dpp v144, v144, v144 row_ror:8 row_mask:0xf bank_mask:0xf
    v_add_f32_dpp v146, v146, v146 row_ror:8 row_mask:0xf bank_mask:0xf
    s_nop 0
    v_add_f32_dpp v144, v144, v144 row_ror:4 row_mask:0xf bank_mask:0xf
    v_add_f32_dpp v146, v146, v146 row_ror:4 row_mask:0xf bank_mask:0xf
    s_nop 0
    v_add_f32_dpp v144, v144, v144 row_ror:2 row_mask:0xf bank_mask:0xf
    v_add_f32_dpp v146, v146, v146 row_ror:2 row_mask:0xf bank_mask:0xf
    s_nop 0
    s_nop 0
    v_add_f32_dpp v144, v144, v144 row_ror:1 row_mask:0xf bank_mask:0xf
    v_add_f32_dpp v146, v146, v146 row_ror:1 row_mask:0xf bank_mask:0xf
    v_mul_f32 v145, 0x3acccccd, v144
    v_mul_f32 v44, 0x3acccccd, v146
    v_fma_f32 v44, -v145, v145, v44
    v_max_f32 v44, 0, v44
    v_cvt_pk_bf16_f32 v145, v145, v145
    v_lshlrev_b32 v145, 16, v145
    v_cvt_pk_bf16_f32 v44, v44, v44
    v_lshlrev_b32 v44, 16, v44
    v_add_f32 v44, 0x3727c5ac, v44
    v_cvt_pk_bf16_f32 v44, v44, v44
    v_lshlrev_b32 v44, 16, v44
    v_sqrt_f32 v44, v44
    s_nop 0
    v_cvt_pk_bf16_f32 v147, v44, v44
    v_lshlrev_b32 v147, 16, v147
    v_rcp_f32 v147, v147
    v_cmp_eq_u32 vcc, 0, v7
    v_mul_f32_e64 v145, -v145, v147
    s_nop 0
    v_cndmask_b32 v45, v145, v147, vcc
    buffer_store_dword v45, v123, s[40:43], s71 offen sc1
    s_add_u32 s71, s69, s7
    buffer_load_dword v14, v151, s[24:27], s71 offen
    s_mov_b32 s38, 2621440
    s_mov_b32 s39, 0x00020000
    s_lshl2_add_u32 s72, s62, s56
    v_min_u32 v36, 29, v1
    v_lshlrev_b32 v36, 7, v36
    s_lshl_b32 s88, s72, 8
    s_add_u32 s88, s88, 188416
    v_min_u32 v30, 2, v7
    v_lshl_add_u32 v30, v30, 2, v8
    v_lshlrev_b32 v30, 4, v30
    s_mul_i32 s86, s61, 196608
    s_mul_i32 s72, s72, 768
    s_add_u32 s86, s86, s72
    s_add_u32 s86, s86, 15073280
    s_lshl4_add_u32 s87, s61, s62
    s_add_u32 s87, s87, 480
    s_lshl_b32 s87, s87, 7
    s_add_u32 s71, s56, 1
    s_and_b32 s71, s71, 3
    s_lshl_b32 s84, s71, 12
    s_lshl2_add_u32 s72, s63, s63
    s_add_u32 s71, s71, s72
    s_mul_i32 s72, s61, 81920
    s_add_u32 s72, s72, 6553600
    s_add_u32 s73, s71, 0
    s_sub_u32 s74, s73, 20
    s_min_u32 s73, s73, s74
    s_lshl_b32 s73, s73, 12
    s_add_u32 s79, s72, s73
    s_add_u32 s73, s71, 4
    s_sub_u32 s74, s73, 20
    s_min_u32 s73, s73, s74
    s_lshl_b32 s73, s73, 12
    s_add_u32 s80, s72, s73
    s_add_u32 s73, s71, 8
    s_sub_u32 s74, s73, 20
    s_min_u32 s73, s73, s74
    s_lshl_b32 s73, s73, 12
    s_add_u32 s81, s72, s73
    s_add_u32 s73, s71, 12
    s_sub_u32 s74, s73, 20
    s_min_u32 s73, s73, s74
    s_lshl_b32 s73, s73, 12
    s_add_u32 s82, s72, s73
    s_add_u32 s73, s71, 16
    s_sub_u32 s74, s73, 20
    s_min_u32 s73, s73, s74
    s_lshl_b32 s73, s73, 12
    s_add_u32 s83, s72, s73
    v_add_u32 v3, 1310720, v2
    v_lshrrev_b32 v27, 3, v1
    v_min_u32 v27, 4, v27
    v_lshl_add_u32 v27, v27, 2, s71
    v_subrev_u32 v44, 20, v27
    v_min_u32 v27, v27, v44
    s_and_b32 s73, s62, 3
    s_lshl_b32 s73, s73, 10
    s_add_u32 s73, s73, s72
    v_and_b32_e64 v44, 7, v1
    v_lshl_add_u32 v37, v27, 5, v44
    v_lshl_add_u32 v37, v37, 7, s73
    v_lshl_add_u32 v27, v27, 3, v44
    v_lshlrev_b32_e64 v27, 6, v27
    v_add_u32 v27, 20480, v27
    v_bfe_u32 v44, v1, 2, 2
    v_lshl_add_u32 v45, v8, 3, v44
    v_lshlrev_b32 v45, 7, v45
    v_and_b32 v46, 3, v1
    v_lshlrev_b32_e64 v28, 7, v46
    v_lshl_add_u32 v45, v46, 3, v45
    v_add_u32 v45, 81920, v45
    v_cmp_eq_u32 s[48:49], 1, v46
    v_cmp_eq_u32 s[50:51], 2, v46
    v_cmp_eq_u32 s[52:53], 3, v46
    v_lshrrev_b32 v44, 1, v44
    v_and_b32 v46, 1, v8
    v_lshl_or_b32 v44, v46, 1, v44
    s_add_u32 s71, s56, 0
    s_and_b32 s71, s71, 3
    v_xor_b32 v46, s71, v44
    v_lshl_add_u32 v16, v46, 5, v45
    s_add_u32 s71, s56, 1
    s_and_b32 s71, s71, 3
    v_xor_b32 v46, s71, v44
    v_lshl_add_u32 v17, v46, 5, v45
    s_add_u32 s71, s56, 2
    s_and_b32 s71, s71, 3
    v_xor_b32 v46, s71, v44
    v_lshl_add_u32 v18, v46, 5, v45
    s_add_u32 s71, s56, 3
    s_and_b32 s71, s71, 3
    v_xor_b32 v46, s71, v44
    v_lshl_add_u32 v19, v46, 5, v45
    v_mov_b32 v40, 0x3f803f80
    v_mov_b32 v41, 0x3f803f80
    v_mov_b32 v42, 0x3f803f80
    v_mov_b32 v43, 0x3f803f80
    s_lshl2_add_u32 s85, s61, s56
    s_lshl_b32 s85, s85, 10
    s_add_u32 s85, s85, 204800
    s_lshl_b32 s71, s63, 8
    s_and_b32 s72, s62, 3
    s_cselect_b32 s71, 0x80000000, s71
    v_lshrrev_b32 v44, 2, v7
    v_cmp_eq_u32_e64 vcc, v44, v8
    v_lshl_add_u32 v26, v7, 4, s71
    s_lshl_b32 s72, s56, 10
    s_add_u32 s72, s72, 81920
    v_cndmask_b32 v26, v5, v26, vcc
    v_lshl_add_u32 v24, v7, 4, s72
    v_sub_u32 v44, s56, v8
    v_and_b32_e64 v44, 3, v44
    v_lshl_add_u32 v44, v8, 2, v44
    v_lshl_add_u32 v44, v44, 4, v7
    v_lshlrev_b32 v44, 4, v44
    v_add_u32 v23, 81920, v44
    v_lshrrev_b32 v46, 1, v8
    v_lshl_add_u32 v25, v46, 8, v24
    s_mov_b32 s72, 49152
    v_lshlrev_b32 v45, 4, v7
    v_and_b32 v44, 1, v8
    v_add3_u32 v20, v44, s56, 0
    v_and_b32 v20, 3, v20
    v_mad_u32_u24 v20, v20, s72, v45
    v_lshl_add_u32 v20, v46, 8, v20
    v_add3_u32 v21, v44, s56, 2
    v_and_b32 v21, 3, v21
    v_mad_u32_u24 v21, v21, s72, v45
    v_lshl_add_u32 v21, v46, 8, v21
    v_lshl_or_b32 v22, v44, 1, v46
    v_add_u32 v22, s56, v22
    v_and_b32 v22, 3, v22
    v_mad_u32_u24 v22, v22, s72, v45
    s_mul_i32 s71, s56, 5600
    v_mul_u32_u24 v33, 560, v46
    v_lshl_add_u32 v33, v44, 8, v33
    v_add3_u32 v33, v33, v45, s71
    s_and_b32 s75, s57, 1
    s_lshl_b32 s75, s75, 2
    s_bfe_u32 s71, s57, 0x20001
    s_add_u32 s75, s75, s71
    s_lshl_b32 s75, s75, 1
    s_and_b32 s71, s58, 1
    s_add_u32 s75, s75, s71
    s_bfe_u32 s76, s58, 0x10001
    s_lshr_b32 s77, s57, 3
    s_mul_i32 s77, s77, 8
    s_lshr_b32 s71, s58, 2
    s_add_u32 s77, s77, s71
    s_lshl2_add_u32 s71, s77, s56
    s_mul_i32 s89, s71, 61440
    s_add_u32 s89, s89, 13107200
    s_and_b32 s71, s58, 3
    s_mul_i32 s71, s71, 3840
    s_add_u32 s96, s89, s71
    s_lshr_b32 s71, s58, 2
    s_mul_i32 s71, s71, 1536
    v_and_b32 v44, 31, v1
    v_min_u32 v44, 11, v44
    v_lshl_add_u32 v44, v44, 7, s71
    v_lshrrev_b32 v45, 5, v1
    v_mul_u32_u24 v45, 49152, v45
    v_add_u32_e64 v38, v44, v45
    s_lshl_b32 s71, s56, 3
    s_lshr_b32 s72, s77, 2
    s_add_u32 s71, s71, s72
    s_add_u32 s71, s71, 1200
    s_add_u32 s72, s62, 1296
    v_cmp_gt_u32 vcc, 4, v1
    v_lshl_add_u32 v29, v1, 1, s71
    v_mov_b32 v44, s72
    v_cndmask_b32 v29, v44, v29, vcc
    v_lshlrev_b32_e64 v29, 7, v29
    s_lshl2_add_u32 s94, s75, s56
    s_lshl_b32 s94, s94, 9
    s_add_u32 s94, s94, 61440
    s_lshl1_add_u32 s90, s75, s76
    s_mul_i32 s90, s90, 98304
    s_mul_i32 s71, s56, 12288
    s_add_u32 s90, s90, s71
    s_add_u32 s90, s90, 15073280
    s_lshr_b32 s71, s56, 1
    s_and_b32 s72, s56, 1
    v_lshrrev_b32 v44, 5, v1
    v_xor_b32 v44, s76, v44
    v_lshrrev_b32 v45, 2, v1
    v_lshl_add_u32 v44, v45, 1, v44
    v_and_b32_e64 v46, 3, v1
    v_lshl_add_u32 v44, v44, 2, v46
    v_lshlrev_b32 v31, 4, v44
    s_lshl4_add_u32 s92, s71, s75
    s_mul_i32 s92, s92, 81920
    s_mul_i32 s73, s77, 10240
    s_add_u32 s92, s92, s73
    s_mul_i32 s73, s72, 6144
    s_add_u32 s92, s92, s73
    s_add_u32 s92, s92, 6553600
    s_mul_i32 s93, s56, 3072
    s_add_u32 s93, s93, 98304
    s_mul_i32 s73, s71, 6144
    s_add_u32 s73, s73, 98304
    v_bfe_u32 v44, v1, 3, 1
    v_xor_b32 v44, s72, v44
    v_lshl_add_u32 v44, v45, 1, v44
    v_lshl_add_u32 v44, v44, 2, v46
    v_lshl_add_u32 v32, v44, 3, s73
    s_lshl2_add_u32 s91, s75, s71
    s_lshl1_add_u32 s91, s91, s76
    s_lshl1_add_u32 s91, s91, s72
    s_mul_i32 s91, s91, 5120
    s_mul_i32 s71, s77, 160
    s_add_u32 s91, s91, s71
    s_lshl_b32 s71, s56, 6
    s_movk_i32 s72, 1280
    v_min_u32 v44, 39, v1
    v_mul_u32_u24 v45, 6554, v44
    v_lshrrev_b32 v45, 16, v45
    v_mul_u32_u24 v46, 10, v45
    v_sub_u32_e64 v44, v44, v46
    v_mul_u32_u24 v34, 560, v44
    v_lshl_add_u32 v34, v45, 4, v34
    v_add_u32 v34, s71, v34
    v_cmp_gt_u32 vcc, 40, v1
    v_lshlrev_b32_e64 v44, 4, v44
    v_mad_u32_u24 v35, v45, s72, v44
    v_cndmask_b32 v35, v5, v35, vcc
    s_lshl_b32 s71, s55, 7
    s_add_u32 s71, s71, 137216
    v_cmp_gt_u32 vcc, 1, v0
    v_lshlrev_b32 v44, 7, v0
    s_nop 0
    v_cndmask_b32_e64 v44, v5, v44, vcc
    s_waitcnt vmcnt(1)
    s_barrier
    buffer_store_dwordx2 v[10:11], v44, s[40:43], s71 offen sc1
    s_lshl2_add_u32 s71, s55, s56
    s_mul_i32 s71, s71, 5120
    s_mul_i32 s72, s56, 5120
    s_add_u32 s71, s71, 1310720
    s_add_u32 m0, s72, 123520
    s_nop 0
    buffer_load_dwordx4 v110, s[20:23], s71 offen lds
    s_add_u32 m0, s72, 124544
    s_nop 0
    buffer_load_dwordx4 v111, s[20:23], s71 offen lds
    s_add_u32 m0, s72, 125568
    s_nop 0
    buffer_load_dwordx4 v112, s[20:23], s71 offen lds
    s_add_u32 m0, s72, 126592
    s_nop 0
    buffer_load_dwordx4 v113, s[20:23], s71 offen lds
    s_add_u32 m0, s72, 127616
    s_nop 0
    buffer_load_dwordx4 v114, s[20:23], s71 offen lds
    s_add_u32 s71, s70, s7
    buffer_load_dword v14, v151, s[24:27], s71 offen
    s_add_u32 m0, s95, 0
    s_nop 0
    buffer_load_dwordx4 v184, s[24:27], s67 offen lds
    s_add_u32 m0, s95, 1024
    s_nop 0
    buffer_load_dwordx4 v185, s[24:27], s67 offen lds
    s_add_u32 m0, s95, 2048
    s_nop 0
    buffer_load_dwordx4 v186, s[24:27], s67 offen lds
    s_add_u32 m0, s95, 12352
    s_add_u32 s64, s67, 98304
    buffer_load_dwordx4 v184, s[24:27], s64 offen lds
    s_add_u32 m0, s95, 13376
    s_nop 0
    buffer_load_dwordx4 v185, s[24:27], s64 offen lds
    s_add_u32 m0, s95, 14400
    s_nop 0
    buffer_load_dwordx4 v186, s[24:27], s64 offen lds
    s_add_u32 m0, s95, 24704
    s_add_u32 s64, s67, 196608
    buffer_load_dwordx4 v184, s[24:27], s64 offen lds
    s_add_u32 m0, s95, 25728
    s_nop 0
    buffer_load_dwordx4 v185, s[24:27], s64 offen lds
    s_add_u32 m0, s95, 26752
    s_nop 0
    buffer_load_dwordx4 v186, s[24:27], s64 offen lds
    s_add_u32 m0, s95, 37056
    s_add_u32 s64, s67, 294912
    buffer_load_dwordx4 v184, s[24:27], s64 offen lds
    s_add_u32 m0, s95, 38080
    s_nop 0
    buffer_load_dwordx4 v185, s[24:27], s64 offen lds
    s_add_u32 m0, s95, 39104
    s_nop 0
    buffer_load_dwordx4 v186, s[24:27], s64 offen lds
    s_add_u32 m0, s95, 49408
    s_add_u32 s64, s67, 393216
    buffer_load_dwordx4 v184, s[24:27], s64 offen lds
    s_add_u32 m0, s95, 50432
    s_nop 0
    buffer_load_dwordx4 v185, s[24:27], s64 offen lds
    s_add_u32 m0, s95, 51456
    s_nop 0
    buffer_load_dwordx4 v186, s[24:27], s64 offen lds
    s_waitcnt vmcnt(16)
    s_barrier
    ds_read_b64_tr_b16 v[70:71], v120 offset:20480
    ds_read_b64_tr_b16 v[72:73], v120 offset:25600
    ds_read_b64_tr_b16 v[74:75], v120 offset:20736
    ds_read_b64_tr_b16 v[76:77], v120 offset:25856
    ds_read_b64_tr_b16 v[78:79], v120 offset:20992
    ds_read_b64_tr_b16 v[80:81], v120 offset:26112
    ds_read_b64_tr_b16 v[82:83], v120 offset:21248
    ds_read_b64_tr_b16 v[84:85], v120 offset:26368
    ds_read_b64_tr_b16 v[86:87], v120 offset:21504
    ds_read_b64_tr_b16 v[88:89], v120 offset:26624
    ds_read_b128 v[124:127], v121 offset:20480
    ds_read_b128 v[128:131], v121 offset:20736
    ds_read_b128 v[132:135], v121 offset:20992
    ds_read_b128 v[136:139], v121 offset:21248
    ds_read_b128 v[140:143], v121 offset:21504
    s_add_u32 s73, s55, 64
    s_mul_i32 s71, s56, 132096
    s_lshl_b32 s72, s73, 7
    s_add_u32 s71, s71, s72
    s_bfe_u32 s72, s73, 0x20001
    s_lshl_b32 s72, s72, 4
    v_xor_b32 v46, s72, v122
    s_add_u32 s72, s71, 3801088
    s_waitcnt lgkmcnt(13)
    buffer_store_dwordx4 v[70:73], v46, s[40:43], s72 offen sc1
    s_add_u32 s72, s71, 4329472
    s_waitcnt lgkmcnt(11)
    buffer_store_dwordx4 v[74:77], v46, s[40:43], s72 offen sc1
    s_add_u32 s72, s71, 4857856
    s_waitcnt lgkmcnt(9)
    buffer_store_dwordx4 v[78:81], v46, s[40:43], s72 offen sc1
    s_add_u32 s72, s71, 5386240
    s_waitcnt lgkmcnt(7)
    buffer_store_dwordx4 v[82:85], v46, s[40:43], s72 offen sc1
    s_add_u32 s72, s71, 5914624
    s_waitcnt lgkmcnt(5)
    buffer_store_dwordx4 v[86:89], v46, s[40:43], s72 offen sc1
    v_mov_b32 v144, 0
    v_mov_b32 v145, 0
    v_mov_b32 v146, 0
    v_mov_b32 v147, 0
    s_waitcnt lgkmcnt(0)
    v_dot2c_f32_bf16 v144, v124, v148
    v_dot2c_f32_bf16 v146, v124, v124
    v_dot2c_f32_bf16 v145, v125, v148
    v_dot2c_f32_bf16 v147, v125, v125
    v_dot2c_f32_bf16 v144, v126, v148
    v_dot2c_f32_bf16 v146, v126, v126
    v_dot2c_f32_bf16 v145, v127, v148
    v_dot2c_f32_bf16 v147, v127, v127
    v_dot2c_f32_bf16 v144, v128, v148
    v_dot2c_f32_bf16 v146, v128, v128
    v_dot2c_f32_bf16 v145, v129, v148
    v_dot2c_f32_bf16 v147, v129, v129
    v_dot2c_f32_bf16 v144, v130, v148
    v_dot2c_f32_bf16 v146, v130, v130
    v_dot2c_f32_bf16 v145, v131, v148
    v_dot2c_f32_bf16 v147, v131, v131
    v_dot2c_f32_bf16 v144, v132, v148
    v_dot2c_f32_bf16 v146, v132, v132
    v_dot2c_f32_bf16 v145, v133, v148
    v_dot2c_f32_bf16 v147, v133, v133
    v_dot2c_f32_bf16 v144, v134, v148
    v_dot2c_f32_bf16 v146, v134, v134
    v_dot2c_f32_bf16 v145, v135, v148
    v_dot2c_f32_bf16 v147, v135, v135
    v_dot2c_f32_bf16 v144, v136, v148
    v_dot2c_f32_bf16 v146, v136, v136
    v_dot2c_f32_bf16 v145, v137, v148
    v_dot2c_f32_bf16 v147, v137, v137
    v_dot2c_f32_bf16 v144, v138, v148
    v_dot2c_f32_bf16 v146, v138, v138
    v_dot2c_f32_bf16 v145, v139, v148
    v_dot2c_f32_bf16 v147, v139, v139
    v_dot2c_f32_bf16 v144, v140, v148
    v_dot2c_f32_bf16 v146, v140, v140
    v_dot2c_f32_bf16 v145, v141, v148
    v_dot2c_f32_bf16 v147, v141, v141
    v_dot2c_f32_bf16 v144, v142, v148
    v_dot2c_f32_bf16 v146, v142, v142
    v_dot2c_f32_bf16 v145, v143, v148
    v_dot2c_f32_bf16 v147, v143, v143
    s_lshr_b32 s71, s73, 4
    s_lshl_b32 s71, s71, 11
    s_and_b32 s73, s73, 15
    s_lshl4_add_u32 s73, s56, s73
    s_lshl4_add_u32 s71, s73, s71
    s_add_u32 s71, s71, 172032
    v_add_f32 v144, v144, v145
    v_add_f32 v146, v146, v147
    s_nop 0
    v_add_f32_dpp v144, v144, v144 row_ror:8 row_mask:0xf bank_mask:0xf
    v_add_f32_dpp v146, v146, v146 row_ror:8 row_mask:0xf bank_mask:0xf
    s_nop 0
    v_add_f32_dpp v144, v144, v144 row_ror:4 row_mask:0xf bank_mask:0xf
    v_add_f32_dpp v146, v146, v146 row_ror:4 row_mask:0xf bank_mask:0xf
    s_nop 0
    v_add_f32_dpp v144, v144, v144 row_ror:2 row_mask:0xf bank_mask:0xf
    v_add_f32_dpp v146, v146, v146 row_ror:2 row_mask:0xf bank_mask:0xf
    s_nop 0
    v_add_f32_dpp v144, v144, v144 row_ror:1 row_mask:0xf bank_mask:0xf
    v_add_f32_dpp v146, v146, v146 row_ror:1 row_mask:0xf bank_mask:0xf
    v_mul_f32 v145, 0x3acccccd, v144
    v_mul_f32 v44, 0x3acccccd, v146
    v_fma_f32 v44, -v145, v145, v44
    v_max_f32 v44, 0, v44
    v_cvt_pk_bf16_f32 v145, v145, v145
    v_lshlrev_b32 v145, 16, v145
    v_cvt_pk_bf16_f32 v44, v44, v44
    v_lshlrev_b32 v44, 16, v44
    v_add_f32 v44, 0x3727c5ac, v44
    v_cvt_pk_bf16_f32 v44, v44, v44
    v_lshlrev_b32 v44, 16, v44
    v_sqrt_f32 v44, v44
    s_nop 0
    v_cvt_pk_bf16_f32 v147, v44, v44
    v_lshlrev_b32 v147, 16, v147
    v_rcp_f32 v147, v147
    v_cmp_eq_u32 vcc, 0, v7
    v_mul_f32_e64 v145, -v145, v147
    s_nop 0
    v_cndmask_b32 v45, v145, v147, vcc
    buffer_store_dword v45, v123, s[40:43], s71 offen sc1
    s_add_u32 m0, s95, 61760
    s_nop 0
    buffer_load_dwordx4 v184, s[24:27], s68 offen lds
    s_add_u32 m0, s95, 62784
    s_nop 0
    buffer_load_dwordx4 v185, s[24:27], s68 offen lds
    s_add_u32 m0, s95, 63808
    s_nop 0
    buffer_load_dwordx4 v186, s[24:27], s68 offen lds
    s_add_u32 m0, s95, 74112
    s_add_u32 s64, s68, 98304
    buffer_load_dwordx4 v184, s[24:27], s64 offen lds
    s_add_u32 m0, s95, 75136
    s_nop 0
    buffer_load_dwordx4 v185, s[24:27], s64 offen lds
    s_add_u32 m0, s95, 76160
    s_nop 0
    buffer_load_dwordx4 v186, s[24:27], s64 offen lds
    s_add_u32 m0, s95, 86464
    s_add_u32 s64, s68, 196608
    buffer_load_dwordx4 v184, s[24:27], s64 offen lds
    s_add_u32 m0, s95, 87488
    s_nop 0
    buffer_load_dwordx4 v185, s[24:27], s64 offen lds
    s_add_u32 m0, s95, 88512
    s_nop 0
    buffer_load_dwordx4 v186, s[24:27], s64 offen lds
    s_add_u32 m0, s95, 98816
    s_add_u32 s64, s68, 294912
    buffer_load_dwordx4 v184, s[24:27], s64 offen lds
    s_add_u32 m0, s95, 99840
    s_nop 0
    buffer_load_dwordx4 v185, s[24:27], s64 offen lds
    s_add_u32 m0, s95, 100864
    s_nop 0
    buffer_load_dwordx4 v186, s[24:27], s64 offen lds
    s_add_u32 m0, s95, 111168
    s_add_u32 s64, s68, 393216
    buffer_load_dwordx4 v184, s[24:27], s64 offen lds
    s_add_u32 m0, s95, 112192
    s_nop 0
    buffer_load_dwordx4 v185, s[24:27], s64 offen lds
    s_add_u32 m0, s95, 113216
    s_nop 0
    buffer_load_dwordx4 v186, s[24:27], s64 offen lds
    s_lshl_b32 s71, s55, 7
    s_add_u32 s71, s71, 145408
    v_cmp_gt_u32 vcc, 1, v0
    v_lshlrev_b32 v44, 7, v0
    s_nop 0
    v_cndmask_b32 v44, v5, v44, vcc
    s_waitcnt vmcnt(15)
    s_barrier
    buffer_store_dwordx2 v[10:11], v44, s[40:43], s71 offen sc1
    s_barrier
    ds_read_b64_tr_b16 a[0:1], v187 offset:0
    ds_read_b64_tr_b16 a[2:3], v187 offset:768
    ds_read_b64_tr_b16 a[4:5], v187 offset:3088
    ds_read_b64_tr_b16 a[6:7], v187 offset:3856
    ds_read_b64_tr_b16 a[8:9], v188 offset:0
    ds_read_b64_tr_b16 a[10:11], v188 offset:768
    ds_read_b64_tr_b16 a[12:13], v187 offset:12352
    ds_read_b64_tr_b16 a[14:15], v187 offset:13120
    ds_read_b64_tr_b16 a[16:17], v187 offset:15440
    ds_read_b64_tr_b16 a[18:19], v187 offset:16208
    ds_read_b64_tr_b16 a[20:21], v188 offset:12352
    ds_read_b64_tr_b16 a[22:23], v188 offset:13120
    ds_read_b64_tr_b16 a[24:25], v187 offset:24704
    ds_read_b64_tr_b16 a[26:27], v187 offset:25472
    ds_read_b64_tr_b16 a[28:29], v187 offset:27792
    ds_read_b64_tr_b16 a[30:31], v187 offset:28560
    ds_read_b64_tr_b16 a[32:33], v188 offset:24704
    ds_read_b64_tr_b16 a[34:35], v188 offset:25472
    ds_read_b64_tr_b16 a[36:37], v187 offset:37056
    ds_read_b64_tr_b16 a[38:39], v187 offset:37824
    ds_read_b64_tr_b16 a[40:41], v187 offset:40144
    ds_read_b64_tr_b16 a[42:43], v187 offset:40912
    ds_read_b64_tr_b16 a[44:45], v188 offset:37056
    ds_read_b64_tr_b16 a[46:47], v188 offset:37824
    ds_read_b64_tr_b16 a[48:49], v187 offset:49408
    ds_read_b64_tr_b16 a[50:51], v187 offset:50176
    ds_read_b64_tr_b16 a[52:53], v187 offset:52496
    ds_read_b64_tr_b16 a[54:55], v187 offset:53264
    ds_read_b64_tr_b16 a[56:57], v188 offset:49408
    ds_read_b64_tr_b16 a[58:59], v188 offset:50176
    v_add_u32 v187, 61760, v187
    v_add_u32 v188, 61760, v188
    s_waitcnt lgkmcnt(0)
    s_barrier
    s_add_u32 m0, s95, 0
    s_nop 0
    buffer_load_dwordx4 v184, s[24:27], s69 offen lds
    s_add_u32 m0, s95, 1024
    s_nop 0
    buffer_load_dwordx4 v185, s[24:27], s69 offen lds
    s_add_u32 m0, s95, 2048
    s_nop 0
    buffer_load_dwordx4 v186, s[24:27], s69 offen lds
    s_add_u32 m0, s95, 12352
    s_add_u32 s64, s69, 98304
    buffer_load_dwordx4 v184, s[24:27], s64 offen lds
    s_add_u32 m0, s95, 13376
    s_nop 0
    buffer_load_dwordx4 v185, s[24:27], s64 offen lds
    s_add_u32 m0, s95, 14400
    s_nop 0
    buffer_load_dwordx4 v186, s[24:27], s64 offen lds
    s_add_u32 m0, s95, 24704
    s_add_u32 s64, s69, 196608
    buffer_load_dwordx4 v184, s[24:27], s64 offen lds
    s_add_u32 m0, s95, 25728
    s_nop 0
    buffer_load_dwordx4 v185, s[24:27], s64 offen lds
    s_add_u32 m0, s95, 26752
    s_nop 0
    buffer_load_dwordx4 v186, s[24:27], s64 offen lds
    s_add_u32 m0, s95, 37056
    s_add_u32 s64, s69, 294912
    buffer_load_dwordx4 v184, s[24:27], s64 offen lds
    s_add_u32 m0, s95, 38080
    s_nop 0
    buffer_load_dwordx4 v185, s[24:27], s64 offen lds
    s_add_u32 m0, s95, 39104
    s_nop 0
    buffer_load_dwordx4 v186, s[24:27], s64 offen lds
    s_add_u32 m0, s95, 49408
    s_add_u32 s64, s69, 393216
    buffer_load_dwordx4 v184, s[24:27], s64 offen lds
    s_add_u32 m0, s95, 50432
    s_nop 0
    buffer_load_dwordx4 v185, s[24:27], s64 offen lds
    s_add_u32 m0, s95, 51456
    s_nop 0
    buffer_load_dwordx4 v186, s[24:27], s64 offen lds
    s_waitcnt vmcnt(16)
    s_barrier
    ds_read_b64_tr_b16 a[60:61], v187 offset:0
    ds_read_b64_tr_b16 a[62:63], v187 offset:768
    ds_read_b64_tr_b16 a[64:65], v187 offset:3088
    ds_read_b64_tr_b16 a[66:67], v187 offset:3856
    ds_read_b64_tr_b16 a[68:69], v188 offset:0
    ds_read_b64_tr_b16 a[70:71], v188 offset:768
    ds_read_b64_tr_b16 a[72:73], v187 offset:12352
    ds_read_b64_tr_b16 a[74:75], v187 offset:13120
    ds_read_b64_tr_b16 a[76:77], v187 offset:15440
    ds_read_b64_tr_b16 a[78:79], v187 offset:16208
    ds_read_b64_tr_b16 a[80:81], v188 offset:12352
    ds_read_b64_tr_b16 a[82:83], v188 offset:13120
    ds_read_b64_tr_b16 a[84:85], v187 offset:24704
    ds_read_b64_tr_b16 a[86:87], v187 offset:25472
    ds_read_b64_tr_b16 a[88:89], v187 offset:27792
    ds_read_b64_tr_b16 a[90:91], v187 offset:28560
    ds_read_b64_tr_b16 a[92:93], v188 offset:24704
    ds_read_b64_tr_b16 a[94:95], v188 offset:25472
    ds_read_b64_tr_b16 a[96:97], v187 offset:37056
    ds_read_b64_tr_b16 a[98:99], v187 offset:37824
    ds_read_b64_tr_b16 a[100:101], v187 offset:40144
    ds_read_b64_tr_b16 a[102:103], v187 offset:40912
    ds_read_b64_tr_b16 a[104:105], v188 offset:37056
    ds_read_b64_tr_b16 a[106:107], v188 offset:37824
    ds_read_b64_tr_b16 a[108:109], v187 offset:49408
    ds_read_b64_tr_b16 a[110:111], v187 offset:50176
    ds_read_b64_tr_b16 a[112:113], v187 offset:52496
    ds_read_b64_tr_b16 a[114:115], v187 offset:53264
    ds_read_b64_tr_b16 a[116:117], v188 offset:49408
    ds_read_b64_tr_b16 a[118:119], v188 offset:50176
    v_add_u32 v187, 4294905536, v187
    v_add_u32 v188, 4294905536, v188
    s_waitcnt lgkmcnt(0)
    s_barrier
    s_add_u32 m0, s95, 61760
    s_nop 0
    buffer_load_dwordx4 v184, s[24:27], s70 offen lds
    s_add_u32 m0, s95, 62784
    s_nop 0
    buffer_load_dwordx4 v185, s[24:27], s70 offen lds
    s_add_u32 m0, s95, 63808
    s_nop 0
    s_nop 0
    buffer_load_dwordx4 v186, s[24:27], s70 offen lds
    s_add_u32 m0, s95, 74112
    s_add_u32 s64, s70, 98304
    buffer_load_dwordx4 v184, s[24:27], s64 offen lds
    s_add_u32 m0, s95, 75136
    s_nop 0
    buffer_load_dwordx4 v185, s[24:27], s64 offen lds
    s_add_u32 m0, s95, 76160
    s_nop 0
    buffer_load_dwordx4 v186, s[24:27], s64 offen lds
    s_add_u32 m0, s95, 86464
    s_add_u32 s64, s70, 196608
    buffer_load_dwordx4 v184, s[24:27], s64 offen lds
    s_add_u32 m0, s95, 87488
    s_nop 0
    buffer_load_dwordx4 v185, s[24:27], s64 offen lds
    s_add_u32 m0, s95, 88512
    s_nop 0
    buffer_load_dwordx4 v186, s[24:27], s64 offen lds
    s_add_u32 m0, s95, 98816
    s_add_u32 s64, s70, 294912
    buffer_load_dwordx4 v184, s[24:27], s64 offen lds
    s_add_u32 m0, s95, 99840
    s_nop 0
    buffer_load_dwordx4 v185, s[24:27], s64 offen lds
    s_add_u32 m0, s95, 100864
    s_nop 0
    buffer_load_dwordx4 v186, s[24:27], s64 offen lds
    s_add_u32 m0, s95, 111168
    s_add_u32 s64, s70, 393216
    buffer_load_dwordx4 v184, s[24:27], s64 offen lds
    s_add_u32 m0, s95, 112192
    s_nop 0
    buffer_load_dwordx4 v185, s[24:27], s64 offen lds
    s_add_u32 m0, s95, 113216
    s_nop 0
    buffer_load_dwordx4 v186, s[24:27], s64 offen lds
    s_waitcnt vmcnt(15)
    s_barrier
    ds_read_b64_tr_b16 a[120:121], v187 offset:0
    ds_read_b64_tr_b16 a[122:123], v187 offset:768
    ds_read_b64_tr_b16 a[124:125], v187 offset:3088
    ds_read_b64_tr_b16 a[126:127], v187 offset:3856
    ds_read_b64_tr_b16 a[128:129], v188 offset:0
    ds_read_b64_tr_b16 a[130:131], v188 offset:768
    ds_read_b64_tr_b16 a[132:133], v187 offset:12352
    ds_read_b64_tr_b16 a[134:135], v187 offset:13120
    ds_read_b64_tr_b16 a[136:137], v187 offset:15440
    ds_read_b64_tr_b16 a[138:139], v187 offset:16208
    ds_read_b64_tr_b16 a[140:141], v188 offset:12352
    ds_read_b64_tr_b16 a[142:143], v188 offset:13120
    ds_read_b64_tr_b16 a[144:145], v187 offset:24704
    ds_read_b64_tr_b16 a[146:147], v187 offset:25472
    ds_read_b64_tr_b16 a[148:149], v187 offset:27792
    ds_read_b64_tr_b16 a[150:151], v187 offset:28560
    ds_read_b64_tr_b16 a[152:153], v188 offset:24704
    ds_read_b64_tr_b16 a[154:155], v188 offset:25472
    ds_read_b64_tr_b16 a[156:157], v187 offset:37056
    ds_read_b64_tr_b16 a[158:159], v187 offset:37824
    ds_read_b64_tr_b16 a[160:161], v187 offset:40144
    ds_read_b64_tr_b16 a[162:163], v187 offset:40912
    ds_read_b64_tr_b16 a[164:165], v188 offset:37056
    ds_read_b64_tr_b16 a[166:167], v188 offset:37824
    ds_read_b64_tr_b16 a[168:169], v187 offset:49408
    ds_read_b64_tr_b16 a[170:171], v187 offset:50176
    ds_read_b64_tr_b16 a[172:173], v187 offset:52496
    ds_read_b64_tr_b16 a[174:175], v187 offset:53264
    ds_read_b64_tr_b16 a[176:177], v188 offset:49408
    ds_read_b64_tr_b16 a[178:179], v188 offset:50176
    v_add_u32 v187, 61760, v187
    v_add_u32 v188, 61760, v188
    s_waitcnt lgkmcnt(0) vmcnt(0)
    s_barrier
    ds_read_b64_tr_b16 a[180:181], v187 offset:0
    ds_read_b64_tr_b16 a[182:183], v187 offset:768
    ds_read_b64_tr_b16 a[184:185], v187 offset:3088
    ds_read_b64_tr_b16 a[186:187], v187 offset:3856
    ds_read_b64_tr_b16 a[188:189], v188 offset:0
    ds_read_b64_tr_b16 a[190:191], v188 offset:768
    ds_read_b64_tr_b16 a[192:193], v187 offset:12352
    ds_read_b64_tr_b16 a[194:195], v187 offset:13120
    ds_read_b64_tr_b16 a[196:197], v187 offset:15440
    ds_read_b64_tr_b16 a[198:199], v187 offset:16208
    ds_read_b64_tr_b16 a[200:201], v188 offset:12352
    ds_read_b64_tr_b16 a[202:203], v188 offset:13120
    ds_read_b64_tr_b16 a[204:205], v187 offset:24704
    ds_read_b64_tr_b16 a[206:207], v187 offset:25472
    ds_read_b64_tr_b16 a[208:209], v187 offset:27792
    ds_read_b64_tr_b16 a[210:211], v187 offset:28560
    ds_read_b64_tr_b16 a[212:213], v188 offset:24704
    ds_read_b64_tr_b16 a[214:215], v188 offset:25472
    ds_read_b64_tr_b16 a[216:217], v187 offset:37056
    ds_read_b64_tr_b16 a[218:219], v187 offset:37824
    ds_read_b64_tr_b16 a[220:221], v187 offset:40144
    ds_read_b64_tr_b16 a[222:223], v187 offset:40912
    ds_read_b64_tr_b16 a[224:225], v188 offset:37056
    ds_read_b64_tr_b16 a[226:227], v188 offset:37824
    ds_read_b64_tr_b16 a[228:229], v187 offset:49408
    ds_read_b64_tr_b16 a[230:231], v187 offset:50176
    ds_read_b64_tr_b16 a[232:233], v187 offset:52496
    ds_read_b64_tr_b16 a[234:235], v187 offset:53264
    ds_read_b64_tr_b16 a[236:237], v188 offset:49408
    ds_read_b64_tr_b16 a[238:239], v188 offset:50176
    s_waitcnt lgkmcnt(0)
    s_branch L_ptail
L_dprep:
    s_waitcnt lgkmcnt(0)
    s_load_dwordx2 s[44:45], s[40:41], 524032
    s_and_b32 s61, s57, 1
    s_lshl_b32 s61, s61, 3
    s_lshr_b32 s73, s58, 2
    s_add_u32 s61, s61, s73
    s_lshr_b32 s62, s57, 1
    s_lshl_b32 s62, s62, 2
    s_and_b32 s73, s58, 3
    s_add_u32 s62, s62, s73
    s_lshr_b32 s63, s62, 2
    s_mul_i32 s74, s62, 192
    s_add_u32 s73, s63, 0
    s_and_b32 s73, s73, 3
    s_mul_i32 s73, s73, 491520
    s_add_u32 s67, s74, s73
    s_add_u32 s73, s63, 1
    s_and_b32 s73, s73, 3
    s_mul_i32 s73, s73, 491520
    s_add_u32 s68, s74, s73
    s_add_u32 s73, s63, 2
    s_and_b32 s73, s73, 3
    s_mul_i32 s73, s73, 491520
    s_add_u32 s69, s74, s73
    s_add_u32 s73, s63, 3
    s_and_b32 s73, s73, 3
    s_mul_i32 s73, s73, 491520
    s_add_u32 s70, s74, s73
    s_lshr_b32 s73, s56, 1
    s_lshl_b32 s73, s73, 3
    s_movk_i32 s74, 3072
    s_mul_i32 s95, s56, 3088
    v_add_u32 v44, 0, v1
    v_mul_u32_u24 v45, 5462, v44
    v_lshrrev_b32 v45, 16, v45
    v_mul_u32_u24 v46, 12, v45
    v_sub_u32 v44, v44, v46
    v_lshlrev_b32 v44, 4, v44
    v_and_b32 v46, 8, v45
    v_add3_u32 v45, v45, v46, s73
    v_mad_u32_u24 v184, v45, s74, v44
    v_add_u32 v44, 64, v1
    v_mul_u32_u24 v45, 5462, v44
    v_lshrrev_b32 v45, 16, v45
    v_mul_u32_u24 v46, 12, v45
    v_sub_u32 v44, v44, v46
    v_lshlrev_b32 v44, 4, v44
    v_and_b32_e64 v46, 8, v45
    v_add3_u32 v45, v45, v46, s73
    v_mad_u32_u24 v185, v45, s74, v44
    v_add_u32 v44, 128, v1
    v_mul_u32_u24 v45, 5462, v44
    v_lshrrev_b32 v45, 16, v45
    v_mul_u32_u24 v46, 12, v45
    v_sub_u32 v44, v44, v46
    v_lshlrev_b32 v44, 4, v44
    v_and_b32_e64 v46, 8, v45
    v_add3_u32 v45, v45, v46, s73
    v_mad_u32_u24 v186, v45, s74, v44
    s_mov_b32 s26, 1966080
    s_mov_b32 s27, 0x00020000
    s_bitcmp1_b32 s56, 0
    s_cselect_b32 s24, s32, s24
    s_cselect_b32 s25, s33, s25
    s_and_b32 s75, s56, 2
    s_sub_u32 s76, s54, 8
    s_lshl2_add_u32 s75, s76, s75
    v_add_u32 v44, 0, v1
    v_mul_u32_u24 v45, 10923, v44
    v_lshrrev_b32 v45, 16, v45
    v_mul_u32_u24 v46, 6, v45
    v_sub_u32 v44, v44, v46
    v_min_u32 v45, 9, v45
    v_mul_u32_u24 v45, 3072, v45
    v_lshl_add_u32 v151, v44, 7, v45
    s_and_b32 s72, s62, 3
    s_mul_i32 s72, s72, 192
    s_mul_i32 s7, s75, 30720
    s_sub_u32 s7, s7, s72
    s_add_u32 s71, s67, s7
    buffer_load_dword v14, v151, s[24:27], s71 offen
    s_add_u32 s71, s67, s7
    s_add_u32 s71, s71, 30720
    buffer_load_dword v14, v151, s[24:27], s71 offen
    s_mul_i32 s71, s57, 12
    s_add_u32 s71, s71, s54
    s_lshl2_add_u32 s71, s71, s56
    s_lshl_b32 s71, s71, 10
    v_cmp_gt_u32 vcc, 16, v1
    v_lshlrev_b32 v44, 6, v1
    v_mov_b32 v45, 0
    v_cndmask_b32_e64 v44, v5, v44, vcc
    buffer_atomic_add v45, v44, s[40:43], s71 offen sc1
    v_bfe_u32 v47, v1, 2, 2
    v_and_b32 v48, 3, v1
    v_bfe_u32 v46, v1, 2, 2
    v_and_b32 v44, 1, v8
    v_mul_u32_u24 v187, 6176, v44
    v_lshrrev_b32_e64 v44, 1, v8
    v_lshl_add_u32 v44, v44, 3, v46
    v_mul_u32_u24 v44, 192, v44
    s_mul_i32 s73, s56, 48
    s_add_u32 s73, s73, 0
    v_add3_u32 v187, v187, v44, s73
    v_and_b32 v46, 3, v1
    v_lshrrev_b32 v44, 1, v46
    v_mul_u32_u24 v44, 3088, v44
    v_and_b32_e64 v45, 1, v46
    v_lshl_add_u32 v44, v45, 3, v44
    v_add3_u32 v188, v187, v44, 32
    v_lshl_add_u32 v187, v46, 3, v187
    s_mov_b32 s30, 1966080
    s_mov_b32 s31, 0x00020000
    s_movk_i32 s73, 1280
    v_add_u32 v44, 0, v1
    v_mul_u32_u24 v45, 6554, v44
    v_lshrrev_b32 v45, 16, v45
    v_mul_u32_u24 v46, 10, v45
    v_sub_u32 v44, v44, v46
    v_lshlrev_b32 v44, 4, v44
    v_and_b32 v46, 4, v45
    v_lshlrev_b32 v46, 1, v46
    v_and_b32 v115, 8, v45
    v_lshrrev_b32 v115, 1, v115
    v_and_b32_e64 v45, 19, v45
    v_or3_b32 v45, v45, v46, v115
    v_mad_u32_u24 v115, v45, s73, v44
    v_add_u32 v44, 64, v1
    v_mul_u32_u24 v45, 6554, v44
    v_lshrrev_b32 v45, 16, v45
    v_mul_u32_u24 v46, 10, v45
    v_sub_u32 v44, v44, v46
    v_lshlrev_b32 v44, 4, v44
    v_and_b32 v46, 4, v45
    v_lshlrev_b32 v46, 1, v46
    v_and_b32 v116, 8, v45
    v_lshrrev_b32 v116, 1, v116
    v_and_b32 v45, 19, v45
    v_or3_b32 v45, v45, v46, v116
    v_mad_u32_u24 v116, v45, s73, v44
    v_add_u32 v44, 128, v1
    v_mul_u32_u24 v45, 6554, v44
    v_lshrrev_b32 v45, 16, v45
    v_mul_u32_u24 v46, 10, v45
    v_sub_u32 v44, v44, v46
    v_lshlrev_b32 v44, 4, v44
    v_and_b32 v46, 4, v45
    v_lshlrev_b32 v46, 1, v46
    v_and_b32 v117, 8, v45
    v_lshrrev_b32 v117, 1, v117
    v_and_b32_e64 v45, 19, v45
    v_or3_b32 v45, v45, v46, v117
    v_mad_u32_u24 v117, v45, s73, v44
    v_add_u32 v44, 192, v1
    v_mul_u32_u24 v45, 6554, v44
    v_lshrrev_b32 v45, 16, v45
    v_mul_u32_u24 v46, 10, v45
    v_sub_u32 v44, v44, v46
    v_lshlrev_b32 v44, 4, v44
    v_and_b32 v46, 4, v45
    v_lshlrev_b32 v46, 1, v46
    v_and_b32 v118, 8, v45
    v_lshrrev_b32 v118, 1, v118
    v_and_b32_e64 v45, 19, v45
    v_or3_b32 v45, v45, v46, v118
    v_mad_u32_u24 v118, v45, s73, v44
    v_add_u32 v44, 256, v1
    v_mul_u32_u24 v45, 6554, v44
    v_lshrrev_b32 v45, 16, v45
    v_mul_u32_u24 v46, 10, v45
    v_sub_u32 v44, v44, v46
    v_lshlrev_b32 v44, 4, v44
    v_and_b32 v46, 4, v45
    v_lshlrev_b32 v46, 1, v46
    v_and_b32 v119, 8, v45
    v_lshrrev_b32 v119, 1, v119
    v_and_b32_e64 v45, 19, v45
    v_or3_b32 v45, v45, v46, v119
    v_mad_u32_u24 v119, v45, s73, v44
    s_lshl2_add_u32 s74, s54, s56
    s_bfe_u32 s71, s74, 0x10003
    s_and_b32 s74, s74, 7
    s_lshl1_add_u32 s71, s57, s71
    s_mul_i32 s71, s71, 3
    s_mul_i32 s72, s74, 160
    s_mul_i32 s74, s74, 48
    s_add_u32 s74, s74, s71
    s_mul_i32 s71, s71, 40960
    s_add_u32 s5, s71, s72
    s_mul_i32 s6, s56, 15360
    s_mul_i32 s4, s74, 5120
    s_add_u32 s4, s4, 13107200
    v_and_b32 v44, 1, v8
    v_lshl_add_u32 v44, v44, 2, v47
    v_lshrrev_b32 v45, 1, v8
    v_lshl_add_u32 v44, v45, 4, v44
    v_mul_u32_u24 v44, 160, v44
    v_lshl_add_u32 v44, v48, 3, v44
    v_add_u32 v149, s6, v44
    s_lshl2_add_u32 s73, s57, s54
    s_add_u32 s73, s73, 1192
    s_lshl_b32 s73, s73, 7
    v_add_u32_e64 v6, s73, v4
    s_mov_b32 s38, 2621440
    s_mov_b32 s39, 0x00020000
    s_lshl2_add_u32 s72, s62, s56
    v_min_u32 v36, 29, v1
    v_lshlrev_b32 v36, 7, v36
    s_lshl_b32 s88, s72, 8
    s_add_u32 s88, s88, 188416
    v_min_u32 v30, 2, v7
    v_lshl_add_u32 v30, v30, 2, v8
    v_lshlrev_b32 v30, 4, v30
    s_mul_i32 s86, s61, 196608
    s_mul_i32 s72, s72, 768
    s_add_u32 s86, s86, s72
    s_add_u32 s86, s86, 15073280
    s_lshl4_add_u32 s87, s61, s62
    s_add_u32 s87, s87, 480
    s_lshl_b32 s87, s87, 7
    s_add_u32 s71, s56, 1
    s_and_b32 s71, s71, 3
    s_lshl_b32 s84, s71, 12
    s_lshl2_add_u32 s72, s63, s63
    s_add_u32 s71, s71, s72
    s_mul_i32 s72, s61, 81920
    s_add_u32 s72, s72, 6553600
    s_add_u32 s73, s71, 0
    s_sub_u32 s74, s73, 20
    s_min_u32 s73, s73, s74
    s_lshl_b32 s73, s73, 12
    s_add_u32 s79, s72, s73
    s_add_u32 s73, s71, 4
    s_sub_u32 s74, s73, 20
    s_min_u32 s73, s73, s74
    s_lshl_b32 s73, s73, 12
    s_add_u32 s80, s72, s73
    s_add_u32 s73, s71, 8
    s_sub_u32 s74, s73, 20
    s_min_u32 s73, s73, s74
    s_lshl_b32 s73, s73, 12
    s_add_u32 s81, s72, s73
    s_add_u32 s73, s71, 12
    s_sub_u32 s74, s73, 20
    s_min_u32 s73, s73, s74
    s_lshl_b32 s73, s73, 12
    s_add_u32 s82, s72, s73
    s_add_u32 s73, s71, 16
    s_sub_u32 s74, s73, 20
    s_min_u32 s73, s73, s74
    s_lshl_b32 s73, s73, 12
    s_add_u32 s83, s72, s73
    v_add_u32 v3, 1310720, v2
    v_lshrrev_b32 v27, 3, v1
    v_min_u32 v27, 4, v27
    v_lshl_add_u32 v27, v27, 2, s71
    v_subrev_u32 v44, 20, v27
    v_min_u32 v27, v27, v44
    s_and_b32 s73, s62, 3
    s_lshl_b32 s73, s73, 10
    s_add_u32 s73, s73, s72
    v_and_b32_e64 v44, 7, v1
    v_lshl_add_u32 v37, v27, 5, v44
    v_lshl_add_u32 v37, v37, 7, s73
    v_lshl_add_u32 v27, v27, 3, v44
    v_lshlrev_b32_e64 v27, 6, v27
    v_add_u32 v27, 20480, v27
    v_bfe_u32 v44, v1, 2, 2
    v_lshl_add_u32 v45, v8, 3, v44
    v_lshlrev_b32 v45, 7, v45
    v_and_b32 v46, 3, v1
    v_lshlrev_b32_e64 v28, 7, v46
    v_lshl_add_u32 v45, v46, 3, v45
    v_add_u32 v45, 81920, v45
    v_cmp_eq_u32 s[48:49], 1, v46
    v_cmp_eq_u32 s[50:51], 2, v46
    v_cmp_eq_u32 s[52:53], 3, v46
    v_lshrrev_b32 v44, 1, v44
    v_and_b32 v46, 1, v8
    v_lshl_or_b32 v44, v46, 1, v44
    s_add_u32 s71, s56, 0
    s_and_b32 s71, s71, 3
    v_xor_b32 v46, s71, v44
    v_lshl_add_u32 v16, v46, 5, v45
    s_add_u32 s71, s56, 1
    s_and_b32 s71, s71, 3
    v_xor_b32 v46, s71, v44
    v_lshl_add_u32 v17, v46, 5, v45
    s_add_u32 s71, s56, 2
    s_and_b32 s71, s71, 3
    v_xor_b32 v46, s71, v44
    v_lshl_add_u32 v18, v46, 5, v45
    s_add_u32 s71, s56, 3
    s_and_b32 s71, s71, 3
    v_xor_b32 v46, s71, v44
    v_lshl_add_u32 v19, v46, 5, v45
    v_mov_b32 v40, 0x3f803f80
    v_mov_b32 v41, 0x3f803f80
    v_mov_b32 v42, 0x3f803f80
    v_mov_b32 v43, 0x3f803f80
    s_lshl2_add_u32 s85, s61, s56
    s_lshl_b32 s85, s85, 10
    s_add_u32 s85, s85, 204800
    s_lshl_b32 s71, s63, 8
    s_and_b32 s72, s62, 3
    s_cselect_b32 s71, 0x80000000, s71
    v_lshrrev_b32 v44, 2, v7
    v_cmp_eq_u32_e64 vcc, v44, v8
    v_lshl_add_u32 v26, v7, 4, s71
    s_lshl_b32 s72, s56, 10
    s_add_u32 s72, s72, 81920
    v_cndmask_b32 v26, v5, v26, vcc
    v_lshl_add_u32 v24, v7, 4, s72
    v_sub_u32 v44, s56, v8
    v_and_b32_e64 v44, 3, v44
    v_lshl_add_u32 v44, v8, 2, v44
    v_lshl_add_u32 v44, v44, 4, v7
    v_lshlrev_b32 v44, 4, v44
    v_add_u32 v23, 81920, v44
    v_lshrrev_b32 v46, 1, v8
    v_lshl_add_u32 v25, v46, 8, v24
    s_mov_b32 s72, 49152
    v_lshlrev_b32 v45, 4, v7
    v_and_b32 v44, 1, v8
    v_add3_u32 v20, v44, s56, 0
    v_and_b32 v20, 3, v20
    v_mad_u32_u24 v20, v20, s72, v45
    v_lshl_add_u32 v20, v46, 8, v20
    v_add3_u32 v21, v44, s56, 2
    v_and_b32 v21, 3, v21
    v_mad_u32_u24 v21, v21, s72, v45
    v_lshl_add_u32 v21, v46, 8, v21
    v_lshl_or_b32 v22, v44, 1, v46
    v_add_u32 v22, s56, v22
    v_and_b32 v22, 3, v22
    v_mad_u32_u24 v22, v22, s72, v45
    s_mul_i32 s71, s56, 5600
    v_mul_u32_u24 v33, 560, v46
    v_lshl_add_u32 v33, v44, 8, v33
    v_add3_u32 v33, v33, v45, s71
    s_and_b32 s75, s57, 1
    s_lshl_b32 s75, s75, 2
    s_bfe_u32 s71, s57, 0x20001
    s_add_u32 s75, s75, s71
    s_lshl_b32 s75, s75, 1
    s_and_b32 s71, s58, 1
    s_add_u32 s75, s75, s71
    s_bfe_u32 s76, s58, 0x10001
    s_lshr_b32 s77, s57, 3
    s_mul_i32 s77, s77, 8
    s_lshr_b32 s71, s58, 2
    s_add_u32 s77, s77, s71
    s_lshl2_add_u32 s71, s77, s56
    s_mul_i32 s89, s71, 61440
    s_add_u32 s89, s89, 13107200
    s_and_b32 s71, s58, 3
    s_mul_i32 s71, s71, 3840
    s_add_u32 s96, s89, s71
    s_lshr_b32 s71, s58, 2
    s_mul_i32 s71, s71, 1536
    v_and_b32 v44, 31, v1
    v_min_u32 v44, 11, v44
    v_lshl_add_u32 v44, v44, 7, s71
    v_lshrrev_b32 v45, 5, v1
    v_mul_u32_u24 v45, 49152, v45
    v_add_u32_e64 v38, v44, v45
    s_lshl_b32 s71, s56, 3
    s_lshr_b32 s72, s77, 2
    s_add_u32 s71, s71, s72
    s_add_u32 s71, s71, 1200
    s_add_u32 s72, s62, 1296
    v_cmp_gt_u32 vcc, 4, v1
    v_lshl_add_u32 v29, v1, 1, s71
    v_mov_b32 v44, s72
    v_cndmask_b32 v29, v44, v29, vcc
    v_lshlrev_b32_e64 v29, 7, v29
    s_lshl2_add_u32 s94, s75, s56
    s_lshl_b32 s94, s94, 9
    s_add_u32 s94, s94, 61440
    s_lshl1_add_u32 s90, s75, s76
    s_mul_i32 s90, s90, 98304
    s_mul_i32 s71, s56, 12288
    s_add_u32 s90, s90, s71
    s_add_u32 s90, s90, 15073280
    s_lshr_b32 s71, s56, 1
    s_and_b32 s72, s56, 1
    v_lshrrev_b32 v44, 5, v1
    v_xor_b32 v44, s76, v44
    v_lshrrev_b32 v45, 2, v1
    v_lshl_add_u32 v44, v45, 1, v44
    v_and_b32_e64 v46, 3, v1
    v_lshl_add_u32 v44, v44, 2, v46
    v_lshlrev_b32 v31, 4, v44
    s_lshl4_add_u32 s92, s71, s75
    s_mul_i32 s92, s92, 81920
    s_mul_i32 s73, s77, 10240
    s_add_u32 s92, s92, s73
    s_mul_i32 s73, s72, 6144
    s_add_u32 s92, s92, s73
    s_add_u32 s92, s92, 6553600
    s_mul_i32 s93, s56, 3072
    s_add_u32 s93, s93, 98304
    s_mul_i32 s73, s71, 6144
    s_add_u32 s73, s73, 98304
    v_bfe_u32 v44, v1, 3, 1
    v_xor_b32 v44, s72, v44
    v_lshl_add_u32 v44, v45, 1, v44
    v_lshl_add_u32 v44, v44, 2, v46
    v_lshl_add_u32 v32, v44, 3, s73
    s_lshl2_add_u32 s91, s75, s71
    s_lshl1_add_u32 s91, s91, s76
    s_lshl1_add_u32 s91, s91, s72
    s_mul_i32 s91, s91, 5120
    s_mul_i32 s71, s77, 160
    s_add_u32 s91, s91, s71
    s_lshl_b32 s71, s56, 6
    s_movk_i32 s72, 1280
    v_min_u32 v44, 39, v1
    v_mul_u32_u24 v45, 6554, v44
    v_lshrrev_b32 v45, 16, v45
    v_mul_u32_u24 v46, 10, v45
    v_sub_u32_e64 v44, v44, v46
    v_mul_u32_u24 v34, 560, v44
    v_lshl_add_u32 v34, v45, 4, v34
    v_add_u32 v34, s71, v34
    v_cmp_gt_u32 vcc, 40, v1
    v_lshlrev_b32_e64 v44, 4, v44
    v_mad_u32_u24 v35, v45, s72, v44
    v_cndmask_b32 v35, v5, v35, vcc
    s_and_b32 s73, s57, 1
    s_cselect_b32 s73, 0x80000000, 0
    v_cmp_eq_u32 vcc, 0, v7
    v_or_b32 v44, s73, v30
    s_add_u32 s74, s62, 1296
    v_cndmask_b32 v150, v5, v44, vcc
    s_lshl_b32 s74, s74, 7
    s_or_b32 s74, s74, s73
    v_cmp_eq_u32 vcc, 1, v0
    v_mov_b32 v44, s74
    s_nop 0
    v_cndmask_b32 v6, v6, v44, vcc
    s_waitcnt lgkmcnt(0)
    s_add_u32 s44, s44, 0x7f4a7c15
    s_addc_u32 s45, s45, 0x9e3779b9
    v_mov_b32 v10, s44
    v_mov_b32 v11, s45
    s_add_u32 m0, s95, 0
    s_nop 0
    buffer_load_dwordx4 v184, s[24:27], s67 offen lds
    s_add_u32 m0, s95, 1024
    s_nop 0
    buffer_load_dwordx4 v185, s[24:27], s67 offen lds
    s_add_u32 m0, s95, 2048
    s_nop 0
    buffer_load_dwordx4 v186, s[24:27], s67 offen lds
    s_add_u32 m0, s95, 12352
    s_add_u32 s64, s67, 98304
    buffer_load_dwordx4 v184, s[24:27], s64 offen lds
    s_add_u32 m0, s95, 13376
    s_nop 0
    buffer_load_dwordx4 v185, s[24:27], s64 offen lds
    s_add_u32 m0, s95, 14400
    s_nop 0
    buffer_load_dwordx4 v186, s[24:27], s64 offen lds
    s_add_u32 m0, s95, 24704
    s_add_u32 s64, s67, 196608
    buffer_load_dwordx4 v184, s[24:27], s64 offen lds
    s_add_u32 m0, s95, 25728
    s_nop 0
    buffer_load_dwordx4 v185, s[24:27], s64 offen lds
    s_add_u32 m0, s95, 26752
    s_nop 0
    buffer_load_dwordx4 v186, s[24:27], s64 offen lds
    s_add_u32 m0, s95, 37056
    s_add_u32 s64, s67, 294912
    buffer_load_dwordx4 v184, s[24:27], s64 offen lds
    s_add_u32 m0, s95, 38080
    s_nop 0
    buffer_load_dwordx4 v185, s[24:27], s64 offen lds
    s_add_u32 m0, s95, 39104
    s_nop 0
    buffer_load_dwordx4 v186, s[24:27], s64 offen lds
    s_add_u32 m0, s95, 49408
    s_add_u32 s64, s67, 393216
    buffer_load_dwordx4 v184, s[24:27], s64 offen lds
    s_add_u32 m0, s95, 50432
    s_nop 0
    buffer_load_dwordx4 v185, s[24:27], s64 offen lds
    s_add_u32 m0, s95, 51456
    s_nop 0
    buffer_load_dwordx4 v186, s[24:27], s64 offen lds
    s_add_u32 m0, s95, 61760
    s_nop 0
    buffer_load_dwordx4 v184, s[24:27], s68 offen lds
    s_add_u32 m0, s95, 62784
    s_nop 0
    buffer_load_dwordx4 v185, s[24:27], s68 offen lds
    s_add_u32 m0, s95, 63808
    s_nop 0
    buffer_load_dwordx4 v186, s[24:27], s68 offen lds
    s_add_u32 m0, s95, 74112
    s_add_u32 s64, s68, 98304
    buffer_load_dwordx4 v184, s[24:27], s64 offen lds
    s_add_u32 m0, s95, 75136
    s_nop 0
    buffer_load_dwordx4 v185, s[24:27], s64 offen lds
    s_add_u32 m0, s95, 76160
    s_nop 0
    buffer_load_dwordx4 v186, s[24:27], s64 offen lds
    s_add_u32 m0, s95, 86464
    s_add_u32 s64, s68, 196608
    buffer_load_dwordx4 v184, s[24:27], s64 offen lds
    s_add_u32 m0, s95, 87488
    s_nop 0
    buffer_load_dwordx4 v185, s[24:27], s64 offen lds
    s_add_u32 m0, s95, 88512
    s_nop 0
    buffer_load_dwordx4 v186, s[24:27], s64 offen lds
    s_add_u32 m0, s95, 98816
    s_add_u32 s64, s68, 294912
    buffer_load_dwordx4 v184, s[24:27], s64 offen lds
    s_add_u32 m0, s95, 99840
    s_nop 0
    buffer_load_dwordx4 v185, s[24:27], s64 offen lds
    s_add_u32 m0, s95, 100864
    s_nop 0
    buffer_load_dwordx4 v186, s[24:27], s64 offen lds
    s_add_u32 m0, s95, 111168
    s_add_u32 s64, s68, 393216
    buffer_load_dwordx4 v184, s[24:27], s64 offen lds
    s_add_u32 m0, s95, 112192
    s_nop 0
    buffer_load_dwordx4 v185, s[24:27], s64 offen lds
    s_add_u32 m0, s95, 113216
    s_nop 0
    buffer_load_dwordx4 v186, s[24:27], s64 offen lds
    s_waitcnt vmcnt(15)
    s_barrier
    s_nop 0
    ds_read_b64_tr_b16 a[0:1], v187 offset:0
    ds_read_b64_tr_b16 a[2:3], v187 offset:768
    ds_read_b64_tr_b16 a[4:5], v187 offset:3088
    ds_read_b64_tr_b16 a[6:7], v187 offset:3856
    ds_read_b64_tr_b16 a[8:9], v188 offset:0
    ds_read_b64_tr_b16 a[10:11], v188 offset:768
    ds_read_b64_tr_b16 a[12:13], v187 offset:12352
    ds_read_b64_tr_b16 a[14:15], v187 offset:13120
    ds_read_b64_tr_b16 a[16:17], v187 offset:15440
    ds_read_b64_tr_b16 a[18:19], v187 offset:16208
    ds_read_b64_tr_b16 a[20:21], v188 offset:12352
    ds_read_b64_tr_b16 a[22:23], v188 offset:13120
    ds_read_b64_tr_b16 a[24:25], v187 offset:24704
    ds_read_b64_tr_b16 a[26:27], v187 offset:25472
    ds_read_b64_tr_b16 a[28:29], v187 offset:27792
    ds_read_b64_tr_b16 a[30:31], v187 offset:28560
    ds_read_b64_tr_b16 a[32:33], v188 offset:24704
    ds_read_b64_tr_b16 a[34:35], v188 offset:25472
    ds_read_b64_tr_b16 a[36:37], v187 offset:37056
    ds_read_b64_tr_b16 a[38:39], v187 offset:37824
    ds_read_b64_tr_b16 a[40:41], v187 offset:40144
    ds_read_b64_tr_b16 a[42:43], v187 offset:40912
    ds_read_b64_tr_b16 a[44:45], v188 offset:37056
    ds_read_b64_tr_b16 a[46:47], v188 offset:37824
    ds_read_b64_tr_b16 a[48:49], v187 offset:49408
    ds_read_b64_tr_b16 a[50:51], v187 offset:50176
    ds_read_b64_tr_b16 a[52:53], v187 offset:52496
    ds_read_b64_tr_b16 a[54:55], v187 offset:53264
    ds_read_b64_tr_b16 a[56:57], v188 offset:49408
    ds_read_b64_tr_b16 a[58:59], v188 offset:50176
    v_add_u32 v187, 61760, v187
    v_add_u32 v188, 61760, v188
    s_waitcnt lgkmcnt(0)
    s_barrier
    s_add_u32 m0, s95, 0
    s_nop 0
    buffer_load_dwordx4 v184, s[24:27], s69 offen lds
    s_add_u32 m0, s95, 1024
    s_nop 0
    buffer_load_dwordx4 v185, s[24:27], s69 offen lds
    s_add_u32 m0, s95, 2048
    s_nop 0
    buffer_load_dwordx4 v186, s[24:27], s69 offen lds
    s_add_u32 m0, s95, 12352
    s_add_u32 s64, s69, 98304
    buffer_load_dwordx4 v184, s[24:27], s64 offen lds
    s_add_u32 m0, s95, 13376
    s_nop 0
    buffer_load_dwordx4 v185, s[24:27], s64 offen lds
    s_add_u32 m0, s95, 14400
    s_nop 0
    buffer_load_dwordx4 v186, s[24:27], s64 offen lds
    s_add_u32 m0, s95, 24704
    s_add_u32 s64, s69, 196608
    buffer_load_dwordx4 v184, s[24:27], s64 offen lds
    s_add_u32 m0, s95, 25728
    s_nop 0
    buffer_load_dwordx4 v185, s[24:27], s64 offen lds
    s_add_u32 m0, s95, 26752
    s_nop 0
    buffer_load_dwordx4 v186, s[24:27], s64 offen lds
    s_add_u32 m0, s95, 37056
    s_add_u32 s64, s69, 294912
    buffer_load_dwordx4 v184, s[24:27], s64 offen lds
    s_add_u32 m0, s95, 38080
    s_nop 0
    buffer_load_dwordx4 v185, s[24:27], s64 offen lds
    s_add_u32 m0, s95, 39104
    s_nop 0
    buffer_load_dwordx4 v186, s[24:27], s64 offen lds
    s_add_u32 m0, s95, 49408
    s_add_u32 s64, s69, 393216
    buffer_load_dwordx4 v184, s[24:27], s64 offen lds
    s_add_u32 m0, s95, 50432
    s_nop 0
    buffer_load_dwordx4 v185, s[24:27], s64 offen lds
    s_add_u32 m0, s95, 51456
    s_nop 0
    buffer_load_dwordx4 v186, s[24:27], s64 offen lds
    s_waitcnt vmcnt(15)
    s_barrier
    ds_read_b64_tr_b16 a[60:61], v187 offset:0
    ds_read_b64_tr_b16 a[62:63], v187 offset:768
    ds_read_b64_tr_b16 a[64:65], v187 offset:3088
    ds_read_b64_tr_b16 a[66:67], v187 offset:3856
    ds_read_b64_tr_b16 a[68:69], v188 offset:0
    ds_read_b64_tr_b16 a[70:71], v188 offset:768
    ds_read_b64_tr_b16 a[72:73], v187 offset:12352
    ds_read_b64_tr_b16 a[74:75], v187 offset:13120
    ds_read_b64_tr_b16 a[76:77], v187 offset:15440
    ds_read_b64_tr_b16 a[78:79], v187 offset:16208
    ds_read_b64_tr_b16 a[80:81], v188 offset:12352
    ds_read_b64_tr_b16 a[82:83], v188 offset:13120
    ds_read_b64_tr_b16 a[84:85], v187 offset:24704
    ds_read_b64_tr_b16 a[86:87], v187 offset:25472
    ds_read_b64_tr_b16 a[88:89], v187 offset:27792
    ds_read_b64_tr_b16 a[90:91], v187 offset:28560
    ds_read_b64_tr_b16 a[92:93], v188 offset:24704
    ds_read_b64_tr_b16 a[94:95], v188 offset:25472
    ds_read_b64_tr_b16 a[96:97], v187 offset:37056
    ds_read_b64_tr_b16 a[98:99], v187 offset:37824
    ds_read_b64_tr_b16 a[100:101], v187 offset:40144
    ds_read_b64_tr_b16 a[102:103], v187 offset:40912
    ds_read_b64_tr_b16 a[104:105], v188 offset:37056
    ds_read_b64_tr_b16 a[106:107], v188 offset:37824
    ds_read_b64_tr_b16 a[108:109], v187 offset:49408
    ds_read_b64_tr_b16 a[110:111], v187 offset:50176
    ds_read_b64_tr_b16 a[112:113], v187 offset:52496
    ds_read_b64_tr_b16 a[114:115], v187 offset:53264
    ds_read_b64_tr_b16 a[116:117], v188 offset:49408
    ds_read_b64_tr_b16 a[118:119], v188 offset:50176
    v_add_u32 v187, 4294905536, v187
    v_add_u32 v188, 4294905536, v188
    s_waitcnt lgkmcnt(0)
    s_barrier
    s_add_u32 m0, s95, 61760
    s_nop 0
    buffer_load_dwordx4 v184, s[24:27], s70 offen lds
    s_add_u32 m0, s95, 62784
    s_nop 0
    buffer_load_dwordx4 v185, s[24:27], s70 offen lds
    s_add_u32 m0, s95, 63808
    s_nop 0
    buffer_load_dwordx4 v186, s[24:27], s70 offen lds
    s_add_u32 m0, s95, 74112
    s_add_u32 s64, s70, 98304
    buffer_load_dwordx4 v184, s[24:27], s64 offen lds
    s_add_u32 m0, s95, 75136
    s_nop 0
    buffer_load_dwordx4 v185, s[24:27], s64 offen lds
    s_add_u32 m0, s95, 76160
    s_nop 0
    buffer_load_dwordx4 v186, s[24:27], s64 offen lds
    s_add_u32 m0, s95, 86464
    s_add_u32 s64, s70, 196608
    buffer_load_dwordx4 v184, s[24:27], s64 offen lds
    s_add_u32 m0, s95, 87488
    s_nop 0
    buffer_load_dwordx4 v185, s[24:27], s64 offen lds
    s_add_u32 m0, s95, 88512
    s_nop 0
    buffer_load_dwordx4 v186, s[24:27], s64 offen lds
    s_add_u32 m0, s95, 98816
    s_add_u32 s64, s70, 294912
    buffer_load_dwordx4 v184, s[24:27], s64 offen lds
    s_add_u32 m0, s95, 99840
    s_nop 0
    buffer_load_dwordx4 v185, s[24:27], s64 offen lds
    s_add_u32 m0, s95, 100864
    s_nop 0
    buffer_load_dwordx4 v186, s[24:27], s64 offen lds
    s_add_u32 m0, s95, 111168
    s_add_u32 s64, s70, 393216
    buffer_load_dwordx4 v184, s[24:27], s64 offen lds
    s_add_u32 m0, s95, 112192
    s_nop 0
    buffer_load_dwordx4 v185, s[24:27], s64 offen lds
    s_add_u32 m0, s95, 113216
    s_nop 0
    buffer_load_dwordx4 v186, s[24:27], s64 offen lds
    s_waitcnt vmcnt(15)
    s_barrier
    ds_read_b64_tr_b16 a[120:121], v187 offset:0
    s_nop 0
    ds_read_b64_tr_b16 a[122:123], v187 offset:768
    ds_read_b64_tr_b16 a[124:125], v187 offset:3088
    ds_read_b64_tr_b16 a[126:127], v187 offset:3856
    ds_read_b64_tr_b16 a[128:129], v188 offset:0
    ds_read_b64_tr_b16 a[130:131], v188 offset:768
    ds_read_b64_tr_b16 a[132:133], v187 offset:12352
    ds_read_b64_tr_b16 a[134:135], v187 offset:13120
    ds_read_b64_tr_b16 a[136:137], v187 offset:15440
    ds_read_b64_tr_b16 a[138:139], v187 offset:16208
    ds_read_b64_tr_b16 a[140:141], v188 offset:12352
    ds_read_b64_tr_b16 a[142:143], v188 offset:13120
    ds_read_b64_tr_b16 a[144:145], v187 offset:24704
    ds_read_b64_tr_b16 a[146:147], v187 offset:25472
    ds_read_b64_tr_b16 a[148:149], v187 offset:27792
    ds_read_b64_tr_b16 a[150:151], v187 offset:28560
    ds_read_b64_tr_b16 a[152:153], v188 offset:24704
    ds_read_b64_tr_b16 a[154:155], v188 offset:25472
    ds_read_b64_tr_b16 a[156:157], v187 offset:37056
    ds_read_b64_tr_b16 a[158:159], v187 offset:37824
    ds_read_b64_tr_b16 a[160:161], v187 offset:40144
    ds_read_b64_tr_b16 a[162:163], v187 offset:40912
    ds_read_b64_tr_b16 a[164:165], v188 offset:37056
    ds_read_b64_tr_b16 a[166:167], v188 offset:37824
    ds_read_b64_tr_b16 a[168:169], v187 offset:49408
    ds_read_b64_tr_b16 a[170:171], v187 offset:50176
    ds_read_b64_tr_b16 a[172:173], v187 offset:52496
    ds_read_b64_tr_b16 a[174:175], v187 offset:53264
    ds_read_b64_tr_b16 a[176:177], v188 offset:49408
    ds_read_b64_tr_b16 a[178:179], v188 offset:50176
    v_add_u32 v187, 61760, v187
    v_add_u32 v188, 61760, v188
    s_waitcnt lgkmcnt(0)
    s_barrier
    s_add_u32 m0, s6, 0
    s_nop 0
    buffer_load_dwordx4 v115, s[28:31], s5 offen lds
    s_add_u32 m0, s6, 1024
    s_nop 0
    buffer_load_dwordx4 v116, s[28:31], s5 offen lds
    s_add_u32 m0, s6, 2048
    s_nop 0
    buffer_load_dwordx4 v117, s[28:31], s5 offen lds
    s_add_u32 m0, s6, 3072
    s_nop 0
    buffer_load_dwordx4 v118, s[28:31], s5 offen lds
    s_add_u32 m0, s6, 4096
    s_nop 0
    buffer_load_dwordx4 v119, s[28:31], s5 offen lds
    s_add_u32 s5, s5, 40960
    s_add_u32 m0, s6, 5120
    s_nop 0
    buffer_load_dwordx4 v115, s[28:31], s5 offen lds
    s_add_u32 m0, s6, 6144
    s_nop 0
    buffer_load_dwordx4 v116, s[28:31], s5 offen lds
    s_add_u32 m0, s6, 7168
    s_nop 0
    buffer_load_dwordx4 v117, s[28:31], s5 offen lds
    s_add_u32 m0, s6, 8192
    s_nop 0
    buffer_load_dwordx4 v118, s[28:31], s5 offen lds
    s_add_u32 m0, s6, 9216
    s_nop 0
    buffer_load_dwordx4 v119, s[28:31], s5 offen lds
    s_add_u32 s5, s5, 40960
    s_add_u32 m0, s6, 10240
    s_nop 0
    buffer_load_dwordx4 v115, s[28:31], s5 offen lds
    s_add_u32 m0, s6, 11264
    s_nop 0
    buffer_load_dwordx4 v116, s[28:31], s5 offen lds
    s_add_u32 m0, s6, 12288
    s_nop 0
    buffer_load_dwordx4 v117, s[28:31], s5 offen lds
    s_add_u32 m0, s6, 13312
    s_nop 0
    buffer_load_dwordx4 v118, s[28:31], s5 offen lds
    s_add_u32 m0, s6, 14336
    s_nop 0
    buffer_load_dwordx4 v119, s[28:31], s5 offen lds
    s_add_u32 s5, s5, 40960
    s_waitcnt vmcnt(15)
    s_barrier
    ds_read_b64_tr_b16 a[180:181], v187 offset:0
    ds_read_b64_tr_b16 a[182:183], v187 offset:768
    ds_read_b64_tr_b16 a[184:185], v187 offset:3088
    ds_read_b64_tr_b16 a[186:187], v187 offset:3856
    ds_read_b64_tr_b16 a[188:189], v188 offset:0
    ds_read_b64_tr_b16 a[190:191], v188 offset:768
    ds_read_b64_tr_b16 a[192:193], v187 offset:12352
    ds_read_b64_tr_b16 a[194:195], v187 offset:13120
    ds_read_b64_tr_b16 a[196:197], v187 offset:15440
    ds_read_b64_tr_b16 a[198:199], v187 offset:16208
    ds_read_b64_tr_b16 a[200:201], v188 offset:12352
    ds_read_b64_tr_b16 a[202:203], v188 offset:13120
    ds_read_b64_tr_b16 a[204:205], v187 offset:24704
    ds_read_b64_tr_b16 a[206:207], v187 offset:25472
    ds_read_b64_tr_b16 a[208:209], v187 offset:27792
    ds_read_b64_tr_b16 a[210:211], v187 offset:28560
    ds_read_b64_tr_b16 a[212:213], v188 offset:24704
    ds_read_b64_tr_b16 a[214:215], v188 offset:25472
    ds_read_b64_tr_b16 a[216:217], v187 offset:37056
    ds_read_b64_tr_b16 a[218:219], v187 offset:37824
    ds_read_b64_tr_b16 a[220:221], v187 offset:40144
    ds_read_b64_tr_b16 a[222:223], v187 offset:40912
    ds_read_b64_tr_b16 a[224:225], v188 offset:37056
    ds_read_b64_tr_b16 a[226:227], v188 offset:37824
    ds_read_b64_tr_b16 a[228:229], v187 offset:49408
    ds_read_b64_tr_b16 a[230:231], v187 offset:50176
    ds_read_b64_tr_b16 a[232:233], v187 offset:52496
    ds_read_b64_tr_b16 a[234:235], v187 offset:53264
    ds_read_b64_tr_b16 a[236:237], v188 offset:49408
    ds_read_b64_tr_b16 a[238:239], v188 offset:50176
    s_waitcnt lgkmcnt(0)
    v_mfma_f32_16x16x32_bf16 v[172:175], a[0:3], v[40:43], 0
    v_mfma_f32_16x16x32_bf16 v[176:179], a[4:7], v[40:43], 0
    v_mfma_f32_16x16x32_bf16 v[180:183], a[8:11], v[40:43], 0
    v_mfma_f32_16x16x32_bf16 v[172:175], a[12:15], v[40:43], v[172:175]
    v_mfma_f32_16x16x32_bf16 v[176:179], a[16:19], v[40:43], v[176:179]
    v_mfma_f32_16x16x32_bf16 v[180:183], a[20:23], v[40:43], v[180:183]
    v_mfma_f32_16x16x32_bf16 v[172:175], a[24:27], v[40:43], v[172:175]
    v_mfma_f32_16x16x32_bf16 v[176:179], a[28:31], v[40:43], v[176:179]
    v_mfma_f32_16x16x32_bf16 v[180:183], a[32:35], v[40:43], v[180:183]
    v_mfma_f32_16x16x32_bf16 v[172:175], a[36:39], v[40:43], v[172:175]
    v_mfma_f32_16x16x32_bf16 v[176:179], a[40:43], v[40:43], v[176:179]
    v_mfma_f32_16x16x32_bf16 v[180:183], a[44:47], v[40:43], v[180:183]
    v_mfma_f32_16x16x32_bf16 v[172:175], a[48:51], v[40:43], v[172:175]
    v_mfma_f32_16x16x32_bf16 v[176:179], a[52:55], v[40:43], v[176:179]
    v_mfma_f32_16x16x32_bf16 v[180:183], a[56:59], v[40:43], v[180:183]
    v_mfma_f32_16x16x32_bf16 v[172:175], a[60:63], v[40:43], v[172:175]
    v_mfma_f32_16x16x32_bf16 v[176:179], a[64:67], v[40:43], v[176:179]
    v_mfma_f32_16x16x32_bf16 v[180:183], a[68:71], v[40:43], v[180:183]
    v_mfma_f32_16x16x32_bf16 v[172:175], a[72:75], v[40:43], v[172:175]
    v_mfma_f32_16x16x32_bf16 v[176:179], a[76:79], v[40:43], v[176:179]
    v_mfma_f32_16x16x32_bf16 v[180:183], a[80:83], v[40:43], v[180:183]
    v_mfma_f32_16x16x32_bf16 v[172:175], a[84:87], v[40:43], v[172:175]
    v_mfma_f32_16x16x32_bf16 v[176:179], a[88:91], v[40:43], v[176:179]
    v_mfma_f32_16x16x32_bf16 v[180:183], a[92:95], v[40:43], v[180:183]
    v_mfma_f32_16x16x32_bf16 v[172:175], a[96:99], v[40:43], v[172:175]
    v_mfma_f32_16x16x32_bf16 v[176:179], a[100:103], v[40:43], v[176:179]
    v_mfma_f32_16x16x32_bf16 v[180:183], a[104:107], v[40:43], v[180:183]
    v_mfma_f32_16x16x32_bf16 v[172:175], a[108:111], v[40:43], v[172:175]
    v_mfma_f32_16x16x32_bf16 v[176:179], a[112:115], v[40:43], v[176:179]
    v_mfma_f32_16x16x32_bf16 v[180:183], a[116:119], v[40:43], v[180:183]
    v_mfma_f32_16x16x32_bf16 v[172:175], a[120:123], v[40:43], v[172:175]
    v_mfma_f32_16x16x32_bf16 v[176:179], a[124:127], v[40:43], v[176:179]
    v_mfma_f32_16x16x32_bf16 v[180:183], a[128:131], v[40:43], v[180:183]
    v_mfma_f32_16x16x32_bf16 v[172:175], a[132:135], v[40:43], v[172:175]
    v_mfma_f32_16x16x32_bf16 v[176:179], a[136:139], v[40:43], v[176:179]
    v_mfma_f32_16x16x32_bf16 v[180:183], a[140:143], v[40:43], v[180:183]
    v_mfma_f32_16x16x32_bf16 v[172:175], a[144:147], v[40:43], v[172:175]
    v_mfma_f32_16x16x32_bf16 v[176:179], a[148:151], v[40:43], v[176:179]
    v_mfma_f32_16x16x32_bf16 v[180:183], a[152:155], v[40:43], v[180:183]
    v_mfma_f32_16x16x32_bf16 v[172:175], a[156:159], v[40:43], v[172:175]
    v_mfma_f32_16x16x32_bf16 v[176:179], a[160:163], v[40:43], v[176:179]
    v_mfma_f32_16x16x32_bf16 v[180:183], a[164:167], v[40:43], v[180:183]
    v_mfma_f32_16x16x32_bf16 v[172:175], a[168:171], v[40:43], v[172:175]
    v_mfma_f32_16x16x32_bf16 v[176:179], a[172:175], v[40:43], v[176:179]
    v_mfma_f32_16x16x32_bf16 v[180:183], a[176:179], v[40:43], v[180:183]
    v_mfma_f32_16x16x32_bf16 v[172:175], a[180:183], v[40:43], v[172:175]
    v_mfma_f32_16x16x32_bf16 v[176:179], a[184:187], v[40:43], v[176:179]
    v_mfma_f32_16x16x32_bf16 v[180:183], a[188:191], v[40:43], v[180:183]
    v_mfma_f32_16x16x32_bf16 v[172:175], a[192:195], v[40:43], v[172:175]
    v_mfma_f32_16x16x32_bf16 v[176:179], a[196:199], v[40:43], v[176:179]
    v_mfma_f32_16x16x32_bf16 v[180:183], a[200:203], v[40:43], v[180:183]
    v_mfma_f32_16x16x32_bf16 v[172:175], a[204:207], v[40:43], v[172:175]
    v_mfma_f32_16x16x32_bf16 v[176:179], a[208:211], v[40:43], v[176:179]
    v_mfma_f32_16x16x32_bf16 v[180:183], a[212:215], v[40:43], v[180:183]
    v_mfma_f32_16x16x32_bf16 v[172:175], a[216:219], v[40:43], v[172:175]
    v_mfma_f32_16x16x32_bf16 v[176:179], a[220:223], v[40:43], v[176:179]
    v_mfma_f32_16x16x32_bf16 v[180:183], a[224:227], v[40:43], v[180:183]
    v_mfma_f32_16x16x32_bf16 v[172:175], a[228:231], v[40:43], v[172:175]
    v_mfma_f32_16x16x32_bf16 v[176:179], a[232:235], v[40:43], v[176:179]
    v_mfma_f32_16x16x32_bf16 v[180:183], a[236:239], v[40:43], v[180:183]
    s_nop 5
    buffer_store_dwordx4 v[172:175], v150, s[40:43], s88 offen offset:0 sc1
    buffer_store_dwordx4 v[176:179], v150, s[40:43], s88 offen offset:64 sc1
    buffer_store_dwordx4 v[180:183], v150, s[40:43], s88 offen offset:128 sc1
    s_waitcnt vmcnt(13)
    s_nop 0
    ds_read_b64_tr_b16 v[50:51], v149 offset:0
    ds_read_b64_tr_b16 v[52:53], v149 offset:1280
    ds_read_b64_tr_b16 v[54:55], v149 offset:32
    ds_read_b64_tr_b16 v[56:57], v149 offset:1312
    ds_read_b64_tr_b16 v[58:59], v149 offset:64
    ds_read_b64_tr_b16 v[60:61], v149 offset:1344
    ds_read_b64_tr_b16 v[62:63], v149 offset:96
    ds_read_b64_tr_b16 v[64:65], v149 offset:1376
    ds_read_b64_tr_b16 v[66:67], v149 offset:128
    ds_read_b64_tr_b16 v[68:69], v149 offset:1408
    s_waitcnt lgkmcnt(8)
    buffer_store_dwordx4 v[50:53], v2, s[40:43], s4 offen offset:0 sc1
    s_waitcnt lgkmcnt(6)
    buffer_store_dwordx4 v[54:57], v2, s[40:43], s4 offen offset:1024 sc1
    s_waitcnt lgkmcnt(4)
    buffer_store_dwordx4 v[58:61], v2, s[40:43], s4 offen offset:2048 sc1
    s_waitcnt lgkmcnt(2)
    buffer_store_dwordx4 v[62:65], v2, s[40:43], s4 offen offset:3072 sc1
    s_add_u32 s4, s4, 4096
    s_waitcnt lgkmcnt(0)
    buffer_store_dwordx4 v[66:69], v2, s[40:43], s4 offen offset:0 sc1
    s_waitcnt vmcnt(13)
    ds_read_b64_tr_b16 v[70:71], v149 offset:5120
    ds_read_b64_tr_b16 v[72:73], v149 offset:6400
    ds_read_b64_tr_b16 v[74:75], v149 offset:5152
    ds_read_b64_tr_b16 v[76:77], v149 offset:6432
    ds_read_b64_tr_b16 v[78:79], v149 offset:5184
    ds_read_b64_tr_b16 v[80:81], v149 offset:6464
    ds_read_b64_tr_b16 v[82:83], v149 offset:5216
    ds_read_b64_tr_b16 v[84:85], v149 offset:6496
    ds_read_b64_tr_b16 v[86:87], v149 offset:5248
    ds_read_b64_tr_b16 v[88:89], v149 offset:6528
    s_waitcnt lgkmcnt(8)
    buffer_store_dwordx4 v[70:73], v2, s[40:43], s4 offen offset:1024 sc1
    s_waitcnt lgkmcnt(6)
    buffer_store_dwordx4 v[74:77], v2, s[40:43], s4 offen offset:2048 sc1
    s_waitcnt lgkmcnt(4)
    buffer_store_dwordx4 v[78:81], v2, s[40:43], s4 offen offset:3072 sc1
    s_add_u32 s4, s4, 4096
    s_waitcnt lgkmcnt(2)
    buffer_store_dwordx4 v[82:85], v2, s[40:43], s4 offen offset:0 sc1
    s_waitcnt lgkmcnt(0)
    buffer_store_dwordx4 v[86:89], v2, s[40:43], s4 offen offset:1024 sc1
    s_waitcnt vmcnt(13)
    ds_read_b64_tr_b16 v[90:91], v149 offset:10240
    ds_read_b64_tr_b16 v[92:93], v149 offset:11520
    ds_read_b64_tr_b16 v[94:95], v149 offset:10272
    ds_read_b64_tr_b16 v[96:97], v149 offset:11552
    ds_read_b64_tr_b16 v[98:99], v149 offset:10304
    ds_read_b64_tr_b16 v[100:101], v149 offset:11584
    ds_read_b64_tr_b16 v[102:103], v149 offset:10336
    ds_read_b64_tr_b16 v[104:105], v149 offset:11616
    ds_read_b64_tr_b16 v[106:107], v149 offset:10368
    ds_read_b64_tr_b16 v[108:109], v149 offset:11648
    s_waitcnt lgkmcnt(8)
    buffer_store_dwordx4 v[90:93], v2, s[40:43], s4 offen offset:2048 sc1
    s_waitcnt lgkmcnt(6)
    buffer_store_dwordx4 v[94:97], v2, s[40:43], s4 offen offset:3072 sc1
    s_add_u32 s4, s4, 4096
    s_waitcnt lgkmcnt(4)
    buffer_store_dwordx4 v[98:101], v2, s[40:43], s4 offen offset:0 sc1
    s_waitcnt lgkmcnt(2)
    buffer_store_dwordx4 v[102:105], v2, s[40:43], s4 offen offset:1024 sc1
    s_waitcnt lgkmcnt(0)
    buffer_store_dwordx4 v[106:109], v2, s[40:43], s4 offen offset:2048 sc1
L_ptail:
    s_mov_b32 s3, 1
    s_mov_b64 exec, 0
    s_cmp_eq_u32 s56, 0
    s_cbranch_scc1 L_pg1
    s_cmp_eq_u32 s56, 1
    s_cbranch_scc1 L_pg2
    s_cmp_eq_u32 s56, 2
    s_cbranch_scc1 L_pg3
    s_branch L_pg4
L_pgret2:
    s_waitcnt vmcnt(0)
    s_barrier
    buffer_store_dwordx2 v[10:11], v6, s[40:43], 0 offen sc1
    v_mov_b32_e64 v6, v5
    s_add_u32 s76, s57, 1312
    s_lshl_b32 s76, s76, 7
    v_mov_b32 v9, 0
    buffer_load_dwordx2 v[12:13], v9, s[40:43], s76 offen sc1
    s_waitcnt vmcnt(0)
    v_cmp_ne_u64 vcc, v[10:11], v[12:13]
    s_cbranch_vccnz L_spin24
L_ok23:
    buffer_load_dwordx2 v[12:13], v27, s[40:43], 0 offen sc1
    s_waitcnt vmcnt(0)
    v_cmp_ne_u64 vcc, v[10:11], v[12:13]
    s_cbranch_vccnz L_spin28
L_ok27:
    s_add_u32 m0, s84, 81920
    s_nop 0
    buffer_load_dwordx4 v2, s[40:43], s79 offen offset:0 sc1 lds
    buffer_load_dwordx4 v2, s[40:43], s79 offen offset:1024 sc1 lds
    buffer_load_dwordx4 v2, s[40:43], s79 offen offset:2048 sc1 lds
    buffer_load_dwordx4 v2, s[40:43], s79 offen offset:3072 sc1 lds
    s_add_u32 m0, s84, 98304
    s_nop 0
    buffer_load_dwordx4 v2, s[40:43], s80 offen offset:0 sc1 lds
    buffer_load_dwordx4 v2, s[40:43], s80 offen offset:1024 sc1 lds
    buffer_load_dwordx4 v2, s[40:43], s80 offen offset:2048 sc1 lds
    buffer_load_dwordx4 v2, s[40:43], s80 offen offset:3072 sc1 lds
    s_waitcnt vmcnt(4)
    s_branch L_join
L_codeend:
.if (L_codeend - L_main) > 45056
.error "code larger than the prefetched range"
.endif
.fill (49152 - (L_codeend - L_main)) / 4, 4, 0xbf800000
.section .rodata,"a"
.p2align 6
.amdhsa_kernel sequential_preLN__ssm_conv_h3__geglu_ffn__prompt_kernel
  .amdhsa_next_free_vgpr 512
  .amdhsa_next_free_sgpr 102
  .amdhsa_accum_offset 256
  .amdhsa_group_segment_fixed_size 0
  .amdhsa_kernarg_size 104
  .amdhsa_user_sgpr_count 2
  .amdhsa_user_sgpr_kernarg_segment_ptr 1
  .amdhsa_system_sgpr_workgroup_id_x 1
.end_amdhsa_kernel
```
